```python
import torch

def _softmax(x, axis=-1):
    return torch.softmax(x, dim=axis)
def _gelu(x):
    return torch.nn.functional.gelu(x, approximate="tanh")
def _silu(x):
    return torch.nn.functional.silu(x)
def _sigmoid(x):
    return torch.sigmoid(x)
def _layernorm(x, axis=-1, eps=1e-5):
    m = x.mean(dim=axis, keepdim=True)
    v = x.var(dim=axis, keepdim=True, unbiased=False)
    return (x - m) / torch.sqrt(v + eps)
def _scatter_add(tgt, idx, src, axis=0):
    return tgt.clone().index_add_(axis, idx, src)
def _segment_sum(src, seg, n):
    out = torch.zeros((n,) + src.shape[1:], dtype=src.dtype)
    return out.index_add_(0, seg, src)
def _pad(x, pw):
    flat = tuple(v for pair in reversed(pw) for v in pair)
    return torch.nn.functional.pad(x, flat)

kernel_name = 'recurrent_scan__spectral_gfnet__glu_gated_bilinear__prompt'

def setup_inputs():

    _w = (lambda a: (lambda t: t.to(torch.bfloat16) if t.is_floating_point() else t)(torch.as_tensor(a)))
    def _A_setup():
        B, S, D = 1, 2048, 1024
        Df = D // 2 + 1
        return {
            "x": _w((lambda *s: torch.randn(*s, dtype=torch.bfloat16) * 0.2)(B, S, D)),
            "w_r": _w((lambda *s: torch.randn(*s, dtype=torch.bfloat16) * 1.6)(S, Df) * 0.02),
            "w_i": _w((lambda *s: torch.randn(*s, dtype=torch.bfloat16) * 1.6)(S, Df) * 0.02),
        }
    _A_in = _A_setup()

    def _B_setup():
        B, S, D, F = 1, 2048, 1024, 3584
        return {
            "x": _w((lambda *s: torch.randn(*s, dtype=torch.bfloat16) * 0.2)(B, S, D)),
            "w_gate": _w((lambda *s: torch.randn(*s, dtype=torch.bfloat16) * 0.8)(D, F) * (D ** -0.5)),
            "w_up": _w((lambda *s: torch.randn(*s, dtype=torch.bfloat16) * 0.8)(D, F) * (D ** -0.5)),
            "w_down": _w((lambda *s: torch.randn(*s, dtype=torch.bfloat16) * 0.8)(F, D) * (F ** -0.5)),
        }
    _B_in = _B_setup()

    return {
        "A_x": _A_in["x"],
        "A_w_r": _A_in["w_r"],
        "A_w_i": _A_in["w_i"],
        "B_x": _B_in["x"],
        "B_w_gate": _B_in["w_gate"],
        "B_w_up": _B_in["w_up"],
        "B_w_down": _B_in["w_down"],
    }

def reference(A_x, A_w_r, A_w_i, B_x, B_w_gate, B_w_up, B_w_down):
    def _A_ref(x, w_r, w_i):
        B, S, D = x.shape
        X = (lambda x, axes=(-2,-1): torch.fft.rfft2(x.float(), dim=axes))(x, axes=(-2, -1))
        W = w_r + 1j * w_i
        X = X * W
        y = (lambda x, s, axes=(-2,-1): torch.fft.irfft2(x, s=s, dim=axes).to(torch.bfloat16))(X, (S, D), axes=(-2, -1))
        return y

    def _B_ref(x, w_gate, w_up, w_down):
        g = torch.einsum("bsd,df->bsf", x, w_gate)
        u = torch.einsum("bsd,df->bsf", x, w_up)
        h = g * u
        return torch.einsum("bsf,fd->bsd", h, w_down)

    x = A_x
    xn = _layernorm(x, axis=-1)
    s = _A_ref(xn, A_w_r, A_w_i)
    g = _silu(_B_ref(xn, B_w_gate, B_w_up, B_w_down))
    return x + s * g
```

```asm
; @launch kernel=k1_kernel grid=(256,1,1) block=(512,1,1) lds=163840
.amdgcn_target "amdgcn-amd-amdhsa--gfx950"
.text
.globl k1_kernel
.p2align 8
.type k1_kernel,@function
k1_kernel:
    s_cmp_ge_u32 s2, 256
    s_cbranch_scc1 k2_end
    s_nop 0
    s_load_dwordx2 s[4:5], s[0:1], 0
    s_load_dwordx2 s[6:7], s[0:1], 72
    s_load_dwordx4 s[36:39], s[0:1], 8
    s_load_dwordx4 s[40:43], s[0:1], 32
    s_load_dwordx2 s[80:81], s[0:1], 64
    v_lshrrev_b32 v1, 6, v0
    v_and_b32_e64 v0, 63, v0
    v_readfirstlane_b32 s3, v1
    s_and_b32 s20, s2, 31
    s_lshr_b32 s21, s2, 5
    s_add_u32 s24, s21, 0
    s_and_b32 s24, s24, 7
    s_lshl_b32 s24, s24, 8
    s_add_u32 s25, s21, 1
    s_and_b32 s25, s25, 7
    s_lshl_b32 s25, s25, 8
    s_add_u32 s26, s21, 2
    s_and_b32 s26, s26, 7
    s_lshl_b32 s26, s26, 8
    s_add_u32 s27, s21, 3
    s_and_b32 s27, s27, 7
    s_lshl_b32 s27, s27, 8
    s_add_u32 s28, s21, 4
    s_and_b32 s28, s28, 7
    s_lshl_b32 s28, s28, 8
    s_add_u32 s29, s21, 5
    s_and_b32 s29, s29, 7
    s_lshl_b32 s29, s29, 8
    s_add_u32 s30, s21, 6
    s_and_b32 s30, s30, 7
    s_lshl_b32 s30, s30, 8
    s_add_u32 s31, s21, 7
    s_and_b32 s31, s31, 7
    s_lshl_b32 s31, s31, 8
    v_bfe_u32 v3, v0, 2, 2
    v_lshl_add_u32 v2, v1, 4, v3
    v_lshlrev_b32 v2, 16, v2
    s_lshl_b32 s22, s20, 11
    v_add_u32 v2, s22, v2
    v_lshrrev_b32 v161, 4, v0
    v_lshl_add_u32 v2, v161, 6, v2
    v_and_b32_e64 v160, 3, v0
    v_lshl_add_u32 v4, v160, 4, v2
    v_add_u32 v5, 0x40000, v4
    v_add_u32 v6, 0x80000, v4
    v_add_u32 v7, 0xc0000, v4
    v_lshlrev_b32 v173, 4, v0
    s_waitcnt lgkmcnt(0)
    s_mov_b32 s8, s4
    s_mov_b32 s9, s5
    s_mov_b32 s10, 4194304
    s_mov_b32 s11, 0x20000
    s_add_u32 s84, s6, 41943040
    s_addc_u32 s85, s7, 0
    s_nop 0
    s_mov_b32 s86, 8192
    s_mov_b32 s87, 0x20000
    s_cmp_lt_u32 s3, 4
    s_cbranch_scc1 k1_main
    s_cmp_lg_u32 s3, 4
    s_cbranch_scc1 k1_hb
    s_mov_b32 s12, s80
    s_mov_b32 s13, s81
    s_mov_b32 s14, 256
    s_mov_b32 s15, 0x20000
    s_cmp_lg_u32 s2, 0
    s_cbranch_scc1 k1_h1
    v_cmp_gt_u32_e64 vcc, 8, v0
    s_movk_i32 s16, 1024
    s_nop 0
    v_cndmask_b32 v4, 0, 1, vcc
    v_mov_b32_e64 v8, 0
    v_cndmask_b32 v5, 0, 1, vcc
    v_mov_b32_e64 v9, 0
    v_cndmask_b32 v6, 0, 1, vcc
    v_mov_b32_e64 v10, 0
    v_cndmask_b32 v7, 0, 1, vcc
    v_mov_b32_e64 v11, 0
    buffer_store_dwordx4 v[4:7], v173, s[84:87], 0 offen sc1
    buffer_store_dwordx4 v[8:11], v173, s[84:87], s16 offen offset:0 sc1
    buffer_store_dwordx4 v[8:11], v173, s[84:87], s16 offen offset:1024 sc1
    buffer_store_dwordx4 v[8:11], v173, s[84:87], s16 offen offset:2048 sc1
    buffer_store_dwordx4 v[8:11], v173, s[84:87], s16 offen offset:3072 sc1
    s_waitcnt vmcnt(0)
    s_mov_b64 exec, 1
    buffer_store_dword v4, off, s[12:15], 0 sc1
    s_mov_b64 exec, -1
k1_h1:
    s_mov_b32 s44, s36
    s_mov_b32 s45, s37
    s_nop 0
    s_mov_b32 s46, 2101248
    s_mov_b32 s47, 0x20000
    s_mov_b32 s48, s38
    s_mov_b32 s49, s39
    s_mov_b32 s50, 2101248
    s_mov_b32 s51, 0x20000
    s_mov_b32 s52, s40
    s_mov_b32 s53, s41
    s_mov_b32 s54, 1835008
    s_mov_b32 s55, 0x20000
    s_mov_b32 s56, s42
    s_mov_b32 s57, s43
    s_mov_b32 s58, 1835008
    s_mov_b32 s59, 0x20000
    s_lshl_b32 s36, s2, 12
    s_lshl_b32 s37, s2, 13
    buffer_load_dwordx4 v[208:211], v173, s[52:55], s36 offen offset:0
    buffer_load_dwordx4 v[208:211], v173, s[52:55], s36 offen offset:1024
    buffer_load_dwordx4 v[208:211], v173, s[52:55], s36 offen offset:2048
    buffer_load_dwordx4 v[208:211], v173, s[52:55], s36 offen offset:3072
    buffer_load_dwordx4 v[208:211], v173, s[56:59], s36 offen offset:0
    buffer_load_dwordx4 v[208:211], v173, s[56:59], s36 offen offset:1024
    buffer_load_dwordx4 v[208:211], v173, s[56:59], s36 offen offset:2048
    buffer_load_dwordx4 v[208:211], v173, s[56:59], s36 offen offset:3072
    s_add_u32 s36, s36, 0x100000
    buffer_load_dwordx4 v[208:211], v173, s[52:55], s36 offen offset:0
    buffer_load_dwordx4 v[208:211], v173, s[52:55], s36 offen offset:1024
    buffer_load_dwordx4 v[208:211], v173, s[52:55], s36 offen offset:2048
    buffer_load_dwordx4 v[208:211], v173, s[52:55], s36 offen offset:3072
    buffer_load_dwordx4 v[208:211], v173, s[56:59], s36 offen offset:0
    buffer_load_dwordx4 v[208:211], v173, s[56:59], s36 offen offset:1024
    buffer_load_dwordx4 v[208:211], v173, s[56:59], s36 offen offset:2048
    buffer_load_dwordx4 v[208:211], v173, s[56:59], s36 offen offset:3072
    s_add_u32 s36, s36, 0x100000
    s_nop 0
    s_barrier
    s_mov_b32 s16, 0x40000
    s_waitcnt vmcnt(0)
k1_go:
    s_nop 0
    buffer_load_dword v4, off, s[12:15], 0 sc1
    s_waitcnt vmcnt(0)
    v_cmp_ne_u32 vcc, 1, v4
    s_sub_u32 s16, s16, 1
    s_cbranch_scc1 k1_gx
    s_cbranch_vccnz k1_go
k1_gx:
    s_branch k1_join
k1_hb:
    s_barrier
    s_branch k1_join
k1_main:
    buffer_load_dwordx4 v[16:19], v4, s[8:11], s24 offen
    buffer_load_dwordx4 v[20:23], v5, s[8:11], s24 offen
    buffer_load_dwordx4 v[24:27], v6, s[8:11], s24 offen
    buffer_load_dwordx4 v[28:31], v7, s[8:11], s24 offen
    buffer_load_dwordx4 v[32:35], v4, s[8:11], s25 offen
    buffer_load_dwordx4 v[36:39], v5, s[8:11], s25 offen
    buffer_load_dwordx4 v[40:43], v6, s[8:11], s25 offen
    buffer_load_dwordx4 v[44:47], v7, s[8:11], s25 offen
    buffer_load_dwordx4 v[48:51], v4, s[8:11], s26 offen
    buffer_load_dwordx4 v[52:55], v5, s[8:11], s26 offen
    buffer_load_dwordx4 v[56:59], v6, s[8:11], s26 offen
    buffer_load_dwordx4 v[60:63], v7, s[8:11], s26 offen
    buffer_load_dwordx4 v[64:67], v4, s[8:11], s27 offen
    buffer_load_dwordx4 v[68:71], v5, s[8:11], s27 offen
    buffer_load_dwordx4 v[72:75], v6, s[8:11], s27 offen
    buffer_load_dwordx4 v[76:79], v7, s[8:11], s27 offen
    buffer_load_dwordx4 v[80:83], v4, s[8:11], s28 offen
    buffer_load_dwordx4 v[84:87], v5, s[8:11], s28 offen
    buffer_load_dwordx4 v[88:91], v6, s[8:11], s28 offen
    buffer_load_dwordx4 v[92:95], v7, s[8:11], s28 offen
    buffer_load_dwordx4 v[96:99], v4, s[8:11], s29 offen
    buffer_load_dwordx4 v[100:103], v5, s[8:11], s29 offen
    buffer_load_dwordx4 v[104:107], v6, s[8:11], s29 offen
    buffer_load_dwordx4 v[108:111], v7, s[8:11], s29 offen
    buffer_load_dwordx4 v[112:115], v4, s[8:11], s30 offen
    buffer_load_dwordx4 v[116:119], v5, s[8:11], s30 offen
    buffer_load_dwordx4 v[120:123], v6, s[8:11], s30 offen
    buffer_load_dwordx4 v[124:127], v7, s[8:11], s30 offen
    buffer_load_dwordx4 v[128:131], v4, s[8:11], s31 offen
    buffer_load_dwordx4 v[132:135], v5, s[8:11], s31 offen
    buffer_load_dwordx4 v[136:139], v6, s[8:11], s31 offen
    buffer_load_dwordx4 v[140:143], v7, s[8:11], s31 offen
    s_mov_b32 s12, s6
    s_mov_b32 s13, s7
    s_mov_b32 s14, 4194304
    s_mov_b32 s15, 0x20000
    s_add_u32 s16, s6, 4194304
    s_addc_u32 s17, s7, 0
    s_nop 0
    s_mov_b32 s18, 4194304
    s_mov_b32 s19, 0x20000
    s_mov_b32 s44, s36
    s_mov_b32 s45, s37
    s_mov_b32 s46, 2101248
    s_mov_b32 s47, 0x20000
    s_mov_b32 s48, s38
    s_mov_b32 s49, s39
    s_mov_b32 s50, 2101248
    s_mov_b32 s51, 0x20000
    s_mov_b32 s52, s40
    s_mov_b32 s53, s41
    s_mov_b32 s54, 0
    s_nop 0
    s_mov_b32 s55, 0x20000
    s_mov_b32 s56, s42
    s_mov_b32 s57, s43
    s_mov_b32 s58, 0
    s_nop 0
    s_mov_b32 s59, 0x20000
    s_lshl_b32 s36, s2, 2
    s_add_u32 s36, s36, s3
    s_lshl_b32 s37, s36, 11
    s_lshl_b32 s36, s36, 10
    v_mov_b32 v12, 0x3f803f80
    v_mov_b32 v13, 0x3f803f80
    v_mov_b32 v14, 0x3f803f80
    v_mov_b32 v15, 0x3f803f80
    s_and_b32 s23, s3, 1
    s_lshl_b32 s23, s23, 5
    v_and_b32 v174, 31, v0
    v_add_u32 v162, s23, v174
    v_lshrrev_b32 v163, 1, v162
    v_and_b32 v164, 1, v162
    v_cmp_eq_u32 vcc, 1, v162
    s_nop 1
    v_cndmask_b32 v163, v163, 32, vcc
    v_cndmask_b32 v164, v164, 0, vcc
    v_cvt_f32_u32 v163, v163
    v_cvt_f32_u32 v164, v164
    v_mul_f32 v163, 0x3c800000, v163
    v_mul_f32 v164, 0x3e800000, v164
    v_lshrrev_b32 v165, 5, v0
    v_lshlrev_b32 v166, 3, v165
    v_cvt_f32_u32_e64 v166, v166
    v_fma_f32 v164, v166, v163, v164
    v_fmamk_f32 v166, v163, 0x00000000, v164
    v_fmamk_f32 v167, v163, 0x3f800000, v164
    v_cos_f32 v166, v166
    v_cos_f32_e64 v167, v167
    s_nop 0
    v_cvt_pk_bf16_f32 v144, v166, v167
    v_fmamk_f32 v166, v163, 0x40000000, v164
    v_fmamk_f32 v167, v163, 0x40400000, v164
    v_cos_f32 v166, v166
    v_cos_f32_e64 v167, v167
    s_nop 0
    v_cvt_pk_bf16_f32 v145, v166, v167
    v_fmamk_f32 v166, v163, 0x40800000, v164
    v_fmamk_f32 v167, v163, 0x40a00000, v164
    v_cos_f32 v166, v166
    v_cos_f32_e64 v167, v167
    s_nop 0
    v_cvt_pk_bf16_f32 v146, v166, v167
    v_fmamk_f32 v166, v163, 0x40c00000, v164
    v_fmamk_f32 v167, v163, 0x40e00000, v164
    v_cos_f32 v166, v166
    v_cos_f32_e64 v167, v167
    s_nop 0
    v_cvt_pk_bf16_f32 v147, v166, v167
    v_fmamk_f32 v166, v163, 0x41800000, v164
    v_fmamk_f32 v167, v163, 0x41880000, v164
    v_cos_f32 v166, v166
    v_cos_f32_e64 v167, v167
    s_nop 0
    v_cvt_pk_bf16_f32 v148, v166, v167
    v_fmamk_f32 v166, v163, 0x41900000, v164
    v_fmamk_f32 v167, v163, 0x41980000, v164
    v_cos_f32 v166, v166
    v_cos_f32_e64 v167, v167
    s_nop 0
    v_cvt_pk_bf16_f32 v149, v166, v167
    v_fmamk_f32 v166, v163, 0x41a00000, v164
    v_fmamk_f32 v167, v163, 0x41a80000, v164
    v_cos_f32 v166, v166
    v_cos_f32_e64 v167, v167
    s_nop 0
    v_cvt_pk_bf16_f32 v150, v166, v167
    v_fmamk_f32 v166, v163, 0x41b00000, v164
    v_fmamk_f32 v167, v163, 0x41b80000, v164
    v_cos_f32 v166, v166
    v_cos_f32_e64 v167, v167
    s_nop 0
    v_cvt_pk_bf16_f32 v151, v166, v167
    v_fmamk_f32 v166, v163, 0x42000000, v164
    v_fmamk_f32 v167, v163, 0x42040000, v164
    v_cos_f32 v166, v166
    v_cos_f32_e64 v167, v167
    s_nop 0
    v_cvt_pk_bf16_f32 v152, v166, v167
    v_fmamk_f32 v166, v163, 0x42080000, v164
    v_fmamk_f32 v167, v163, 0x420c0000, v164
    v_cos_f32 v166, v166
    v_cos_f32_e64 v167, v167
    s_nop 0
    v_cvt_pk_bf16_f32 v153, v166, v167
    v_fmamk_f32 v166, v163, 0x42100000, v164
    v_fmamk_f32 v167, v163, 0x42140000, v164
    v_cos_f32 v166, v166
    v_cos_f32_e64 v167, v167
    s_nop 0
    v_cvt_pk_bf16_f32 v154, v166, v167
    v_fmamk_f32 v166, v163, 0x42180000, v164
    v_fmamk_f32 v167, v163, 0x421c0000, v164
    v_cos_f32 v166, v166
    v_cos_f32_e64 v167, v167
    s_nop 0
    v_cvt_pk_bf16_f32 v155, v166, v167
    v_fmamk_f32 v166, v163, 0x42400000, v164
    v_fmamk_f32 v167, v163, 0x42440000, v164
    v_cos_f32 v166, v166
    v_cos_f32_e64 v167, v167
    s_nop 0
    v_cvt_pk_bf16_f32 v156, v166, v167
    v_fmamk_f32 v166, v163, 0x42480000, v164
    v_fmamk_f32 v167, v163, 0x424c0000, v164
    v_cos_f32 v166, v166
    v_cos_f32_e64 v167, v167
    s_nop 0
    v_cvt_pk_bf16_f32 v157, v166, v167
    v_fmamk_f32 v166, v163, 0x42500000, v164
    v_fmamk_f32 v167, v163, 0x42540000, v164
    v_cos_f32 v166, v166
    v_cos_f32_e64 v167, v167
    s_nop 0
    v_cvt_pk_bf16_f32 v158, v166, v167
    v_fmamk_f32 v166, v163, 0x42580000, v164
    v_fmamk_f32 v167, v163, 0x425c0000, v164
    v_cos_f32 v166, v166
    v_cos_f32_e64 v167, v167
    s_nop 0
    v_cvt_pk_bf16_f32 v159, v166, v167
    s_lshl_b32 s34, s20, 17
    s_lshl_b32 s32, s21, 13
    s_add_u32 s34, s34, s32
    s_lshr_b32 s33, s3, 1
    s_lshl_b32 s32, s33, 16
    s_add_u32 s34, s34, s32
    s_lshl_b32 s32, s23, 5
    s_add_u32 s34, s34, s32
    s_add_u32 s35, s34, 4096
    s_lshl_b32 s32, s3, 12
    v_add_u32 v168, s32, v173
    v_lshlrev_b32_e64 v169, 10, v3
    v_lshl_add_u32 v169, v160, 6, v169
    v_lshl_add_u32 v169, v161, 4, v169
    v_add_u32_e64 v169, s32, v169
    v_mul_u32_u24 v172, 80, v3
    s_mul_i32 s32, s3, 4608
    s_add_u32 s32, s32, 16384
    v_mul_u32_u24 v175, 144, v174
    v_lshl_add_u32 v175, v165, 3, v175
    v_add_u32 v175, s32, v175
    v_lshrrev_b32 v166, 3, v0
    v_and_b32_e64 v167, 7, v0
    v_mul_u32_u24 v162, 144, v166
    v_lshl_add_u32 v162, v167, 4, v162
    v_add_u32 v162, s32, v162
    v_lshlrev_b32 v171, 16, v166
    v_lshl_add_u32 v171, v167, 4, v171
    s_lshl_b32 s22, s20, 11
    s_lshl_b32 s32, s21, 8
    s_add_u32 s22, s22, s32
    s_lshl_b32 s32, s33, 7
    s_add_u32 s22, s22, s32
    s_lshl_b32 s32, s23, 16
    s_add_u32 s22, s22, s32
    s_nop 0
    v_cmp_eq_u32 s[24:25], 1, v160
    v_cmp_eq_u32 s[26:27], 2, v160
    v_cmp_eq_u32 s[28:29], 3, v160
    v_lshrrev_b32_e64 v170, 5, v0
    v_mul_u32_u24 v170, 2048, v170
    v_bfe_u32 v166, v0, 2, 2
    v_lshl_add_u32 v170, v166, 6, v170
    v_bfe_u32 v166, v0, 4, 1
    v_lshl_add_u32 v170, v166, 5, v170
    v_and_b32_e64 v166, 3, v0
    v_lshl_add_u32 v170, v166, 3, v170
    s_lshl_b32 s32, s33, 9
    v_add_u32_e64 v170, s32, v170
    s_waitcnt vmcnt(31)
    v_mfma_f32_16x16x32_bf16 v[176:179], v[12:15], v[16:19], 0
    v_mfma_f32_16x16x32_bf16 v[192:195], v[16:19], v[16:19], 0
    s_nop 0
    s_waitcnt vmcnt(30)
    v_mfma_f32_16x16x32_bf16 v[180:183], v[12:15], v[20:23], 0
    v_mfma_f32_16x16x32_bf16 v[196:199], v[20:23], v[20:23], 0
    s_nop 0
    s_waitcnt vmcnt(29)
    v_mfma_f32_16x16x32_bf16 v[184:187], v[12:15], v[24:27], 0
    v_mfma_f32_16x16x32_bf16 v[200:203], v[24:27], v[24:27], 0
    s_nop 0
    s_waitcnt vmcnt(28)
    v_mfma_f32_16x16x32_bf16 v[188:191], v[12:15], v[28:31], 0
    v_mfma_f32_16x16x32_bf16 v[204:207], v[28:31], v[28:31], 0
    s_nop 0
    s_waitcnt vmcnt(27)
    v_mfma_f32_16x16x32_bf16 v[176:179], v[12:15], v[32:35], v[176:179]
    v_mfma_f32_16x16x32_bf16 v[192:195], v[32:35], v[32:35], v[192:195]
    s_nop 0
    s_waitcnt vmcnt(26)
    v_mfma_f32_16x16x32_bf16 v[180:183], v[12:15], v[36:39], v[180:183]
    v_mfma_f32_16x16x32_bf16 v[196:199], v[36:39], v[36:39], v[196:199]
    s_nop 0
    s_waitcnt vmcnt(25)
    v_mfma_f32_16x16x32_bf16 v[184:187], v[12:15], v[40:43], v[184:187]
    v_mfma_f32_16x16x32_bf16 v[200:203], v[40:43], v[40:43], v[200:203]
    s_nop 0
    s_waitcnt vmcnt(24)
    v_mfma_f32_16x16x32_bf16 v[188:191], v[12:15], v[44:47], v[188:191]
    v_mfma_f32_16x16x32_bf16 v[204:207], v[44:47], v[44:47], v[204:207]
    s_nop 0
    s_waitcnt vmcnt(23)
    v_mfma_f32_16x16x32_bf16 v[176:179], v[12:15], v[48:51], v[176:179]
    v_mfma_f32_16x16x32_bf16 v[192:195], v[48:51], v[48:51], v[192:195]
    s_nop 0
    s_waitcnt vmcnt(22)
    v_mfma_f32_16x16x32_bf16 v[180:183], v[12:15], v[52:55], v[180:183]
    v_mfma_f32_16x16x32_bf16 v[196:199], v[52:55], v[52:55], v[196:199]
    s_nop 0
    s_waitcnt vmcnt(21)
    v_mfma_f32_16x16x32_bf16 v[184:187], v[12:15], v[56:59], v[184:187]
    v_mfma_f32_16x16x32_bf16 v[200:203], v[56:59], v[56:59], v[200:203]
    s_nop 0
    s_waitcnt vmcnt(20)
    v_mfma_f32_16x16x32_bf16 v[188:191], v[12:15], v[60:63], v[188:191]
    v_mfma_f32_16x16x32_bf16 v[204:207], v[60:63], v[60:63], v[204:207]
    s_nop 0
    s_waitcnt vmcnt(19)
    v_mfma_f32_16x16x32_bf16 v[176:179], v[12:15], v[64:67], v[176:179]
    v_mfma_f32_16x16x32_bf16 v[192:195], v[64:67], v[64:67], v[192:195]
    s_nop 0
    s_waitcnt vmcnt(18)
    v_mfma_f32_16x16x32_bf16 v[180:183], v[12:15], v[68:71], v[180:183]
    v_mfma_f32_16x16x32_bf16 v[196:199], v[68:71], v[68:71], v[196:199]
    s_nop 0
    s_waitcnt vmcnt(17)
    v_mfma_f32_16x16x32_bf16 v[184:187], v[12:15], v[72:75], v[184:187]
    v_mfma_f32_16x16x32_bf16 v[200:203], v[72:75], v[72:75], v[200:203]
    s_nop 0
    s_waitcnt vmcnt(16)
    v_mfma_f32_16x16x32_bf16 v[188:191], v[12:15], v[76:79], v[188:191]
    v_mfma_f32_16x16x32_bf16 v[204:207], v[76:79], v[76:79], v[204:207]
    s_nop 0
    s_waitcnt vmcnt(15)
    v_mfma_f32_16x16x32_bf16 v[176:179], v[12:15], v[80:83], v[176:179]
    v_mfma_f32_16x16x32_bf16 v[192:195], v[80:83], v[80:83], v[192:195]
    s_nop 0
    s_waitcnt vmcnt(14)
    v_mfma_f32_16x16x32_bf16 v[180:183], v[12:15], v[84:87], v[180:183]
    v_mfma_f32_16x16x32_bf16 v[196:199], v[84:87], v[84:87], v[196:199]
    s_nop 0
    s_waitcnt vmcnt(13)
    v_mfma_f32_16x16x32_bf16 v[184:187], v[12:15], v[88:91], v[184:187]
    v_mfma_f32_16x16x32_bf16 v[200:203], v[88:91], v[88:91], v[200:203]
    s_nop 0
    s_waitcnt vmcnt(12)
    v_mfma_f32_16x16x32_bf16 v[188:191], v[12:15], v[92:95], v[188:191]
    v_mfma_f32_16x16x32_bf16 v[204:207], v[92:95], v[92:95], v[204:207]
    s_nop 0
    s_waitcnt vmcnt(11)
    v_mfma_f32_16x16x32_bf16 v[176:179], v[12:15], v[96:99], v[176:179]
    v_mfma_f32_16x16x32_bf16 v[192:195], v[96:99], v[96:99], v[192:195]
    s_nop 0
    s_waitcnt vmcnt(10)
    v_mfma_f32_16x16x32_bf16 v[180:183], v[12:15], v[100:103], v[180:183]
    v_mfma_f32_16x16x32_bf16 v[196:199], v[100:103], v[100:103], v[196:199]
    s_nop 0
    s_waitcnt vmcnt(9)
    v_mfma_f32_16x16x32_bf16 v[184:187], v[12:15], v[104:107], v[184:187]
    v_mfma_f32_16x16x32_bf16 v[200:203], v[104:107], v[104:107], v[200:203]
    s_nop 0
    s_waitcnt vmcnt(8)
    v_mfma_f32_16x16x32_bf16 v[188:191], v[12:15], v[108:111], v[188:191]
    v_mfma_f32_16x16x32_bf16 v[204:207], v[108:111], v[108:111], v[204:207]
    s_nop 0
    s_waitcnt vmcnt(7)
    v_mfma_f32_16x16x32_bf16 v[176:179], v[12:15], v[112:115], v[176:179]
    v_mfma_f32_16x16x32_bf16 v[192:195], v[112:115], v[112:115], v[192:195]
    s_nop 0
    s_waitcnt vmcnt(6)
    v_mfma_f32_16x16x32_bf16 v[180:183], v[12:15], v[116:119], v[180:183]
    v_mfma_f32_16x16x32_bf16 v[196:199], v[116:119], v[116:119], v[196:199]
    s_nop 0
    s_waitcnt vmcnt(5)
    v_mfma_f32_16x16x32_bf16 v[184:187], v[12:15], v[120:123], v[184:187]
    v_mfma_f32_16x16x32_bf16 v[200:203], v[120:123], v[120:123], v[200:203]
    s_nop 0
    s_waitcnt vmcnt(4)
    v_mfma_f32_16x16x32_bf16 v[188:191], v[12:15], v[124:127], v[188:191]
    v_mfma_f32_16x16x32_bf16 v[204:207], v[124:127], v[124:127], v[204:207]
    s_nop 0
    s_waitcnt vmcnt(3)
    v_mfma_f32_16x16x32_bf16 v[176:179], v[12:15], v[128:131], v[176:179]
    v_mfma_f32_16x16x32_bf16 v[192:195], v[128:131], v[128:131], v[192:195]
    s_nop 0
    s_waitcnt vmcnt(2)
    v_mfma_f32_16x16x32_bf16 v[180:183], v[12:15], v[132:135], v[180:183]
    v_mfma_f32_16x16x32_bf16 v[196:199], v[132:135], v[132:135], v[196:199]
    s_nop 0
    s_waitcnt vmcnt(1)
    v_mfma_f32_16x16x32_bf16 v[184:187], v[12:15], v[136:139], v[184:187]
    v_mfma_f32_16x16x32_bf16 v[200:203], v[136:139], v[136:139], v[200:203]
    s_nop 0
    s_waitcnt vmcnt(0)
    v_mfma_f32_16x16x32_bf16 v[188:191], v[12:15], v[140:143], v[188:191]
    v_mfma_f32_16x16x32_bf16 v[204:207], v[140:143], v[140:143], v[204:207]
    v_cndmask_b32 v192, v192, v193, s[24:25]
    s_nop 0
    s_nop 0
    v_cndmask_b32 v196, v196, v197, s[24:25]
    s_nop 1
    s_nop 0
    v_cndmask_b32 v200, v200, v201, s[24:25]
    s_nop 1
    s_nop 0
    v_cndmask_b32 v204, v204, v205, s[24:25]
    v_cndmask_b32 v192, v192, v194, s[26:27]
    v_cndmask_b32 v196, v196, v198, s[26:27]
    v_cndmask_b32 v200, v200, v202, s[26:27]
    v_cndmask_b32 v204, v204, v206, s[26:27]
    v_cndmask_b32 v192, v192, v195, s[28:29]
    v_cndmask_b32 v196, v196, v199, s[28:29]
    v_cndmask_b32 v200, v200, v203, s[28:29]
    v_cndmask_b32 v204, v204, v207, s[28:29]
    v_add_f32_dpp v192, v192, v192 quad_perm:[1,0,3,2] row_mask:0xf bank_mask:0xf
    v_add_f32_dpp v196, v196, v196 quad_perm:[1,0,3,2] row_mask:0xf bank_mask:0xf
    v_add_f32_dpp v200, v200, v200 quad_perm:[1,0,3,2] row_mask:0xf bank_mask:0xf
    v_add_f32_dpp v204, v204, v204 quad_perm:[1,0,3,2] row_mask:0xf bank_mask:0xf
    v_add_f32_dpp v192, v192, v192 quad_perm:[2,3,0,1] row_mask:0xf bank_mask:0xf
    v_add_f32_dpp v196, v196, v196 quad_perm:[2,3,0,1] row_mask:0xf bank_mask:0xf
    v_add_f32_dpp v200, v200, v200 quad_perm:[2,3,0,1] row_mask:0xf bank_mask:0xf
    v_add_f32_dpp v204, v204, v204 quad_perm:[2,3,0,1] row_mask:0xf bank_mask:0xf
    ds_bpermute_b32 v192, v172, v192
    ds_bpermute_b32 v196, v172, v196
    ds_bpermute_b32 v200, v172, v200
    ds_bpermute_b32 v204, v172, v204
    v_add_f32_dpp v176, v176, v176 quad_perm:[1,0,3,2] row_mask:0xf bank_mask:0xf
    v_add_f32_dpp v180, v180, v180 quad_perm:[1,0,3,2] row_mask:0xf bank_mask:0xf
    v_add_f32_dpp v184, v184, v184 quad_perm:[1,0,3,2] row_mask:0xf bank_mask:0xf
    v_add_f32_dpp v188, v188, v188 quad_perm:[1,0,3,2] row_mask:0xf bank_mask:0xf
    v_add_f32_dpp v176, v176, v176 quad_perm:[2,3,0,1] row_mask:0xf bank_mask:0xf
    v_add_f32_dpp v180, v180, v180 quad_perm:[2,3,0,1] row_mask:0xf bank_mask:0xf
    v_add_f32_dpp v184, v184, v184 quad_perm:[2,3,0,1] row_mask:0xf bank_mask:0xf
    v_add_f32_dpp v188, v188, v188 quad_perm:[2,3,0,1] row_mask:0xf bank_mask:0xf
    v_mul_f32 v176, 0x3a800000, v176
    v_mul_f32 v180, 0x3a800000, v180
    v_mul_f32 v184, 0x3a800000, v184
    v_mul_f32 v188, 0x3a800000, v188
    v_mul_f32 v177, v176, v176
    v_mul_f32 v181, v180, v180
    v_mul_f32 v185, v184, v184
    v_mul_f32 v189, v188, v188
    v_cvt_pk_bf16_f32 v176, v176, v176
    v_cvt_pk_bf16_f32 v180, v180, v180
    v_cvt_pk_bf16_f32 v184, v184, v184
    v_cvt_pk_bf16_f32 v188, v188, v188
    v_and_b32 v176, 0xffff0000, v176
    v_and_b32 v180, 0xffff0000, v180
    v_and_b32 v184, 0xffff0000, v184
    v_and_b32 v188, 0xffff0000, v188
    s_nop 0
    s_waitcnt lgkmcnt(0)
    v_mul_f32 v192, 0x3a800000, v192
    v_mul_f32 v196, 0x3a800000, v196
    v_mul_f32 v200, 0x3a800000, v200
    v_mul_f32 v204, 0x3a800000, v204
    v_sub_f32 v192, v192, v177
    v_sub_f32 v196, v196, v181
    v_sub_f32 v200, v200, v185
    v_sub_f32 v204, v204, v189
    v_max_f32 v192, 0, v192
    v_max_f32 v196, 0, v196
    v_max_f32 v200, 0, v200
    v_max_f32 v204, 0, v204
    v_cvt_pk_bf16_f32 v192, v192, v192
    v_cvt_pk_bf16_f32 v196, v196, v196
    v_cvt_pk_bf16_f32 v200, v200, v200
    v_cvt_pk_bf16_f32 v204, v204, v204
    v_and_b32 v192, 0xffff0000, v192
    v_and_b32 v196, 0xffff0000, v196
    v_and_b32 v200, 0xffff0000, v200
    v_and_b32 v204, 0xffff0000, v204
    v_add_f32 v192, 0x3727c5ac, v192
    v_add_f32 v196, 0x3727c5ac, v196
    v_add_f32 v200, 0x3727c5ac, v200
    v_add_f32 v204, 0x3727c5ac, v204
    v_cvt_pk_bf16_f32 v192, v192, v192
    v_cvt_pk_bf16_f32 v196, v196, v196
    v_cvt_pk_bf16_f32 v200, v200, v200
    v_cvt_pk_bf16_f32 v204, v204, v204
    v_and_b32 v192, 0xffff0000, v192
    v_and_b32 v196, 0xffff0000, v196
    v_and_b32 v200, 0xffff0000, v200
    v_and_b32 v204, 0xffff0000, v204
    v_sqrt_f32 v192, v192
    v_sqrt_f32 v196, v196
    v_sqrt_f32 v200, v200
    v_sqrt_f32 v204, v204
    v_cvt_pk_bf16_f32 v192, v192, v192
    v_cvt_pk_bf16_f32 v196, v196, v196
    v_cvt_pk_bf16_f32 v200, v200, v200
    v_cvt_pk_bf16_f32 v204, v204, v204
    v_and_b32 v192, 0xffff0000, v192
    v_and_b32 v196, 0xffff0000, v196
    v_and_b32 v200, 0xffff0000, v200
    v_and_b32 v204, 0xffff0000, v204
    v_rcp_f32 v192, v192
    v_rcp_f32 v196, v196
    v_rcp_f32 v200, v200
    v_rcp_f32 v204, v204
    v_lshlrev_b32_e64 v5, 16, v16
    v_and_b32 v6, 0xffff0000, v16
    v_sub_f32 v5, v5, v176
    v_sub_f32 v6, v6, v176
    v_cvt_pk_bf16_f32 v7, v5, v6
    v_lshlrev_b32_e64 v5, 16, v7
    v_and_b32 v6, 0xffff0000, v7
    v_mul_f32 v5, v5, v192
    v_mul_f32 v6, v6, v192
    v_cvt_pk_bf16_f32 v16, v5, v6
    v_lshlrev_b32_e64 v5, 16, v17
    v_and_b32 v6, 0xffff0000, v17
    v_sub_f32 v5, v5, v176
    v_sub_f32 v6, v6, v176
    v_cvt_pk_bf16_f32 v7, v5, v6
    v_lshlrev_b32_e64 v5, 16, v7
    v_and_b32 v6, 0xffff0000, v7
    v_mul_f32 v5, v5, v192
    v_mul_f32 v6, v6, v192
    v_cvt_pk_bf16_f32 v17, v5, v6
    v_lshlrev_b32_e64 v5, 16, v18
    v_and_b32 v6, 0xffff0000, v18
    v_sub_f32 v5, v5, v176
    v_sub_f32 v6, v6, v176
    v_cvt_pk_bf16_f32 v7, v5, v6
    v_lshlrev_b32_e64 v5, 16, v7
    v_and_b32 v6, 0xffff0000, v7
    v_mul_f32 v5, v5, v192
    v_mul_f32 v6, v6, v192
    v_cvt_pk_bf16_f32 v18, v5, v6
    v_lshlrev_b32_e64 v5, 16, v19
    v_and_b32 v6, 0xffff0000, v19
    v_sub_f32 v5, v5, v176
    v_sub_f32 v6, v6, v176
    v_cvt_pk_bf16_f32 v7, v5, v6
    v_lshlrev_b32_e64 v5, 16, v7
    v_and_b32 v6, 0xffff0000, v7
    v_mul_f32 v5, v5, v192
    v_mul_f32 v6, v6, v192
    v_cvt_pk_bf16_f32 v19, v5, v6
    ds_write_b128 v168, v[16:19] offset:0
    v_lshlrev_b32_e64 v5, 16, v20
    v_and_b32 v6, 0xffff0000, v20
    v_sub_f32 v5, v5, v180
    v_sub_f32 v6, v6, v180
    v_cvt_pk_bf16_f32 v7, v5, v6
    v_lshlrev_b32_e64 v5, 16, v7
    v_and_b32 v6, 0xffff0000, v7
    v_mul_f32 v5, v5, v196
    v_mul_f32 v6, v6, v196
    v_cvt_pk_bf16_f32 v20, v5, v6
    v_lshlrev_b32_e64 v5, 16, v21
    v_and_b32 v6, 0xffff0000, v21
    v_sub_f32 v5, v5, v180
    v_sub_f32 v6, v6, v180
    v_cvt_pk_bf16_f32 v7, v5, v6
    v_lshlrev_b32_e64 v5, 16, v7
    v_and_b32 v6, 0xffff0000, v7
    v_mul_f32 v5, v5, v196
    v_mul_f32 v6, v6, v196
    v_cvt_pk_bf16_f32 v21, v5, v6
    v_lshlrev_b32_e64 v5, 16, v22
    v_and_b32 v6, 0xffff0000, v22
    v_sub_f32 v5, v5, v180
    v_sub_f32 v6, v6, v180
    v_cvt_pk_bf16_f32 v7, v5, v6
    v_lshlrev_b32_e64 v5, 16, v7
    v_and_b32 v6, 0xffff0000, v7
    v_mul_f32 v5, v5, v196
    v_mul_f32 v6, v6, v196
    v_cvt_pk_bf16_f32 v22, v5, v6
    v_lshlrev_b32_e64 v5, 16, v23
    v_and_b32 v6, 0xffff0000, v23
    v_sub_f32 v5, v5, v180
    v_sub_f32 v6, v6, v180
    v_cvt_pk_bf16_f32 v7, v5, v6
    v_lshlrev_b32_e64 v5, 16, v7
    v_and_b32 v6, 0xffff0000, v7
    v_mul_f32 v5, v5, v196
    v_mul_f32 v6, v6, v196
    v_cvt_pk_bf16_f32 v23, v5, v6
    ds_write_b128 v168, v[20:23] offset:1024
    v_lshlrev_b32_e64 v5, 16, v24
    v_and_b32 v6, 0xffff0000, v24
    v_sub_f32 v5, v5, v184
    v_sub_f32 v6, v6, v184
    v_cvt_pk_bf16_f32 v7, v5, v6
    v_lshlrev_b32_e64 v5, 16, v7
    v_and_b32 v6, 0xffff0000, v7
    v_mul_f32 v5, v5, v200
    v_mul_f32 v6, v6, v200
    v_cvt_pk_bf16_f32 v24, v5, v6
    v_lshlrev_b32_e64 v5, 16, v25
    v_and_b32 v6, 0xffff0000, v25
    v_sub_f32 v5, v5, v184
    v_sub_f32 v6, v6, v184
    v_cvt_pk_bf16_f32 v7, v5, v6
    v_lshlrev_b32_e64 v5, 16, v7
    v_and_b32 v6, 0xffff0000, v7
    v_mul_f32 v5, v5, v200
    v_mul_f32 v6, v6, v200
    v_cvt_pk_bf16_f32 v25, v5, v6
    v_lshlrev_b32_e64 v5, 16, v26
    v_and_b32 v6, 0xffff0000, v26
    v_sub_f32 v5, v5, v184
    v_sub_f32 v6, v6, v184
    v_cvt_pk_bf16_f32 v7, v5, v6
    v_lshlrev_b32_e64 v5, 16, v7
    v_and_b32 v6, 0xffff0000, v7
    v_mul_f32 v5, v5, v200
    v_mul_f32 v6, v6, v200
    v_cvt_pk_bf16_f32 v26, v5, v6
    v_lshlrev_b32_e64 v5, 16, v27
    v_and_b32 v6, 0xffff0000, v27
    v_sub_f32 v5, v5, v184
    v_sub_f32 v6, v6, v184
    v_cvt_pk_bf16_f32 v7, v5, v6
    v_lshlrev_b32_e64 v5, 16, v7
    v_and_b32 v6, 0xffff0000, v7
    v_mul_f32 v5, v5, v200
    v_mul_f32 v6, v6, v200
    v_cvt_pk_bf16_f32 v27, v5, v6
    ds_write_b128 v168, v[24:27] offset:2048
    v_lshlrev_b32_e64 v5, 16, v28
    v_and_b32 v6, 0xffff0000, v28
    v_sub_f32 v5, v5, v188
    v_sub_f32 v6, v6, v188
    v_cvt_pk_bf16_f32 v7, v5, v6
    v_lshlrev_b32_e64 v5, 16, v7
    v_and_b32 v6, 0xffff0000, v7
    v_mul_f32 v5, v5, v204
    v_mul_f32 v6, v6, v204
    v_cvt_pk_bf16_f32 v28, v5, v6
    v_lshlrev_b32_e64 v5, 16, v29
    v_and_b32 v6, 0xffff0000, v29
    v_sub_f32 v5, v5, v188
    v_sub_f32 v6, v6, v188
    v_cvt_pk_bf16_f32 v7, v5, v6
    v_lshlrev_b32_e64 v5, 16, v7
    v_and_b32 v6, 0xffff0000, v7
    v_mul_f32 v5, v5, v204
    v_mul_f32 v6, v6, v204
    v_cvt_pk_bf16_f32 v29, v5, v6
    v_lshlrev_b32_e64 v5, 16, v30
    v_and_b32 v6, 0xffff0000, v30
    v_sub_f32 v5, v5, v188
    v_sub_f32 v6, v6, v188
    v_cvt_pk_bf16_f32 v7, v5, v6
    v_lshlrev_b32_e64 v5, 16, v7
    v_and_b32 v6, 0xffff0000, v7
    v_mul_f32 v5, v5, v204
    v_mul_f32 v6, v6, v204
    v_cvt_pk_bf16_f32 v30, v5, v6
    v_lshlrev_b32_e64 v5, 16, v31
    v_and_b32 v6, 0xffff0000, v31
    v_sub_f32 v5, v5, v188
    v_sub_f32 v6, v6, v188
    v_cvt_pk_bf16_f32 v7, v5, v6
    v_lshlrev_b32_e64 v5, 16, v7
    v_and_b32 v6, 0xffff0000, v7
    v_mul_f32 v5, v5, v204
    v_mul_f32 v6, v6, v204
    v_cvt_pk_bf16_f32 v31, v5, v6
    ds_write_b128 v168, v[28:31] offset:3072
    ds_read_b128 v[112:115], v169 offset:0
    ds_read_b128 v[116:119], v169 offset:256
    ds_read_b128 v[120:123], v169 offset:512
    ds_read_b128 v[124:127], v169 offset:768
    s_waitcnt lgkmcnt(0)
    s_barrier
    ds_read_b64_tr_b16 v[32:33], v170 offset:0
    ds_read_b64_tr_b16 v[34:35], v170 offset:1024
    ds_read_b64_tr_b16 v[36:37], v170 offset:4096
    ds_read_b64_tr_b16 v[38:39], v170 offset:5120
    ds_read_b64_tr_b16 v[40:41], v170 offset:8192
    ds_read_b64_tr_b16 v[42:43], v170 offset:9216
    ds_read_b64_tr_b16 v[44:45], v170 offset:12288
    ds_read_b64_tr_b16 v[46:47], v170 offset:13312
    ds_read_b64_tr_b16 v[48:49], v170 offset:256
    ds_read_b64_tr_b16 v[50:51], v170 offset:1280
    ds_read_b64_tr_b16 v[52:53], v170 offset:4352
    ds_read_b64_tr_b16 v[54:55], v170 offset:5376
    ds_read_b64_tr_b16 v[56:57], v170 offset:8448
    ds_read_b64_tr_b16 v[58:59], v170 offset:9472
    ds_read_b64_tr_b16 v[60:61], v170 offset:12544
    ds_read_b64_tr_b16 v[62:63], v170 offset:13568
    buffer_store_dwordx4 v[112:115], v173, s[12:15], s34 offen offset:0 sc1
    buffer_store_dwordx4 v[116:119], v173, s[12:15], s34 offen offset:2048 sc1
    buffer_store_dwordx4 v[120:123], v173, s[12:15], s35 offen offset:0 sc1
    buffer_store_dwordx4 v[124:127], v173, s[12:15], s35 offen offset:2048 sc1
    s_nop 0
    s_waitcnt lgkmcnt(8)
    v_mfma_f32_32x32x16_bf16 v[64:79], v[32:35], v[144:147], 0
    v_mfma_f32_32x32x16_bf16 v[64:79], v[36:39], v[148:151], v[64:79]
    v_mfma_f32_32x32x16_bf16 v[64:79], v[40:43], v[152:155], v[64:79]
    v_mfma_f32_32x32x16_bf16 v[64:79], v[44:47], v[156:159], v[64:79]
    s_nop 0
    s_waitcnt lgkmcnt(0)
    v_mfma_f32_32x32x16_bf16 v[80:95], v[48:51], v[144:147], 0
    v_mfma_f32_32x32x16_bf16 v[80:95], v[52:55], v[148:151], v[80:95]
    v_mfma_f32_32x32x16_bf16 v[80:95], v[56:59], v[152:155], v[80:95]
    v_mfma_f32_32x32x16_bf16 v[80:95], v[60:63], v[156:159], v[80:95]
    s_nop 6
    s_nop 0
    v_cvt_pk_bf16_f32 v96, v64, v65
    v_cvt_pk_bf16_f32 v97, v66, v67
    ds_write_b64 v175, v[96:97] offset:0
    v_cvt_pk_bf16_f32 v98, v68, v69
    v_cvt_pk_bf16_f32 v99, v70, v71
    ds_write_b64 v175, v[98:99] offset:16
    v_cvt_pk_bf16_f32 v100, v72, v73
    v_cvt_pk_bf16_f32 v101, v74, v75
    ds_write_b64 v175, v[100:101] offset:32
    v_cvt_pk_bf16_f32 v102, v76, v77
    v_cvt_pk_bf16_f32 v103, v78, v79
    ds_write_b64 v175, v[102:103] offset:48
    v_cvt_pk_bf16_f32 v104, v80, v81
    v_cvt_pk_bf16_f32 v105, v82, v83
    ds_write_b64 v175, v[104:105] offset:64
    v_cvt_pk_bf16_f32 v106, v84, v85
    v_cvt_pk_bf16_f32 v107, v86, v87
    ds_write_b64 v175, v[106:107] offset:80
    v_cvt_pk_bf16_f32 v108, v88, v89
    v_cvt_pk_bf16_f32 v109, v90, v91
    ds_write_b64 v175, v[108:109] offset:96
    v_cvt_pk_bf16_f32 v110, v92, v93
    v_cvt_pk_bf16_f32 v111, v94, v95
    ds_write_b64 v175, v[110:111] offset:112
    ds_read_b128 v[16:19], v162 offset:0
    ds_read_b128 v[20:23], v162 offset:1152
    ds_read_b128 v[24:27], v162 offset:2304
    ds_read_b128 v[28:31], v162 offset:3456
    s_nop 0
    s_waitcnt lgkmcnt(3)
    buffer_store_dwordx4 v[16:19], v171, s[16:19], s22 offen sc1
    s_add_u32 s22, s22, 0x80000
    s_nop 0
    s_waitcnt lgkmcnt(2)
    buffer_store_dwordx4 v[20:23], v171, s[16:19], s22 offen sc1
    s_add_u32 s22, s22, 0x80000
    s_nop 0
    s_waitcnt lgkmcnt(1)
    buffer_store_dwordx4 v[24:27], v171, s[16:19], s22 offen sc1
    s_add_u32 s22, s22, 0x80000
    s_nop 0
    s_waitcnt lgkmcnt(0)
    buffer_store_dwordx4 v[28:31], v171, s[16:19], s22 offen sc1
    s_add_u32 s22, s22, 0x80000
    s_lshl_b32 s57, s20, 3
    s_add_u32 s57, s57, s21
    s_lshl_b32 s57, s57, 2
    s_nop 0
    s_add_u32 s57, s57, 4096
    s_waitcnt vmcnt(0)
k1_join:
    s_barrier
    s_cmp_lg_u32 s3, 0
    s_cbranch_scc1 k1_fc
    s_lshl_b32 s59, s2, 2
    v_mov_b32_e64 v245, 1
    s_mov_b64 exec, 1
    buffer_store_dword v245, off, s[84:87], s57 offset:0 sc1
    s_mov_b64 exec, -1
k1_fc:
    s_nop 0
    s_load_dwordx4 s[36:39], s[0:1], 32
    s_load_dwordx4 s[40:43], s[0:1], 8
    s_load_dwordx2 s[48:49], s[0:1], 48
    s_load_dwordx2 s[6:7], s[0:1], 72
    s_cmp_lt_u32 s2, 32
    s_cbranch_scc1 k2_fft
    s_lshr_b32 s30, s2, 3
    s_sub_u32 s30, s30, 4
    s_and_b32 s28, s2, 1
    s_lshl_b32 s28, s28, 2
    s_and_b32 s31, s30, 3
    s_add_u32 s28, s28, s31
    s_bfe_u32 s29, s2, 0x20001
    s_mul_i32 s29, s29, 7
    s_lshr_b32 s31, s30, 2
    s_add_u32 s29, s29, s31
    v_lshlrev_b32 v2, 4, v0
    v_bfe_u32 v4, v0, 2, 2
    v_mul_u32_u24 v3, 7168, v4
    v_lshrrev_b32_e64 v4, 4, v0
    v_lshl_add_u32 v3, v4, 6, v3
    v_and_b32 v4, 3, v0
    s_and_b32 s32, s3, 2
    v_xor_b32_e64 v4, s32, v4
    v_lshl_add_u32 v3, v4, 4, v3
    s_lshl_b32 s32, s28, 3
    s_add_u32 s32, s32, s3
    s_lshl_b32 s32, s32, 16
    s_nop 0
    s_mul_i32 s33, s3, 4*7168
    s_lshl_b32 s34, s29, 8
    s_add_u32 s33, s33, s34
    s_lshl_b32 s34, s3, 11
    s_lshl_b32 s35, s3, 10
    s_sub_u32 s34, s34, 0x400
    s_waitcnt lgkmcnt(0)
    s_mov_b32 s8, s6
    s_mov_b32 s9, s7
    s_nop 0
    s_mov_b32 s10, 4194304
    s_mov_b32 s11, 0x20000
    s_mov_b32 s12, s36
    s_mov_b32 s13, s37
    s_mov_b32 s14, 7340032
    s_mov_b32 s15, 0x20000
    s_mov_b32 s16, s38
    s_mov_b32 s17, s39
    s_mov_b32 s18, 7340032
    s_mov_b32 s19, 0x20000
    s_add_u32 s20, s6, 8388608
    s_addc_u32 s21, s7, 0
    s_nop 0
    s_mov_b32 s22, 14680064
    s_mov_b32 s23, 0x20000
    s_add_u32 m0, s35, 16384
    s_nop 0
    s_nop 0
    buffer_load_dwordx4 v3, s[12:15], s33 offen lds
    s_add_u32 m0, s35, 24576
    s_nop 0
    s_nop 0
    buffer_load_dwordx4 v3, s[16:19], s33 offen lds
    s_add_u32 s33, s33, 32*7168
    s_add_u32 m0, s35, 49152
    s_nop 0
    s_nop 0
    buffer_load_dwordx4 v3, s[12:15], s33 offen lds
    s_add_u32 m0, s35, 57344
    s_nop 0
    s_nop 0
    buffer_load_dwordx4 v3, s[16:19], s33 offen lds
    s_add_u32 s33, s33, 32*7168
    s_add_u32 m0, s35, 81920
    s_nop 0
    s_nop 0
    buffer_load_dwordx4 v3, s[12:15], s33 offen lds
    s_add_u32 m0, s35, 90112
    s_nop 0
    s_nop 0
    buffer_load_dwordx4 v3, s[16:19], s33 offen lds
    s_add_u32 s33, s33, 32*7168
    s_add_u32 m0, s35, 114688
    s_nop 0
    s_nop 0
    buffer_load_dwordx4 v3, s[12:15], s33 offen lds
    s_add_u32 m0, s35, 122880
    s_nop 0
    s_nop 0
    buffer_load_dwordx4 v3, s[16:19], s33 offen lds
    s_add_u32 s33, s33, 32*7168
    s_cmp_lg_u32 s3, 0
    s_cbranch_scc1 k2_wc_s
    v_mov_b32 v240, 0
    v_mov_b32 v241, 1
    v_mov_b32 v242, 1
    v_mov_b32 v243, 1
    v_and_b32 v244, 31, v0
    s_lshl_b32 s59, s28, 7
    s_add_u32 s59, s59, 4096
    v_lshl_add_u32 v244, v244, 2, s59
    s_mov_b32 s59, 0x40000
    s_waitcnt vmcnt(63)
k2_wc:
    v_and_b32 v240, v240, v241
    v_and_b32 v242, v242, v243
    v_and_b32 v240, v240, v242
    v_cmp_ne_u32 vcc, 1, v240
    s_sub_u32 s59, s59, 1
    s_cbranch_scc1 k2_wc_x
    s_cbranch_vccz k2_wc_x
    buffer_load_dword v240, v244, s[84:87], 0 offen offset:0 sc1
    s_waitcnt vmcnt(0)
    s_branch k2_wc
k2_wc_x:
k2_wc_s:
    s_nop 0
    s_barrier
    s_add_u32 m0, s34, 1024
    s_nop 0
    s_nop 0
    buffer_load_dwordx4 v2, s[8:11], s32 offen sc1 lds
    buffer_load_dwordx4 v2, s[8:11], s32 offen offset:1024 sc1 lds
    s_add_u32 s32, s32, 2048
    s_add_u32 m0, s34, 33792
    s_nop 0
    s_nop 0
    buffer_load_dwordx4 v2, s[8:11], s32 offen sc1 lds
    buffer_load_dwordx4 v2, s[8:11], s32 offen offset:1024 sc1 lds
    s_add_u32 s32, s32, 2048
    s_add_u32 m0, s34, 66560
    s_nop 0
    s_nop 0
    buffer_load_dwordx4 v2, s[8:11], s32 offen sc1 lds
    buffer_load_dwordx4 v2, s[8:11], s32 offen offset:1024 sc1 lds
    s_add_u32 s32, s32, 2048
    s_add_u32 m0, s34, 99328
    s_nop 0
    s_nop 0
    buffer_load_dwordx4 v2, s[8:11], s32 offen sc1 lds
    buffer_load_dwordx4 v2, s[8:11], s32 offen offset:1024 sc1 lds
    s_add_u32 s32, s32, 2048
    s_add_u32 s84, s6, 41943040
    s_addc_u32 s85, s7, 0
    s_nop 0
    s_mov_b32 s86, 4096
    s_mov_b32 s87, 0x20000
    s_sub_u32 s46, s2, 32
    s_lshl_b32 s46, s46, 3
    s_add_u32 s46, s46, s3
    s_mov_b32 s24, s48
    s_mov_b32 s25, s49
    s_nop 0
    s_mov_b32 s26, 7340032
    s_mov_b32 s27, 0x20000
    s_add_u32 s52, s6, 33554432
    s_addc_u32 s53, s7, 0
    s_nop 0
    s_mov_b32 s54, 7340032
    s_mov_b32 s55, 0x20000
    s_lshr_b32 s50, s46, 2
    s_and_b32 s51, s46, 3
    s_lshl_b32 s56, s50, 14
    s_lshl_b32 s47, s51, 9
    s_add_u32 s56, s56, s47
    s_lshl_b32 s50, s50, 10
    s_mul_i32 s51, s51, 4*458752
    s_add_u32 s57, s50, s51
    v_lshrrev_b32 v4, 5, v0
    v_bfe_u32 v14, v0, 2, 2
    v_lshl_add_u32 v14, v4, 2, v14
    v_lshlrev_b32_e64 v14, 11, v14
    v_bfe_u32 v4, v0, 4, 1
    v_lshl_add_u32 v14, v4, 6, v14
    v_and_b32_e64 v4, 3, v0
    v_lshl_add_u32 v14, v4, 4, v14
    v_and_b32 v4, 32, v0
    v_xor_b32 v14, v14, v4
    s_mul_i32 s47, s46, 3072
    s_add_u32 s47, s47, 1835008
    s_lshl_b32 s46, s46, 12
    s_and_b32 s30, s3, 3
    s_lshr_b32 s31, s3, 2
    v_lshrrev_b32 v4, 4, v0
    v_lshlrev_b32 v8, 11, v4
    v_and_b32 v4, 1, v4
    v_lshl_add_u32 v8, v4, 5, v8
    v_bfe_u32 v4, v0, 2, 2
    v_lshl_add_u32 v8, v4, 6, v8
    v_and_b32_e64 v4, 3, v0
    v_lshl_add_u32 v8, v4, 3, v8
    s_lshl_b32 s44, s30, 8
    s_nop 0
    s_add_u32 s44, s44, 16384
    v_add_u32 v8, s44, v8
    s_lshl_b32 s44, s31, 13
    v_add_u32_e64 v5, s44, v2
    v_add_u32 v6, 0x10000, v5
    v_add_u32 v7, 0x20000, v5
    v_add_u32 v9, 0x10000, v8
    v_add_u32 v10, 0x20000, v8
    v_xor_b32 v11, 32, v8
    v_xor_b32 v12, 32, v9
    v_xor_b32 v13, 32, v10
    v_mov_b32 v128, 0
    v_mov_b32 v129, 0
    v_mov_b32 v130, 0
    v_mov_b32 v131, 0
    v_mov_b32 v132, 0
    v_mov_b32 v133, 0
    v_mov_b32 v134, 0
    v_mov_b32 v135, 0
    v_mov_b32 v136, 0
    v_mov_b32 v137, 0
    v_mov_b32 v138, 0
    v_mov_b32 v139, 0
    v_mov_b32 v140, 0
    v_mov_b32 v141, 0
    v_mov_b32 v142, 0
    v_mov_b32 v143, 0
    v_mov_b32 v144, 0
    v_mov_b32 v145, 0
    v_mov_b32 v146, 0
    v_mov_b32 v147, 0
    v_mov_b32 v148, 0
    v_mov_b32 v149, 0
    v_mov_b32 v150, 0
    v_mov_b32 v151, 0
    v_mov_b32 v152, 0
    v_mov_b32 v153, 0
    v_mov_b32 v154, 0
    v_mov_b32 v155, 0
    v_mov_b32 v156, 0
    v_mov_b32 v157, 0
    v_mov_b32 v158, 0
    v_mov_b32 v159, 0
    v_mov_b32 v160, 0
    v_mov_b32 v161, 0
    v_mov_b32 v162, 0
    v_mov_b32 v163, 0
    v_mov_b32 v164, 0
    v_mov_b32 v165, 0
    v_mov_b32 v166, 0
    v_mov_b32 v167, 0
    v_mov_b32 v168, 0
    v_mov_b32 v169, 0
    v_mov_b32 v170, 0
    v_mov_b32 v171, 0
    v_mov_b32 v172, 0
    v_mov_b32 v173, 0
    v_mov_b32 v174, 0
    v_mov_b32 v175, 0
    v_mov_b32 v176, 0
    v_mov_b32 v177, 0
    v_mov_b32 v178, 0
    v_mov_b32 v179, 0
    v_mov_b32 v180, 0
    v_mov_b32 v181, 0
    v_mov_b32 v182, 0
    v_mov_b32 v183, 0
    v_mov_b32 v184, 0
    v_mov_b32 v185, 0
    v_mov_b32 v186, 0
    v_mov_b32 v187, 0
    v_mov_b32 v188, 0
    v_mov_b32 v189, 0
    v_mov_b32 v190, 0
    v_mov_b32 v191, 0
    v_mov_b32 v192, 0
    v_mov_b32 v193, 0
    v_mov_b32 v194, 0
    v_mov_b32 v195, 0
    v_mov_b32 v196, 0
    v_mov_b32 v197, 0
    v_mov_b32 v198, 0
    v_mov_b32 v199, 0
    v_mov_b32 v200, 0
    v_mov_b32 v201, 0
    v_mov_b32 v202, 0
    v_mov_b32 v203, 0
    v_mov_b32 v204, 0
    v_mov_b32 v205, 0
    v_mov_b32 v206, 0
    v_mov_b32 v207, 0
    v_mov_b32 v208, 0
    v_mov_b32 v209, 0
    v_mov_b32 v210, 0
    v_mov_b32 v211, 0
    v_mov_b32 v212, 0
    v_mov_b32 v213, 0
    v_mov_b32 v214, 0
    v_mov_b32 v215, 0
    v_mov_b32 v216, 0
    v_mov_b32 v217, 0
    v_mov_b32 v218, 0
    v_mov_b32 v219, 0
    v_mov_b32 v220, 0
    v_mov_b32 v221, 0
    v_mov_b32 v222, 0
    v_mov_b32 v223, 0
    v_mov_b32 v224, 0
    v_mov_b32 v225, 0
    v_mov_b32 v226, 0
    v_mov_b32 v227, 0
    v_mov_b32 v228, 0
    v_mov_b32 v229, 0
    v_mov_b32 v230, 0
    v_mov_b32 v231, 0
    v_mov_b32 v232, 0
    v_mov_b32 v233, 0
    v_mov_b32 v234, 0
    v_mov_b32 v235, 0
    v_mov_b32 v236, 0
    v_mov_b32 v237, 0
    v_mov_b32 v238, 0
    v_mov_b32 v239, 0
    v_mov_b32 v240, 0
    v_mov_b32 v241, 0
    v_mov_b32 v242, 0
    v_mov_b32 v243, 0
    v_mov_b32 v244, 0
    v_mov_b32 v245, 0
    v_mov_b32 v246, 0
    v_mov_b32 v247, 0
    v_mov_b32 v248, 0
    v_mov_b32 v249, 0
    v_mov_b32 v250, 0
    v_mov_b32 v251, 0
    v_mov_b32 v252, 0
    v_mov_b32 v253, 0
    v_mov_b32 v254, 0
    v_mov_b32_e64 v255, 0
    s_waitcnt vmcnt(6)
    s_barrier
    ds_read_b64_tr_b16 v[48:49], v8 offset:0
    ds_read_b64_tr_b16 v[50:51], v8 offset:1024
    ds_read_b64_tr_b16 v[52:53], v11 offset:0
    ds_read_b64_tr_b16 v[54:55], v11 offset:1024
    ds_read_b64_tr_b16 v[56:57], v8 offset:8192
    ds_read_b64_tr_b16 v[58:59], v8 offset:9216
    ds_read_b64_tr_b16 v[60:61], v11 offset:8192
    ds_read_b64_tr_b16 v[62:63], v11 offset:9216
    ds_read_b128 v[16:19], v5 offset:0
    ds_read_b128 v[20:23], v5 offset:1024
    ds_read_b128 v[24:27], v5 offset:2048
    ds_read_b128 v[28:31], v5 offset:3072
    s_nop 0
    s_waitcnt lgkmcnt(0)
    v_mfma_f32_16x16x32_bf16 v[128:131], v[48:51], v[16:19], v[128:131]
    ds_read_b128 v[32:35], v5 offset:4096
    v_mfma_f32_16x16x32_bf16 v[132:135], v[52:55], v[16:19], v[132:135]
    ds_read_b128 v[36:39], v5 offset:5120
    v_mfma_f32_16x16x32_bf16 v[136:139], v[56:59], v[16:19], v[136:139]
    ds_read_b128 v[40:43], v5 offset:6144
    v_mfma_f32_16x16x32_bf16 v[140:143], v[60:63], v[16:19], v[140:143]
    ds_read_b128 v[44:47], v5 offset:7168
    v_mfma_f32_16x16x32_bf16 v[156:159], v[60:63], v[20:23], v[156:159]
    v_mfma_f32_16x16x32_bf16 v[152:155], v[56:59], v[20:23], v[152:155]
    v_mfma_f32_16x16x32_bf16 v[148:151], v[52:55], v[20:23], v[148:151]
    v_mfma_f32_16x16x32_bf16 v[144:147], v[48:51], v[20:23], v[144:147]
    v_mfma_f32_16x16x32_bf16 v[160:163], v[48:51], v[24:27], v[160:163]
    v_mfma_f32_16x16x32_bf16 v[164:167], v[52:55], v[24:27], v[164:167]
    v_mfma_f32_16x16x32_bf16 v[168:171], v[56:59], v[24:27], v[168:171]
    v_mfma_f32_16x16x32_bf16 v[172:175], v[60:63], v[24:27], v[172:175]
    v_mfma_f32_16x16x32_bf16 v[188:191], v[60:63], v[28:31], v[188:191]
    v_mfma_f32_16x16x32_bf16 v[184:187], v[56:59], v[28:31], v[184:187]
    v_mfma_f32_16x16x32_bf16 v[180:183], v[52:55], v[28:31], v[180:183]
    v_mfma_f32_16x16x32_bf16 v[176:179], v[48:51], v[28:31], v[176:179]
    s_waitcnt vmcnt(4) lgkmcnt(0)
    s_barrier
    v_mfma_f32_16x16x32_bf16 v[192:195], v[48:51], v[32:35], v[192:195]
    ds_read_b64_tr_b16 v[64:65], v8 offset:32768
    v_mfma_f32_16x16x32_bf16 v[196:199], v[52:55], v[32:35], v[196:199]
    ds_read_b64_tr_b16 v[66:67], v8 offset:33792
    v_mfma_f32_16x16x32_bf16 v[200:203], v[56:59], v[32:35], v[200:203]
    ds_read_b64_tr_b16 v[68:69], v11 offset:32768
    v_mfma_f32_16x16x32_bf16 v[204:207], v[60:63], v[32:35], v[204:207]
    ds_read_b64_tr_b16 v[70:71], v11 offset:33792
    v_mfma_f32_16x16x32_bf16 v[220:223], v[60:63], v[36:39], v[220:223]
    ds_read_b64_tr_b16 v[72:73], v8 offset:40960
    v_mfma_f32_16x16x32_bf16 v[216:219], v[56:59], v[36:39], v[216:219]
    ds_read_b64_tr_b16 v[74:75], v8 offset:41984
    v_mfma_f32_16x16x32_bf16 v[212:215], v[52:55], v[36:39], v[212:215]
    ds_read_b64_tr_b16 v[76:77], v11 offset:40960
    v_mfma_f32_16x16x32_bf16 v[208:211], v[48:51], v[36:39], v[208:211]
    ds_read_b64_tr_b16 v[78:79], v11 offset:41984
    v_mfma_f32_16x16x32_bf16 v[224:227], v[48:51], v[40:43], v[224:227]
    ds_read_b128 v[16:19], v5 offset:32768
    v_mfma_f32_16x16x32_bf16 v[228:231], v[52:55], v[40:43], v[228:231]
    ds_read_b128 v[20:23], v5 offset:33792
    v_mfma_f32_16x16x32_bf16 v[232:235], v[56:59], v[40:43], v[232:235]
    ds_read_b128 v[24:27], v5 offset:34816
    v_mfma_f32_16x16x32_bf16 v[236:239], v[60:63], v[40:43], v[236:239]
    ds_read_b128 v[28:31], v5 offset:35840
    v_mfma_f32_16x16x32_bf16 v[252:255], v[60:63], v[44:47], v[252:255]
    v_mfma_f32_16x16x32_bf16 v[248:251], v[56:59], v[44:47], v[248:251]
    v_mfma_f32_16x16x32_bf16 v[244:247], v[52:55], v[44:47], v[244:247]
    v_mfma_f32_16x16x32_bf16 v[240:243], v[48:51], v[44:47], v[240:243]
    s_nop 0
    s_waitcnt lgkmcnt(0)
    v_mfma_f32_16x16x32_bf16 v[128:131], v[64:67], v[16:19], v[128:131]
    ds_read_b128 v[32:35], v5 offset:36864
    v_mfma_f32_16x16x32_bf16 v[132:135], v[68:71], v[16:19], v[132:135]
    ds_read_b128 v[36:39], v5 offset:37888
    v_mfma_f32_16x16x32_bf16 v[136:139], v[72:75], v[16:19], v[136:139]
    ds_read_b128 v[40:43], v5 offset:38912
    v_mfma_f32_16x16x32_bf16 v[140:143], v[76:79], v[16:19], v[140:143]
    ds_read_b128 v[44:47], v5 offset:39936
    v_mfma_f32_16x16x32_bf16 v[156:159], v[76:79], v[20:23], v[156:159]
    s_add_u32 m0, s35, 16384
    v_mfma_f32_16x16x32_bf16 v[152:155], v[72:75], v[20:23], v[152:155]
    buffer_load_dwordx4 v3, s[12:15], s33 offen lds
    v_mfma_f32_16x16x32_bf16 v[148:151], v[68:71], v[20:23], v[148:151]
    v_mfma_f32_16x16x32_bf16 v[144:147], v[64:67], v[20:23], v[144:147]
    s_add_u32 m0, s35, 24576
    v_mfma_f32_16x16x32_bf16 v[160:163], v[64:67], v[24:27], v[160:163]
    buffer_load_dwordx4 v3, s[16:19], s33 offen lds
    s_add_u32 s33, s33, 32*7168
    v_mfma_f32_16x16x32_bf16 v[164:167], v[68:71], v[24:27], v[164:167]
    v_mfma_f32_16x16x32_bf16 v[168:171], v[72:75], v[24:27], v[168:171]
    s_add_u32 m0, s34, 1024
    v_mfma_f32_16x16x32_bf16 v[172:175], v[76:79], v[24:27], v[172:175]
    buffer_load_dwordx4 v2, s[8:11], s32 offen sc1 lds
    v_mfma_f32_16x16x32_bf16 v[188:191], v[76:79], v[28:31], v[188:191]
    v_mfma_f32_16x16x32_bf16 v[184:187], v[72:75], v[28:31], v[184:187]
    v_mfma_f32_16x16x32_bf16 v[180:183], v[68:71], v[28:31], v[180:183]
    buffer_load_dwordx4 v2, s[8:11], s32 offen offset:1024 sc1 lds
    s_add_u32 s32, s32, 2048
    v_mfma_f32_16x16x32_bf16 v[176:179], v[64:67], v[28:31], v[176:179]
    s_waitcnt vmcnt(6) lgkmcnt(0)
    s_barrier
    v_mfma_f32_16x16x32_bf16 v[192:195], v[64:67], v[32:35], v[192:195]
    ds_read_b64_tr_b16 v[48:49], v9 offset:0
    v_mfma_f32_16x16x32_bf16 v[196:199], v[68:71], v[32:35], v[196:199]
    ds_read_b64_tr_b16 v[50:51], v9 offset:1024
    v_mfma_f32_16x16x32_bf16 v[200:203], v[72:75], v[32:35], v[200:203]
    ds_read_b64_tr_b16 v[52:53], v12 offset:0
    v_mfma_f32_16x16x32_bf16 v[204:207], v[76:79], v[32:35], v[204:207]
    ds_read_b64_tr_b16 v[54:55], v12 offset:1024
    v_mfma_f32_16x16x32_bf16 v[220:223], v[76:79], v[36:39], v[220:223]
    ds_read_b64_tr_b16 v[56:57], v9 offset:8192
    v_mfma_f32_16x16x32_bf16 v[216:219], v[72:75], v[36:39], v[216:219]
    ds_read_b64_tr_b16 v[58:59], v9 offset:9216
    v_mfma_f32_16x16x32_bf16 v[212:215], v[68:71], v[36:39], v[212:215]
    ds_read_b64_tr_b16 v[60:61], v12 offset:8192
    v_mfma_f32_16x16x32_bf16 v[208:211], v[64:67], v[36:39], v[208:211]
    ds_read_b64_tr_b16 v[62:63], v12 offset:9216
    v_mfma_f32_16x16x32_bf16 v[224:227], v[64:67], v[40:43], v[224:227]
    ds_read_b128 v[16:19], v6 offset:0
    v_mfma_f32_16x16x32_bf16 v[228:231], v[68:71], v[40:43], v[228:231]
    ds_read_b128 v[20:23], v6 offset:1024
    v_mfma_f32_16x16x32_bf16 v[232:235], v[72:75], v[40:43], v[232:235]
    ds_read_b128 v[24:27], v6 offset:2048
    v_mfma_f32_16x16x32_bf16 v[236:239], v[76:79], v[40:43], v[236:239]
    ds_read_b128 v[28:31], v6 offset:3072
    v_mfma_f32_16x16x32_bf16 v[252:255], v[76:79], v[44:47], v[252:255]
    v_mfma_f32_16x16x32_bf16 v[248:251], v[72:75], v[44:47], v[248:251]
    v_mfma_f32_16x16x32_bf16 v[244:247], v[68:71], v[44:47], v[244:247]
    v_mfma_f32_16x16x32_bf16 v[240:243], v[64:67], v[44:47], v[240:243]
    s_nop 0
    s_waitcnt lgkmcnt(0)
    v_mfma_f32_16x16x32_bf16 v[128:131], v[48:51], v[16:19], v[128:131]
    ds_read_b128 v[32:35], v6 offset:4096
    v_mfma_f32_16x16x32_bf16 v[132:135], v[52:55], v[16:19], v[132:135]
    ds_read_b128 v[36:39], v6 offset:5120
    v_mfma_f32_16x16x32_bf16 v[136:139], v[56:59], v[16:19], v[136:139]
    ds_read_b128 v[40:43], v6 offset:6144
    v_mfma_f32_16x16x32_bf16 v[140:143], v[60:63], v[16:19], v[140:143]
    ds_read_b128 v[44:47], v6 offset:7168
    v_mfma_f32_16x16x32_bf16 v[156:159], v[60:63], v[20:23], v[156:159]
    s_add_u32 m0, s35, 49152
    v_mfma_f32_16x16x32_bf16 v[152:155], v[56:59], v[20:23], v[152:155]
    buffer_load_dwordx4 v3, s[12:15], s33 offen lds
    v_mfma_f32_16x16x32_bf16 v[148:151], v[52:55], v[20:23], v[148:151]
    v_mfma_f32_16x16x32_bf16 v[144:147], v[48:51], v[20:23], v[144:147]
    s_add_u32 m0, s35, 57344
    v_mfma_f32_16x16x32_bf16 v[160:163], v[48:51], v[24:27], v[160:163]
    buffer_load_dwordx4 v3, s[16:19], s33 offen lds
    s_add_u32 s33, s33, 32*7168
    v_mfma_f32_16x16x32_bf16 v[164:167], v[52:55], v[24:27], v[164:167]
    v_mfma_f32_16x16x32_bf16 v[168:171], v[56:59], v[24:27], v[168:171]
    s_add_u32 m0, s34, 33792
    v_mfma_f32_16x16x32_bf16 v[172:175], v[60:63], v[24:27], v[172:175]
    buffer_load_dwordx4 v2, s[8:11], s32 offen sc1 lds
    v_mfma_f32_16x16x32_bf16 v[188:191], v[60:63], v[28:31], v[188:191]
    v_mfma_f32_16x16x32_bf16 v[184:187], v[56:59], v[28:31], v[184:187]
    v_mfma_f32_16x16x32_bf16 v[180:183], v[52:55], v[28:31], v[180:183]
    buffer_load_dwordx4 v2, s[8:11], s32 offen offset:1024 sc1 lds
    s_add_u32 s32, s32, 2048
    v_mfma_f32_16x16x32_bf16 v[176:179], v[48:51], v[28:31], v[176:179]
    s_waitcnt vmcnt(8) lgkmcnt(0)
    s_barrier
    v_mfma_f32_16x16x32_bf16 v[192:195], v[48:51], v[32:35], v[192:195]
    ds_read_b64_tr_b16 v[64:65], v9 offset:32768
    v_mfma_f32_16x16x32_bf16 v[196:199], v[52:55], v[32:35], v[196:199]
    ds_read_b64_tr_b16 v[66:67], v9 offset:33792
    v_mfma_f32_16x16x32_bf16 v[200:203], v[56:59], v[32:35], v[200:203]
    ds_read_b64_tr_b16 v[68:69], v12 offset:32768
    v_mfma_f32_16x16x32_bf16 v[204:207], v[60:63], v[32:35], v[204:207]
    ds_read_b64_tr_b16 v[70:71], v12 offset:33792
    v_mfma_f32_16x16x32_bf16 v[220:223], v[60:63], v[36:39], v[220:223]
    ds_read_b64_tr_b16 v[72:73], v9 offset:40960
    v_mfma_f32_16x16x32_bf16 v[216:219], v[56:59], v[36:39], v[216:219]
    ds_read_b64_tr_b16 v[74:75], v9 offset:41984
    v_mfma_f32_16x16x32_bf16 v[212:215], v[52:55], v[36:39], v[212:215]
    ds_read_b64_tr_b16 v[76:77], v12 offset:40960
    v_mfma_f32_16x16x32_bf16 v[208:211], v[48:51], v[36:39], v[208:211]
    ds_read_b64_tr_b16 v[78:79], v12 offset:41984
    v_mfma_f32_16x16x32_bf16 v[224:227], v[48:51], v[40:43], v[224:227]
    ds_read_b128 v[16:19], v6 offset:32768
    v_mfma_f32_16x16x32_bf16 v[228:231], v[52:55], v[40:43], v[228:231]
    ds_read_b128 v[20:23], v6 offset:33792
    v_mfma_f32_16x16x32_bf16 v[232:235], v[56:59], v[40:43], v[232:235]
    ds_read_b128 v[24:27], v6 offset:34816
    v_mfma_f32_16x16x32_bf16 v[236:239], v[60:63], v[40:43], v[236:239]
    ds_read_b128 v[28:31], v6 offset:35840
    v_mfma_f32_16x16x32_bf16 v[252:255], v[60:63], v[44:47], v[252:255]
    v_mfma_f32_16x16x32_bf16 v[248:251], v[56:59], v[44:47], v[248:251]
    v_mfma_f32_16x16x32_bf16 v[244:247], v[52:55], v[44:47], v[244:247]
    v_mfma_f32_16x16x32_bf16 v[240:243], v[48:51], v[44:47], v[240:243]
    s_nop 0
    s_waitcnt lgkmcnt(0)
    v_mfma_f32_16x16x32_bf16 v[128:131], v[64:67], v[16:19], v[128:131]
    ds_read_b128 v[32:35], v6 offset:36864
    v_mfma_f32_16x16x32_bf16 v[132:135], v[68:71], v[16:19], v[132:135]
    ds_read_b128 v[36:39], v6 offset:37888
    v_mfma_f32_16x16x32_bf16 v[136:139], v[72:75], v[16:19], v[136:139]
    ds_read_b128 v[40:43], v6 offset:38912
    v_mfma_f32_16x16x32_bf16 v[140:143], v[76:79], v[16:19], v[140:143]
    ds_read_b128 v[44:47], v6 offset:39936
    v_mfma_f32_16x16x32_bf16 v[156:159], v[76:79], v[20:23], v[156:159]
    s_add_u32 m0, s35, 81920
    v_mfma_f32_16x16x32_bf16 v[152:155], v[72:75], v[20:23], v[152:155]
    buffer_load_dwordx4 v3, s[12:15], s33 offen lds
    v_mfma_f32_16x16x32_bf16 v[148:151], v[68:71], v[20:23], v[148:151]
    v_mfma_f32_16x16x32_bf16 v[144:147], v[64:67], v[20:23], v[144:147]
    s_add_u32 m0, s35, 90112
    v_mfma_f32_16x16x32_bf16 v[160:163], v[64:67], v[24:27], v[160:163]
    buffer_load_dwordx4 v3, s[16:19], s33 offen lds
    s_add_u32 s33, s33, 32*7168
    v_mfma_f32_16x16x32_bf16 v[164:167], v[68:71], v[24:27], v[164:167]
    v_mfma_f32_16x16x32_bf16 v[168:171], v[72:75], v[24:27], v[168:171]
    s_add_u32 m0, s34, 66560
    v_mfma_f32_16x16x32_bf16 v[172:175], v[76:79], v[24:27], v[172:175]
    buffer_load_dwordx4 v2, s[8:11], s32 offen sc1 lds
    v_mfma_f32_16x16x32_bf16 v[188:191], v[76:79], v[28:31], v[188:191]
    v_mfma_f32_16x16x32_bf16 v[184:187], v[72:75], v[28:31], v[184:187]
    v_mfma_f32_16x16x32_bf16 v[180:183], v[68:71], v[28:31], v[180:183]
    buffer_load_dwordx4 v2, s[8:11], s32 offen offset:1024 sc1 lds
    s_add_u32 s32, s32, 2048
    v_mfma_f32_16x16x32_bf16 v[176:179], v[64:67], v[28:31], v[176:179]
    buffer_load_dwordx4 v[116:119], v2, s[12:15], s47 offen offset:0
    s_waitcnt vmcnt(9) lgkmcnt(0)
    s_barrier
    v_mfma_f32_16x16x32_bf16 v[192:195], v[64:67], v[32:35], v[192:195]
    ds_read_b64_tr_b16 v[48:49], v8 offset:0
    v_mfma_f32_16x16x32_bf16 v[196:199], v[68:71], v[32:35], v[196:199]
    ds_read_b64_tr_b16 v[50:51], v8 offset:1024
    v_mfma_f32_16x16x32_bf16 v[200:203], v[72:75], v[32:35], v[200:203]
    ds_read_b64_tr_b16 v[52:53], v11 offset:0
    v_mfma_f32_16x16x32_bf16 v[204:207], v[76:79], v[32:35], v[204:207]
    ds_read_b64_tr_b16 v[54:55], v11 offset:1024
    v_mfma_f32_16x16x32_bf16 v[220:223], v[76:79], v[36:39], v[220:223]
    ds_read_b64_tr_b16 v[56:57], v8 offset:8192
    v_mfma_f32_16x16x32_bf16 v[216:219], v[72:75], v[36:39], v[216:219]
    ds_read_b64_tr_b16 v[58:59], v8 offset:9216
    v_mfma_f32_16x16x32_bf16 v[212:215], v[68:71], v[36:39], v[212:215]
    ds_read_b64_tr_b16 v[60:61], v11 offset:8192
    v_mfma_f32_16x16x32_bf16 v[208:211], v[64:67], v[36:39], v[208:211]
    ds_read_b64_tr_b16 v[62:63], v11 offset:9216
    v_mfma_f32_16x16x32_bf16 v[224:227], v[64:67], v[40:43], v[224:227]
    ds_read_b128 v[16:19], v5 offset:0
    v_mfma_f32_16x16x32_bf16 v[228:231], v[68:71], v[40:43], v[228:231]
    ds_read_b128 v[20:23], v5 offset:1024
    v_mfma_f32_16x16x32_bf16 v[232:235], v[72:75], v[40:43], v[232:235]
    ds_read_b128 v[24:27], v5 offset:2048
    v_mfma_f32_16x16x32_bf16 v[236:239], v[76:79], v[40:43], v[236:239]
    ds_read_b128 v[28:31], v5 offset:3072
    v_mfma_f32_16x16x32_bf16 v[252:255], v[76:79], v[44:47], v[252:255]
    v_mfma_f32_16x16x32_bf16 v[248:251], v[72:75], v[44:47], v[248:251]
    v_mfma_f32_16x16x32_bf16 v[244:247], v[68:71], v[44:47], v[244:247]
    v_mfma_f32_16x16x32_bf16 v[240:243], v[64:67], v[44:47], v[240:243]
    s_nop 0
    s_waitcnt lgkmcnt(0)
    v_mfma_f32_16x16x32_bf16 v[128:131], v[48:51], v[16:19], v[128:131]
    ds_read_b128 v[32:35], v5 offset:4096
    v_mfma_f32_16x16x32_bf16 v[132:135], v[52:55], v[16:19], v[132:135]
    ds_read_b128 v[36:39], v5 offset:5120
    v_mfma_f32_16x16x32_bf16 v[136:139], v[56:59], v[16:19], v[136:139]
    ds_read_b128 v[40:43], v5 offset:6144
    v_mfma_f32_16x16x32_bf16 v[140:143], v[60:63], v[16:19], v[140:143]
    ds_read_b128 v[44:47], v5 offset:7168
    v_mfma_f32_16x16x32_bf16 v[156:159], v[60:63], v[20:23], v[156:159]
    s_add_u32 m0, s35, 114688
    v_mfma_f32_16x16x32_bf16 v[152:155], v[56:59], v[20:23], v[152:155]
    buffer_load_dwordx4 v3, s[12:15], s33 offen lds
    v_mfma_f32_16x16x32_bf16 v[148:151], v[52:55], v[20:23], v[148:151]
    v_mfma_f32_16x16x32_bf16 v[144:147], v[48:51], v[20:23], v[144:147]
    s_add_u32 m0, s35, 122880
    v_mfma_f32_16x16x32_bf16 v[160:163], v[48:51], v[24:27], v[160:163]
    buffer_load_dwordx4 v3, s[16:19], s33 offen lds
    s_add_u32 s33, s33, 32*7168
    v_mfma_f32_16x16x32_bf16 v[164:167], v[52:55], v[24:27], v[164:167]
    v_mfma_f32_16x16x32_bf16 v[168:171], v[56:59], v[24:27], v[168:171]
    s_add_u32 m0, s34, 99328
    v_mfma_f32_16x16x32_bf16 v[172:175], v[60:63], v[24:27], v[172:175]
    buffer_load_dwordx4 v2, s[8:11], s32 offen sc1 lds
    v_mfma_f32_16x16x32_bf16 v[188:191], v[60:63], v[28:31], v[188:191]
    v_mfma_f32_16x16x32_bf16 v[184:187], v[56:59], v[28:31], v[184:187]
    v_mfma_f32_16x16x32_bf16 v[180:183], v[52:55], v[28:31], v[180:183]
    buffer_load_dwordx4 v2, s[8:11], s32 offen offset:1024 sc1 lds
    s_add_u32 s32, s32, 2048
    v_mfma_f32_16x16x32_bf16 v[176:179], v[48:51], v[28:31], v[176:179]
    buffer_load_dwordx4 v[116:119], v2, s[12:15], s47 offen offset:1024
    s_waitcnt vmcnt(10) lgkmcnt(0)
    s_barrier
    v_mfma_f32_16x16x32_bf16 v[192:195], v[48:51], v[32:35], v[192:195]
    ds_read_b64_tr_b16 v[64:65], v8 offset:32768
    v_mfma_f32_16x16x32_bf16 v[196:199], v[52:55], v[32:35], v[196:199]
    ds_read_b64_tr_b16 v[66:67], v8 offset:33792
    v_mfma_f32_16x16x32_bf16 v[200:203], v[56:59], v[32:35], v[200:203]
    ds_read_b64_tr_b16 v[68:69], v11 offset:32768
    v_mfma_f32_16x16x32_bf16 v[204:207], v[60:63], v[32:35], v[204:207]
    ds_read_b64_tr_b16 v[70:71], v11 offset:33792
    v_mfma_f32_16x16x32_bf16 v[220:223], v[60:63], v[36:39], v[220:223]
    ds_read_b64_tr_b16 v[72:73], v8 offset:40960
    v_mfma_f32_16x16x32_bf16 v[216:219], v[56:59], v[36:39], v[216:219]
    ds_read_b64_tr_b16 v[74:75], v8 offset:41984
    v_mfma_f32_16x16x32_bf16 v[212:215], v[52:55], v[36:39], v[212:215]
    ds_read_b64_tr_b16 v[76:77], v11 offset:40960
    v_mfma_f32_16x16x32_bf16 v[208:211], v[48:51], v[36:39], v[208:211]
    ds_read_b64_tr_b16 v[78:79], v11 offset:41984
    v_mfma_f32_16x16x32_bf16 v[224:227], v[48:51], v[40:43], v[224:227]
    ds_read_b128 v[16:19], v5 offset:32768
    v_mfma_f32_16x16x32_bf16 v[228:231], v[52:55], v[40:43], v[228:231]
    ds_read_b128 v[20:23], v5 offset:33792
    v_mfma_f32_16x16x32_bf16 v[232:235], v[56:59], v[40:43], v[232:235]
    ds_read_b128 v[24:27], v5 offset:34816
    v_mfma_f32_16x16x32_bf16 v[236:239], v[60:63], v[40:43], v[236:239]
    ds_read_b128 v[28:31], v5 offset:35840
    v_mfma_f32_16x16x32_bf16 v[252:255], v[60:63], v[44:47], v[252:255]
    v_mfma_f32_16x16x32_bf16 v[248:251], v[56:59], v[44:47], v[248:251]
    v_mfma_f32_16x16x32_bf16 v[244:247], v[52:55], v[44:47], v[244:247]
    v_mfma_f32_16x16x32_bf16 v[240:243], v[48:51], v[44:47], v[240:243]
    s_nop 0
    s_waitcnt lgkmcnt(0)
    v_mfma_f32_16x16x32_bf16 v[128:131], v[64:67], v[16:19], v[128:131]
    ds_read_b128 v[32:35], v5 offset:36864
    v_mfma_f32_16x16x32_bf16 v[132:135], v[68:71], v[16:19], v[132:135]
    ds_read_b128 v[36:39], v5 offset:37888
    v_mfma_f32_16x16x32_bf16 v[136:139], v[72:75], v[16:19], v[136:139]
    ds_read_b128 v[40:43], v5 offset:38912
    v_mfma_f32_16x16x32_bf16 v[140:143], v[76:79], v[16:19], v[140:143]
    ds_read_b128 v[44:47], v5 offset:39936
    v_mfma_f32_16x16x32_bf16 v[156:159], v[76:79], v[20:23], v[156:159]
    s_add_u32 m0, s35, 16384
    v_mfma_f32_16x16x32_bf16 v[152:155], v[72:75], v[20:23], v[152:155]
    buffer_load_dwordx4 v3, s[12:15], s33 offen lds
    v_mfma_f32_16x16x32_bf16 v[148:151], v[68:71], v[20:23], v[148:151]
    v_mfma_f32_16x16x32_bf16 v[144:147], v[64:67], v[20:23], v[144:147]
    s_add_u32 m0, s35, 24576
    v_mfma_f32_16x16x32_bf16 v[160:163], v[64:67], v[24:27], v[160:163]
    buffer_load_dwordx4 v3, s[16:19], s33 offen lds
    s_add_u32 s33, s33, 32*7168
    v_mfma_f32_16x16x32_bf16 v[164:167], v[68:71], v[24:27], v[164:167]
    v_mfma_f32_16x16x32_bf16 v[168:171], v[72:75], v[24:27], v[168:171]
    s_add_u32 m0, s34, 1024
    v_mfma_f32_16x16x32_bf16 v[172:175], v[76:79], v[24:27], v[172:175]
    buffer_load_dwordx4 v2, s[8:11], s32 offen sc1 lds
    v_mfma_f32_16x16x32_bf16 v[188:191], v[76:79], v[28:31], v[188:191]
    v_mfma_f32_16x16x32_bf16 v[184:187], v[72:75], v[28:31], v[184:187]
    v_mfma_f32_16x16x32_bf16 v[180:183], v[68:71], v[28:31], v[180:183]
    buffer_load_dwordx4 v2, s[8:11], s32 offen offset:1024 sc1 lds
    s_add_u32 s32, s32, 2048
    v_mfma_f32_16x16x32_bf16 v[176:179], v[64:67], v[28:31], v[176:179]
    buffer_load_dwordx4 v[116:119], v2, s[12:15], s47 offen offset:2048
    s_waitcnt vmcnt(11) lgkmcnt(0)
    s_barrier
    v_mfma_f32_16x16x32_bf16 v[192:195], v[64:67], v[32:35], v[192:195]
    ds_read_b64_tr_b16 v[48:49], v9 offset:0
    v_mfma_f32_16x16x32_bf16 v[196:199], v[68:71], v[32:35], v[196:199]
    ds_read_b64_tr_b16 v[50:51], v9 offset:1024
    v_mfma_f32_16x16x32_bf16 v[200:203], v[72:75], v[32:35], v[200:203]
    ds_read_b64_tr_b16 v[52:53], v12 offset:0
    v_mfma_f32_16x16x32_bf16 v[204:207], v[76:79], v[32:35], v[204:207]
    ds_read_b64_tr_b16 v[54:55], v12 offset:1024
    v_mfma_f32_16x16x32_bf16 v[220:223], v[76:79], v[36:39], v[220:223]
    ds_read_b64_tr_b16 v[56:57], v9 offset:8192
    v_mfma_f32_16x16x32_bf16 v[216:219], v[72:75], v[36:39], v[216:219]
    ds_read_b64_tr_b16 v[58:59], v9 offset:9216
    v_mfma_f32_16x16x32_bf16 v[212:215], v[68:71], v[36:39], v[212:215]
    ds_read_b64_tr_b16 v[60:61], v12 offset:8192
    v_mfma_f32_16x16x32_bf16 v[208:211], v[64:67], v[36:39], v[208:211]
    ds_read_b64_tr_b16 v[62:63], v12 offset:9216
    v_mfma_f32_16x16x32_bf16 v[224:227], v[64:67], v[40:43], v[224:227]
    ds_read_b128 v[16:19], v6 offset:0
    v_mfma_f32_16x16x32_bf16 v[228:231], v[68:71], v[40:43], v[228:231]
    ds_read_b128 v[20:23], v6 offset:1024
    v_mfma_f32_16x16x32_bf16 v[232:235], v[72:75], v[40:43], v[232:235]
    ds_read_b128 v[24:27], v6 offset:2048
    v_mfma_f32_16x16x32_bf16 v[236:239], v[76:79], v[40:43], v[236:239]
    ds_read_b128 v[28:31], v6 offset:3072
    v_mfma_f32_16x16x32_bf16 v[252:255], v[76:79], v[44:47], v[252:255]
    v_mfma_f32_16x16x32_bf16 v[248:251], v[72:75], v[44:47], v[248:251]
    v_mfma_f32_16x16x32_bf16 v[244:247], v[68:71], v[44:47], v[244:247]
    v_mfma_f32_16x16x32_bf16 v[240:243], v[64:67], v[44:47], v[240:243]
    s_nop 0
    s_waitcnt lgkmcnt(0)
    v_mfma_f32_16x16x32_bf16 v[128:131], v[48:51], v[16:19], v[128:131]
    ds_read_b128 v[32:35], v6 offset:4096
    v_mfma_f32_16x16x32_bf16 v[132:135], v[52:55], v[16:19], v[132:135]
    ds_read_b128 v[36:39], v6 offset:5120
    v_mfma_f32_16x16x32_bf16 v[136:139], v[56:59], v[16:19], v[136:139]
    ds_read_b128 v[40:43], v6 offset:6144
    v_mfma_f32_16x16x32_bf16 v[140:143], v[60:63], v[16:19], v[140:143]
    ds_read_b128 v[44:47], v6 offset:7168
    v_mfma_f32_16x16x32_bf16 v[156:159], v[60:63], v[20:23], v[156:159]
    s_add_u32 m0, s35, 49152
    v_mfma_f32_16x16x32_bf16 v[152:155], v[56:59], v[20:23], v[152:155]
    buffer_load_dwordx4 v3, s[12:15], s33 offen lds
    v_mfma_f32_16x16x32_bf16 v[148:151], v[52:55], v[20:23], v[148:151]
    v_mfma_f32_16x16x32_bf16 v[144:147], v[48:51], v[20:23], v[144:147]
    s_add_u32 m0, s35, 57344
    v_mfma_f32_16x16x32_bf16 v[160:163], v[48:51], v[24:27], v[160:163]
    buffer_load_dwordx4 v3, s[16:19], s33 offen lds
    s_add_u32 s33, s33, 32*7168
    v_mfma_f32_16x16x32_bf16 v[164:167], v[52:55], v[24:27], v[164:167]
    v_mfma_f32_16x16x32_bf16 v[168:171], v[56:59], v[24:27], v[168:171]
    s_add_u32 m0, s34, 33792
    v_mfma_f32_16x16x32_bf16 v[172:175], v[60:63], v[24:27], v[172:175]
    buffer_load_dwordx4 v2, s[8:11], s32 offen sc1 lds
    v_mfma_f32_16x16x32_bf16 v[188:191], v[60:63], v[28:31], v[188:191]
    v_mfma_f32_16x16x32_bf16 v[184:187], v[56:59], v[28:31], v[184:187]
    v_mfma_f32_16x16x32_bf16 v[180:183], v[52:55], v[28:31], v[180:183]
    buffer_load_dwordx4 v2, s[8:11], s32 offen offset:1024 sc1 lds
    s_add_u32 s32, s32, 2048
    v_mfma_f32_16x16x32_bf16 v[176:179], v[48:51], v[28:31], v[176:179]
    buffer_load_dwordx4 v[116:119], v2, s[16:19], s47 offen offset:0
    s_waitcnt vmcnt(11) lgkmcnt(0)
    s_barrier
    v_mfma_f32_16x16x32_bf16 v[192:195], v[48:51], v[32:35], v[192:195]
    ds_read_b64_tr_b16 v[64:65], v9 offset:32768
    v_mfma_f32_16x16x32_bf16 v[196:199], v[52:55], v[32:35], v[196:199]
    ds_read_b64_tr_b16 v[66:67], v9 offset:33792
    v_mfma_f32_16x16x32_bf16 v[200:203], v[56:59], v[32:35], v[200:203]
    ds_read_b64_tr_b16 v[68:69], v12 offset:32768
    v_mfma_f32_16x16x32_bf16 v[204:207], v[60:63], v[32:35], v[204:207]
    ds_read_b64_tr_b16 v[70:71], v12 offset:33792
    v_mfma_f32_16x16x32_bf16 v[220:223], v[60:63], v[36:39], v[220:223]
    ds_read_b64_tr_b16 v[72:73], v9 offset:40960
    v_mfma_f32_16x16x32_bf16 v[216:219], v[56:59], v[36:39], v[216:219]
    ds_read_b64_tr_b16 v[74:75], v9 offset:41984
    v_mfma_f32_16x16x32_bf16 v[212:215], v[52:55], v[36:39], v[212:215]
    ds_read_b64_tr_b16 v[76:77], v12 offset:40960
    v_mfma_f32_16x16x32_bf16 v[208:211], v[48:51], v[36:39], v[208:211]
    ds_read_b64_tr_b16 v[78:79], v12 offset:41984
    v_mfma_f32_16x16x32_bf16 v[224:227], v[48:51], v[40:43], v[224:227]
    ds_read_b128 v[16:19], v6 offset:32768
    v_mfma_f32_16x16x32_bf16 v[228:231], v[52:55], v[40:43], v[228:231]
    ds_read_b128 v[20:23], v6 offset:33792
    v_mfma_f32_16x16x32_bf16 v[232:235], v[56:59], v[40:43], v[232:235]
    ds_read_b128 v[24:27], v6 offset:34816
    v_mfma_f32_16x16x32_bf16 v[236:239], v[60:63], v[40:43], v[236:239]
    ds_read_b128 v[28:31], v6 offset:35840
    v_mfma_f32_16x16x32_bf16 v[252:255], v[60:63], v[44:47], v[252:255]
    v_mfma_f32_16x16x32_bf16 v[248:251], v[56:59], v[44:47], v[248:251]
    v_mfma_f32_16x16x32_bf16 v[244:247], v[52:55], v[44:47], v[244:247]
    v_mfma_f32_16x16x32_bf16 v[240:243], v[48:51], v[44:47], v[240:243]
    s_nop 0
    s_waitcnt lgkmcnt(0)
    v_mfma_f32_16x16x32_bf16 v[128:131], v[64:67], v[16:19], v[128:131]
    ds_read_b128 v[32:35], v6 offset:36864
    v_mfma_f32_16x16x32_bf16 v[132:135], v[68:71], v[16:19], v[132:135]
    ds_read_b128 v[36:39], v6 offset:37888
    v_mfma_f32_16x16x32_bf16 v[136:139], v[72:75], v[16:19], v[136:139]
    ds_read_b128 v[40:43], v6 offset:38912
    v_mfma_f32_16x16x32_bf16 v[140:143], v[76:79], v[16:19], v[140:143]
    ds_read_b128 v[44:47], v6 offset:39936
    v_mfma_f32_16x16x32_bf16 v[156:159], v[76:79], v[20:23], v[156:159]
    s_add_u32 m0, s35, 81920
    v_mfma_f32_16x16x32_bf16 v[152:155], v[72:75], v[20:23], v[152:155]
    buffer_load_dwordx4 v3, s[12:15], s33 offen lds
    v_mfma_f32_16x16x32_bf16 v[148:151], v[68:71], v[20:23], v[148:151]
    v_mfma_f32_16x16x32_bf16 v[144:147], v[64:67], v[20:23], v[144:147]
    s_add_u32 m0, s35, 90112
    v_mfma_f32_16x16x32_bf16 v[160:163], v[64:67], v[24:27], v[160:163]
    buffer_load_dwordx4 v3, s[16:19], s33 offen lds
    s_add_u32 s33, s33, 32*7168
    v_mfma_f32_16x16x32_bf16 v[164:167], v[68:71], v[24:27], v[164:167]
    v_mfma_f32_16x16x32_bf16 v[168:171], v[72:75], v[24:27], v[168:171]
    s_add_u32 m0, s34, 66560
    v_mfma_f32_16x16x32_bf16 v[172:175], v[76:79], v[24:27], v[172:175]
    buffer_load_dwordx4 v2, s[8:11], s32 offen sc1 lds
    v_mfma_f32_16x16x32_bf16 v[188:191], v[76:79], v[28:31], v[188:191]
    v_mfma_f32_16x16x32_bf16 v[184:187], v[72:75], v[28:31], v[184:187]
    v_mfma_f32_16x16x32_bf16 v[180:183], v[68:71], v[28:31], v[180:183]
    buffer_load_dwordx4 v2, s[8:11], s32 offen offset:1024 sc1 lds
    s_add_u32 s32, s32, 2048
    v_mfma_f32_16x16x32_bf16 v[176:179], v[64:67], v[28:31], v[176:179]
    buffer_load_dwordx4 v[116:119], v2, s[16:19], s47 offen offset:1024
    s_waitcnt vmcnt(11) lgkmcnt(0)
    s_barrier
    v_mfma_f32_16x16x32_bf16 v[192:195], v[64:67], v[32:35], v[192:195]
    ds_read_b64_tr_b16 v[48:49], v8 offset:0
    v_mfma_f32_16x16x32_bf16 v[196:199], v[68:71], v[32:35], v[196:199]
    ds_read_b64_tr_b16 v[50:51], v8 offset:1024
    v_mfma_f32_16x16x32_bf16 v[200:203], v[72:75], v[32:35], v[200:203]
    ds_read_b64_tr_b16 v[52:53], v11 offset:0
    v_mfma_f32_16x16x32_bf16 v[204:207], v[76:79], v[32:35], v[204:207]
    ds_read_b64_tr_b16 v[54:55], v11 offset:1024
    v_mfma_f32_16x16x32_bf16 v[220:223], v[76:79], v[36:39], v[220:223]
    ds_read_b64_tr_b16 v[56:57], v8 offset:8192
    v_mfma_f32_16x16x32_bf16 v[216:219], v[72:75], v[36:39], v[216:219]
    ds_read_b64_tr_b16 v[58:59], v8 offset:9216
    v_mfma_f32_16x16x32_bf16 v[212:215], v[68:71], v[36:39], v[212:215]
    ds_read_b64_tr_b16 v[60:61], v11 offset:8192
    v_mfma_f32_16x16x32_bf16 v[208:211], v[64:67], v[36:39], v[208:211]
    ds_read_b64_tr_b16 v[62:63], v11 offset:9216
    v_mfma_f32_16x16x32_bf16 v[224:227], v[64:67], v[40:43], v[224:227]
    ds_read_b128 v[16:19], v5 offset:0
    v_mfma_f32_16x16x32_bf16 v[228:231], v[68:71], v[40:43], v[228:231]
    ds_read_b128 v[20:23], v5 offset:1024
    v_mfma_f32_16x16x32_bf16 v[232:235], v[72:75], v[40:43], v[232:235]
    ds_read_b128 v[24:27], v5 offset:2048
    v_mfma_f32_16x16x32_bf16 v[236:239], v[76:79], v[40:43], v[236:239]
    ds_read_b128 v[28:31], v5 offset:3072
    v_mfma_f32_16x16x32_bf16 v[252:255], v[76:79], v[44:47], v[252:255]
    v_mfma_f32_16x16x32_bf16 v[248:251], v[72:75], v[44:47], v[248:251]
    v_mfma_f32_16x16x32_bf16 v[244:247], v[68:71], v[44:47], v[244:247]
    v_mfma_f32_16x16x32_bf16 v[240:243], v[64:67], v[44:47], v[240:243]
    s_nop 0
    s_waitcnt lgkmcnt(0)
    v_mfma_f32_16x16x32_bf16 v[128:131], v[48:51], v[16:19], v[128:131]
    ds_read_b128 v[32:35], v5 offset:4096
    v_mfma_f32_16x16x32_bf16 v[132:135], v[52:55], v[16:19], v[132:135]
    ds_read_b128 v[36:39], v5 offset:5120
    v_mfma_f32_16x16x32_bf16 v[136:139], v[56:59], v[16:19], v[136:139]
    ds_read_b128 v[40:43], v5 offset:6144
    v_mfma_f32_16x16x32_bf16 v[140:143], v[60:63], v[16:19], v[140:143]
    ds_read_b128 v[44:47], v5 offset:7168
    v_mfma_f32_16x16x32_bf16 v[156:159], v[60:63], v[20:23], v[156:159]
    s_add_u32 m0, s35, 114688
    v_mfma_f32_16x16x32_bf16 v[152:155], v[56:59], v[20:23], v[152:155]
    buffer_load_dwordx4 v3, s[12:15], s33 offen lds
    v_mfma_f32_16x16x32_bf16 v[148:151], v[52:55], v[20:23], v[148:151]
    v_mfma_f32_16x16x32_bf16 v[144:147], v[48:51], v[20:23], v[144:147]
    s_add_u32 m0, s35, 122880
    v_mfma_f32_16x16x32_bf16 v[160:163], v[48:51], v[24:27], v[160:163]
    buffer_load_dwordx4 v3, s[16:19], s33 offen lds
    s_add_u32 s33, s33, 32*7168
    v_mfma_f32_16x16x32_bf16 v[164:167], v[52:55], v[24:27], v[164:167]
    v_mfma_f32_16x16x32_bf16 v[168:171], v[56:59], v[24:27], v[168:171]
    s_add_u32 m0, s34, 99328
    v_mfma_f32_16x16x32_bf16 v[172:175], v[60:63], v[24:27], v[172:175]
    buffer_load_dwordx4 v2, s[8:11], s32 offen sc1 lds
    v_mfma_f32_16x16x32_bf16 v[188:191], v[60:63], v[28:31], v[188:191]
    v_mfma_f32_16x16x32_bf16 v[184:187], v[56:59], v[28:31], v[184:187]
    v_mfma_f32_16x16x32_bf16 v[180:183], v[52:55], v[28:31], v[180:183]
    buffer_load_dwordx4 v2, s[8:11], s32 offen offset:1024 sc1 lds
    s_add_u32 s32, s32, 2048
    v_mfma_f32_16x16x32_bf16 v[176:179], v[48:51], v[28:31], v[176:179]
    buffer_load_dwordx4 v[116:119], v2, s[16:19], s47 offen offset:2048
    s_waitcnt vmcnt(11) lgkmcnt(0)
    s_barrier
    v_mfma_f32_16x16x32_bf16 v[192:195], v[48:51], v[32:35], v[192:195]
    ds_read_b64_tr_b16 v[64:65], v8 offset:32768
    v_mfma_f32_16x16x32_bf16 v[196:199], v[52:55], v[32:35], v[196:199]
    ds_read_b64_tr_b16 v[66:67], v8 offset:33792
    v_mfma_f32_16x16x32_bf16 v[200:203], v[56:59], v[32:35], v[200:203]
    ds_read_b64_tr_b16 v[68:69], v11 offset:32768
    v_mfma_f32_16x16x32_bf16 v[204:207], v[60:63], v[32:35], v[204:207]
    ds_read_b64_tr_b16 v[70:71], v11 offset:33792
    v_mfma_f32_16x16x32_bf16 v[220:223], v[60:63], v[36:39], v[220:223]
    ds_read_b64_tr_b16 v[72:73], v8 offset:40960
    v_mfma_f32_16x16x32_bf16 v[216:219], v[56:59], v[36:39], v[216:219]
    ds_read_b64_tr_b16 v[74:75], v8 offset:41984
    v_mfma_f32_16x16x32_bf16 v[212:215], v[52:55], v[36:39], v[212:215]
    ds_read_b64_tr_b16 v[76:77], v11 offset:40960
    v_mfma_f32_16x16x32_bf16 v[208:211], v[48:51], v[36:39], v[208:211]
    ds_read_b64_tr_b16 v[78:79], v11 offset:41984
    v_mfma_f32_16x16x32_bf16 v[224:227], v[48:51], v[40:43], v[224:227]
    ds_read_b128 v[16:19], v5 offset:32768
    v_mfma_f32_16x16x32_bf16 v[228:231], v[52:55], v[40:43], v[228:231]
    ds_read_b128 v[20:23], v5 offset:33792
    v_mfma_f32_16x16x32_bf16 v[232:235], v[56:59], v[40:43], v[232:235]
    ds_read_b128 v[24:27], v5 offset:34816
    v_mfma_f32_16x16x32_bf16 v[236:239], v[60:63], v[40:43], v[236:239]
    ds_read_b128 v[28:31], v5 offset:35840
    v_mfma_f32_16x16x32_bf16 v[252:255], v[60:63], v[44:47], v[252:255]
    v_mfma_f32_16x16x32_bf16 v[248:251], v[56:59], v[44:47], v[248:251]
    v_mfma_f32_16x16x32_bf16 v[244:247], v[52:55], v[44:47], v[244:247]
    v_mfma_f32_16x16x32_bf16 v[240:243], v[48:51], v[44:47], v[240:243]
    s_nop 0
    s_waitcnt lgkmcnt(0)
    v_mfma_f32_16x16x32_bf16 v[128:131], v[64:67], v[16:19], v[128:131]
    ds_read_b128 v[32:35], v5 offset:36864
    v_mfma_f32_16x16x32_bf16 v[132:135], v[68:71], v[16:19], v[132:135]
    ds_read_b128 v[36:39], v5 offset:37888
    v_mfma_f32_16x16x32_bf16 v[136:139], v[72:75], v[16:19], v[136:139]
    ds_read_b128 v[40:43], v5 offset:38912
    v_mfma_f32_16x16x32_bf16 v[140:143], v[76:79], v[16:19], v[140:143]
    ds_read_b128 v[44:47], v5 offset:39936
    v_mfma_f32_16x16x32_bf16 v[156:159], v[76:79], v[20:23], v[156:159]
    s_add_u32 m0, s35, 16384
    v_mfma_f32_16x16x32_bf16 v[152:155], v[72:75], v[20:23], v[152:155]
    buffer_load_dwordx4 v3, s[12:15], s33 offen lds
    v_mfma_f32_16x16x32_bf16 v[148:151], v[68:71], v[20:23], v[148:151]
    v_mfma_f32_16x16x32_bf16 v[144:147], v[64:67], v[20:23], v[144:147]
    s_add_u32 m0, s35, 24576
    v_mfma_f32_16x16x32_bf16 v[160:163], v[64:67], v[24:27], v[160:163]
    buffer_load_dwordx4 v3, s[16:19], s33 offen lds
    s_add_u32 s33, s33, 32*7168
    v_mfma_f32_16x16x32_bf16 v[164:167], v[68:71], v[24:27], v[164:167]
    v_mfma_f32_16x16x32_bf16 v[168:171], v[72:75], v[24:27], v[168:171]
    s_add_u32 m0, s34, 1024
    v_mfma_f32_16x16x32_bf16 v[172:175], v[76:79], v[24:27], v[172:175]
    buffer_load_dwordx4 v2, s[8:11], s32 offen sc1 lds
    v_mfma_f32_16x16x32_bf16 v[188:191], v[76:79], v[28:31], v[188:191]
    v_mfma_f32_16x16x32_bf16 v[184:187], v[72:75], v[28:31], v[184:187]
    v_mfma_f32_16x16x32_bf16 v[180:183], v[68:71], v[28:31], v[180:183]
    buffer_load_dwordx4 v2, s[8:11], s32 offen offset:1024 sc1 lds
    s_add_u32 s32, s32, 2048
    v_mfma_f32_16x16x32_bf16 v[176:179], v[64:67], v[28:31], v[176:179]
    s_waitcnt vmcnt(10) lgkmcnt(0)
    s_barrier
    v_mfma_f32_16x16x32_bf16 v[192:195], v[64:67], v[32:35], v[192:195]
    ds_read_b64_tr_b16 v[48:49], v9 offset:0
    v_mfma_f32_16x16x32_bf16 v[196:199], v[68:71], v[32:35], v[196:199]
    ds_read_b64_tr_b16 v[50:51], v9 offset:1024
    v_mfma_f32_16x16x32_bf16 v[200:203], v[72:75], v[32:35], v[200:203]
    ds_read_b64_tr_b16 v[52:53], v12 offset:0
    v_mfma_f32_16x16x32_bf16 v[204:207], v[76:79], v[32:35], v[204:207]
    ds_read_b64_tr_b16 v[54:55], v12 offset:1024
    v_mfma_f32_16x16x32_bf16 v[220:223], v[76:79], v[36:39], v[220:223]
    ds_read_b64_tr_b16 v[56:57], v9 offset:8192
    v_mfma_f32_16x16x32_bf16 v[216:219], v[72:75], v[36:39], v[216:219]
    ds_read_b64_tr_b16 v[58:59], v9 offset:9216
    v_mfma_f32_16x16x32_bf16 v[212:215], v[68:71], v[36:39], v[212:215]
    ds_read_b64_tr_b16 v[60:61], v12 offset:8192
    v_mfma_f32_16x16x32_bf16 v[208:211], v[64:67], v[36:39], v[208:211]
    ds_read_b64_tr_b16 v[62:63], v12 offset:9216
    v_mfma_f32_16x16x32_bf16 v[224:227], v[64:67], v[40:43], v[224:227]
    ds_read_b128 v[16:19], v6 offset:0
    v_mfma_f32_16x16x32_bf16 v[228:231], v[68:71], v[40:43], v[228:231]
    ds_read_b128 v[20:23], v6 offset:1024
    v_mfma_f32_16x16x32_bf16 v[232:235], v[72:75], v[40:43], v[232:235]
    ds_read_b128 v[24:27], v6 offset:2048
    v_mfma_f32_16x16x32_bf16 v[236:239], v[76:79], v[40:43], v[236:239]
    ds_read_b128 v[28:31], v6 offset:3072
    v_mfma_f32_16x16x32_bf16 v[252:255], v[76:79], v[44:47], v[252:255]
    v_mfma_f32_16x16x32_bf16 v[248:251], v[72:75], v[44:47], v[248:251]
    v_mfma_f32_16x16x32_bf16 v[244:247], v[68:71], v[44:47], v[244:247]
    v_mfma_f32_16x16x32_bf16 v[240:243], v[64:67], v[44:47], v[240:243]
    s_nop 0
    s_waitcnt lgkmcnt(0)
    v_mfma_f32_16x16x32_bf16 v[128:131], v[48:51], v[16:19], v[128:131]
    ds_read_b128 v[32:35], v6 offset:4096
    v_mfma_f32_16x16x32_bf16 v[132:135], v[52:55], v[16:19], v[132:135]
    ds_read_b128 v[36:39], v6 offset:5120
    v_mfma_f32_16x16x32_bf16 v[136:139], v[56:59], v[16:19], v[136:139]
    ds_read_b128 v[40:43], v6 offset:6144
    v_mfma_f32_16x16x32_bf16 v[140:143], v[60:63], v[16:19], v[140:143]
    ds_read_b128 v[44:47], v6 offset:7168
    v_mfma_f32_16x16x32_bf16 v[156:159], v[60:63], v[20:23], v[156:159]
    s_add_u32 m0, s35, 49152
    v_mfma_f32_16x16x32_bf16 v[152:155], v[56:59], v[20:23], v[152:155]
    buffer_load_dwordx4 v3, s[12:15], s33 offen lds
    v_mfma_f32_16x16x32_bf16 v[148:151], v[52:55], v[20:23], v[148:151]
    v_mfma_f32_16x16x32_bf16 v[144:147], v[48:51], v[20:23], v[144:147]
    s_add_u32 m0, s35, 57344
    v_mfma_f32_16x16x32_bf16 v[160:163], v[48:51], v[24:27], v[160:163]
    buffer_load_dwordx4 v3, s[16:19], s33 offen lds
    s_add_u32 s33, s33, 32*7168
    v_mfma_f32_16x16x32_bf16 v[164:167], v[52:55], v[24:27], v[164:167]
    v_mfma_f32_16x16x32_bf16 v[168:171], v[56:59], v[24:27], v[168:171]
    s_add_u32 m0, s34, 33792
    v_mfma_f32_16x16x32_bf16 v[172:175], v[60:63], v[24:27], v[172:175]
    buffer_load_dwordx4 v2, s[8:11], s32 offen sc1 lds
    v_mfma_f32_16x16x32_bf16 v[188:191], v[60:63], v[28:31], v[188:191]
    v_mfma_f32_16x16x32_bf16 v[184:187], v[56:59], v[28:31], v[184:187]
    v_mfma_f32_16x16x32_bf16 v[180:183], v[52:55], v[28:31], v[180:183]
    buffer_load_dwordx4 v2, s[8:11], s32 offen offset:1024 sc1 lds
    s_add_u32 s32, s32, 2048
    v_mfma_f32_16x16x32_bf16 v[176:179], v[48:51], v[28:31], v[176:179]
    s_waitcnt vmcnt(9) lgkmcnt(0)
    s_barrier
    v_mfma_f32_16x16x32_bf16 v[192:195], v[48:51], v[32:35], v[192:195]
    ds_read_b64_tr_b16 v[64:65], v9 offset:32768
    v_mfma_f32_16x16x32_bf16 v[196:199], v[52:55], v[32:35], v[196:199]
    ds_read_b64_tr_b16 v[66:67], v9 offset:33792
    v_mfma_f32_16x16x32_bf16 v[200:203], v[56:59], v[32:35], v[200:203]
    ds_read_b64_tr_b16 v[68:69], v12 offset:32768
    v_mfma_f32_16x16x32_bf16 v[204:207], v[60:63], v[32:35], v[204:207]
    ds_read_b64_tr_b16 v[70:71], v12 offset:33792
    v_mfma_f32_16x16x32_bf16 v[220:223], v[60:63], v[36:39], v[220:223]
    ds_read_b64_tr_b16 v[72:73], v9 offset:40960
    v_mfma_f32_16x16x32_bf16 v[216:219], v[56:59], v[36:39], v[216:219]
    ds_read_b64_tr_b16 v[74:75], v9 offset:41984
    v_mfma_f32_16x16x32_bf16 v[212:215], v[52:55], v[36:39], v[212:215]
    ds_read_b64_tr_b16 v[76:77], v12 offset:40960
    v_mfma_f32_16x16x32_bf16 v[208:211], v[48:51], v[36:39], v[208:211]
    ds_read_b64_tr_b16 v[78:79], v12 offset:41984
    v_mfma_f32_16x16x32_bf16 v[224:227], v[48:51], v[40:43], v[224:227]
    ds_read_b128 v[16:19], v6 offset:32768
    v_mfma_f32_16x16x32_bf16 v[228:231], v[52:55], v[40:43], v[228:231]
    ds_read_b128 v[20:23], v6 offset:33792
    v_mfma_f32_16x16x32_bf16 v[232:235], v[56:59], v[40:43], v[232:235]
    ds_read_b128 v[24:27], v6 offset:34816
    v_mfma_f32_16x16x32_bf16 v[236:239], v[60:63], v[40:43], v[236:239]
    ds_read_b128 v[28:31], v6 offset:35840
    v_mfma_f32_16x16x32_bf16 v[252:255], v[60:63], v[44:47], v[252:255]
    v_mfma_f32_16x16x32_bf16 v[248:251], v[56:59], v[44:47], v[248:251]
    v_mfma_f32_16x16x32_bf16 v[244:247], v[52:55], v[44:47], v[244:247]
    v_mfma_f32_16x16x32_bf16 v[240:243], v[48:51], v[44:47], v[240:243]
    s_nop 0
    s_waitcnt lgkmcnt(0)
    v_mfma_f32_16x16x32_bf16 v[128:131], v[64:67], v[16:19], v[128:131]
    ds_read_b128 v[32:35], v6 offset:36864
    v_mfma_f32_16x16x32_bf16 v[132:135], v[68:71], v[16:19], v[132:135]
    ds_read_b128 v[36:39], v6 offset:37888
    v_mfma_f32_16x16x32_bf16 v[136:139], v[72:75], v[16:19], v[136:139]
    ds_read_b128 v[40:43], v6 offset:38912
    v_mfma_f32_16x16x32_bf16 v[140:143], v[76:79], v[16:19], v[140:143]
    ds_read_b128 v[44:47], v6 offset:39936
    v_mfma_f32_16x16x32_bf16 v[156:159], v[76:79], v[20:23], v[156:159]
    s_add_u32 m0, s35, 81920
    v_mfma_f32_16x16x32_bf16 v[152:155], v[72:75], v[20:23], v[152:155]
    buffer_load_dwordx4 v3, s[12:15], s33 offen lds
    v_mfma_f32_16x16x32_bf16 v[148:151], v[68:71], v[20:23], v[148:151]
    v_mfma_f32_16x16x32_bf16 v[144:147], v[64:67], v[20:23], v[144:147]
    s_add_u32 m0, s35, 90112
    v_mfma_f32_16x16x32_bf16 v[160:163], v[64:67], v[24:27], v[160:163]
    buffer_load_dwordx4 v3, s[16:19], s33 offen lds
    s_add_u32 s33, s33, 32*7168
    v_mfma_f32_16x16x32_bf16 v[164:167], v[68:71], v[24:27], v[164:167]
    v_mfma_f32_16x16x32_bf16 v[168:171], v[72:75], v[24:27], v[168:171]
    s_add_u32 m0, s34, 66560
    v_mfma_f32_16x16x32_bf16 v[172:175], v[76:79], v[24:27], v[172:175]
    buffer_load_dwordx4 v2, s[8:11], s32 offen sc1 lds
    v_mfma_f32_16x16x32_bf16 v[188:191], v[76:79], v[28:31], v[188:191]
    v_mfma_f32_16x16x32_bf16 v[184:187], v[72:75], v[28:31], v[184:187]
    v_mfma_f32_16x16x32_bf16 v[180:183], v[68:71], v[28:31], v[180:183]
    buffer_load_dwordx4 v2, s[8:11], s32 offen offset:1024 sc1 lds
    s_add_u32 s32, s32, 2048
    v_mfma_f32_16x16x32_bf16 v[176:179], v[64:67], v[28:31], v[176:179]
    buffer_load_dwordx4 v[96:99], v14, s[24:27], s56 offen offset:0
    s_waitcnt vmcnt(9) lgkmcnt(0)
    s_barrier
    v_mfma_f32_16x16x32_bf16 v[192:195], v[64:67], v[32:35], v[192:195]
    ds_read_b64_tr_b16 v[48:49], v8 offset:0
    v_mfma_f32_16x16x32_bf16 v[196:199], v[68:71], v[32:35], v[196:199]
    ds_read_b64_tr_b16 v[50:51], v8 offset:1024
    v_mfma_f32_16x16x32_bf16 v[200:203], v[72:75], v[32:35], v[200:203]
    ds_read_b64_tr_b16 v[52:53], v11 offset:0
    v_mfma_f32_16x16x32_bf16 v[204:207], v[76:79], v[32:35], v[204:207]
    ds_read_b64_tr_b16 v[54:55], v11 offset:1024
    v_mfma_f32_16x16x32_bf16 v[220:223], v[76:79], v[36:39], v[220:223]
    ds_read_b64_tr_b16 v[56:57], v8 offset:8192
    v_mfma_f32_16x16x32_bf16 v[216:219], v[72:75], v[36:39], v[216:219]
    ds_read_b64_tr_b16 v[58:59], v8 offset:9216
    v_mfma_f32_16x16x32_bf16 v[212:215], v[68:71], v[36:39], v[212:215]
    ds_read_b64_tr_b16 v[60:61], v11 offset:8192
    v_mfma_f32_16x16x32_bf16 v[208:211], v[64:67], v[36:39], v[208:211]
    ds_read_b64_tr_b16 v[62:63], v11 offset:9216
    v_mfma_f32_16x16x32_bf16 v[224:227], v[64:67], v[40:43], v[224:227]
    ds_read_b128 v[16:19], v5 offset:0
    v_mfma_f32_16x16x32_bf16 v[228:231], v[68:71], v[40:43], v[228:231]
    ds_read_b128 v[20:23], v5 offset:1024
    v_mfma_f32_16x16x32_bf16 v[232:235], v[72:75], v[40:43], v[232:235]
    ds_read_b128 v[24:27], v5 offset:2048
    v_mfma_f32_16x16x32_bf16 v[236:239], v[76:79], v[40:43], v[236:239]
    ds_read_b128 v[28:31], v5 offset:3072
    v_mfma_f32_16x16x32_bf16 v[252:255], v[76:79], v[44:47], v[252:255]
    v_mfma_f32_16x16x32_bf16 v[248:251], v[72:75], v[44:47], v[248:251]
    v_mfma_f32_16x16x32_bf16 v[244:247], v[68:71], v[44:47], v[244:247]
    v_mfma_f32_16x16x32_bf16 v[240:243], v[64:67], v[44:47], v[240:243]
    s_nop 0
    s_waitcnt lgkmcnt(0)
    v_mfma_f32_16x16x32_bf16 v[128:131], v[48:51], v[16:19], v[128:131]
    ds_read_b128 v[32:35], v5 offset:4096
    v_mfma_f32_16x16x32_bf16 v[132:135], v[52:55], v[16:19], v[132:135]
    ds_read_b128 v[36:39], v5 offset:5120
    v_mfma_f32_16x16x32_bf16 v[136:139], v[56:59], v[16:19], v[136:139]
    ds_read_b128 v[40:43], v5 offset:6144
    v_mfma_f32_16x16x32_bf16 v[140:143], v[60:63], v[16:19], v[140:143]
    ds_read_b128 v[44:47], v5 offset:7168
    v_mfma_f32_16x16x32_bf16 v[156:159], v[60:63], v[20:23], v[156:159]
    s_add_u32 m0, s35, 114688
    v_mfma_f32_16x16x32_bf16 v[152:155], v[56:59], v[20:23], v[152:155]
    buffer_load_dwordx4 v3, s[12:15], s33 offen lds
    v_mfma_f32_16x16x32_bf16 v[148:151], v[52:55], v[20:23], v[148:151]
    v_mfma_f32_16x16x32_bf16 v[144:147], v[48:51], v[20:23], v[144:147]
    s_add_u32 m0, s35, 122880
    v_mfma_f32_16x16x32_bf16 v[160:163], v[48:51], v[24:27], v[160:163]
    buffer_load_dwordx4 v3, s[16:19], s33 offen lds
    s_add_u32 s33, s33, 32*7168
    v_mfma_f32_16x16x32_bf16 v[164:167], v[52:55], v[24:27], v[164:167]
    v_mfma_f32_16x16x32_bf16 v[168:171], v[56:59], v[24:27], v[168:171]
    s_add_u32 m0, s34, 99328
    v_mfma_f32_16x16x32_bf16 v[172:175], v[60:63], v[24:27], v[172:175]
    buffer_load_dwordx4 v2, s[8:11], s32 offen sc1 lds
    v_mfma_f32_16x16x32_bf16 v[188:191], v[60:63], v[28:31], v[188:191]
    v_mfma_f32_16x16x32_bf16 v[184:187], v[56:59], v[28:31], v[184:187]
    v_mfma_f32_16x16x32_bf16 v[180:183], v[52:55], v[28:31], v[180:183]
    buffer_load_dwordx4 v2, s[8:11], s32 offen offset:1024 sc1 lds
    s_add_u32 s32, s32, 2048
    v_mfma_f32_16x16x32_bf16 v[176:179], v[48:51], v[28:31], v[176:179]
    buffer_load_dwordx4 v[100:103], v14, s[24:27], s56 offen offset:128
    s_waitcnt vmcnt(10) lgkmcnt(0)
    s_barrier
    v_mfma_f32_16x16x32_bf16 v[192:195], v[48:51], v[32:35], v[192:195]
    ds_read_b64_tr_b16 v[64:65], v8 offset:32768
    v_mfma_f32_16x16x32_bf16 v[196:199], v[52:55], v[32:35], v[196:199]
    ds_read_b64_tr_b16 v[66:67], v8 offset:33792
    v_mfma_f32_16x16x32_bf16 v[200:203], v[56:59], v[32:35], v[200:203]
    ds_read_b64_tr_b16 v[68:69], v11 offset:32768
    v_mfma_f32_16x16x32_bf16 v[204:207], v[60:63], v[32:35], v[204:207]
    ds_read_b64_tr_b16 v[70:71], v11 offset:33792
    v_mfma_f32_16x16x32_bf16 v[220:223], v[60:63], v[36:39], v[220:223]
    ds_read_b64_tr_b16 v[72:73], v8 offset:40960
    v_mfma_f32_16x16x32_bf16 v[216:219], v[56:59], v[36:39], v[216:219]
    ds_read_b64_tr_b16 v[74:75], v8 offset:41984
    v_mfma_f32_16x16x32_bf16 v[212:215], v[52:55], v[36:39], v[212:215]
    ds_read_b64_tr_b16 v[76:77], v11 offset:40960
    v_mfma_f32_16x16x32_bf16 v[208:211], v[48:51], v[36:39], v[208:211]
    ds_read_b64_tr_b16 v[78:79], v11 offset:41984
    v_mfma_f32_16x16x32_bf16 v[224:227], v[48:51], v[40:43], v[224:227]
    ds_read_b128 v[16:19], v5 offset:32768
    v_mfma_f32_16x16x32_bf16 v[228:231], v[52:55], v[40:43], v[228:231]
    ds_read_b128 v[20:23], v5 offset:33792
    v_mfma_f32_16x16x32_bf16 v[232:235], v[56:59], v[40:43], v[232:235]
    ds_read_b128 v[24:27], v5 offset:34816
    v_mfma_f32_16x16x32_bf16 v[236:239], v[60:63], v[40:43], v[236:239]
    ds_read_b128 v[28:31], v5 offset:35840
    v_mfma_f32_16x16x32_bf16 v[252:255], v[60:63], v[44:47], v[252:255]
    v_mfma_f32_16x16x32_bf16 v[248:251], v[56:59], v[44:47], v[248:251]
    v_mfma_f32_16x16x32_bf16 v[244:247], v[52:55], v[44:47], v[244:247]
    v_mfma_f32_16x16x32_bf16 v[240:243], v[48:51], v[44:47], v[240:243]
    s_nop 0
    s_waitcnt lgkmcnt(0)
    v_mfma_f32_16x16x32_bf16 v[128:131], v[64:67], v[16:19], v[128:131]
    ds_read_b128 v[32:35], v5 offset:36864
    v_mfma_f32_16x16x32_bf16 v[132:135], v[68:71], v[16:19], v[132:135]
    ds_read_b128 v[36:39], v5 offset:37888
    v_mfma_f32_16x16x32_bf16 v[136:139], v[72:75], v[16:19], v[136:139]
    ds_read_b128 v[40:43], v5 offset:38912
    v_mfma_f32_16x16x32_bf16 v[140:143], v[76:79], v[16:19], v[140:143]
    ds_read_b128 v[44:47], v5 offset:39936
    v_mfma_f32_16x16x32_bf16 v[156:159], v[76:79], v[20:23], v[156:159]
    s_add_u32 m0, s35, 16384
    v_mfma_f32_16x16x32_bf16 v[152:155], v[72:75], v[20:23], v[152:155]
    buffer_load_dwordx4 v3, s[12:15], s33 offen lds
    v_mfma_f32_16x16x32_bf16 v[148:151], v[68:71], v[20:23], v[148:151]
    v_mfma_f32_16x16x32_bf16 v[144:147], v[64:67], v[20:23], v[144:147]
    s_add_u32 m0, s35, 24576
    v_mfma_f32_16x16x32_bf16 v[160:163], v[64:67], v[24:27], v[160:163]
    buffer_load_dwordx4 v3, s[16:19], s33 offen lds
    s_add_u32 s33, s33, 32*7168
    v_mfma_f32_16x16x32_bf16 v[164:167], v[68:71], v[24:27], v[164:167]
    v_mfma_f32_16x16x32_bf16 v[168:171], v[72:75], v[24:27], v[168:171]
    s_add_u32 m0, s34, 1024
    v_mfma_f32_16x16x32_bf16 v[172:175], v[76:79], v[24:27], v[172:175]
    buffer_load_dwordx4 v2, s[8:11], s32 offen sc1 lds
    v_mfma_f32_16x16x32_bf16 v[188:191], v[76:79], v[28:31], v[188:191]
    v_mfma_f32_16x16x32_bf16 v[184:187], v[72:75], v[28:31], v[184:187]
    v_mfma_f32_16x16x32_bf16 v[180:183], v[68:71], v[28:31], v[180:183]
    buffer_load_dwordx4 v2, s[8:11], s32 offen offset:1024 sc1 lds
    s_add_u32 s32, s32, 2048
    v_mfma_f32_16x16x32_bf16 v[176:179], v[64:67], v[28:31], v[176:179]
    buffer_load_dwordx4 v[104:107], v14, s[24:27], s56 offen offset:256
    s_waitcnt vmcnt(11) lgkmcnt(0)
    s_barrier
    v_mfma_f32_16x16x32_bf16 v[192:195], v[64:67], v[32:35], v[192:195]
    ds_read_b64_tr_b16 v[48:49], v9 offset:0
    v_mfma_f32_16x16x32_bf16 v[196:199], v[68:71], v[32:35], v[196:199]
    ds_read_b64_tr_b16 v[50:51], v9 offset:1024
    v_mfma_f32_16x16x32_bf16 v[200:203], v[72:75], v[32:35], v[200:203]
    ds_read_b64_tr_b16 v[52:53], v12 offset:0
    v_mfma_f32_16x16x32_bf16 v[204:207], v[76:79], v[32:35], v[204:207]
    ds_read_b64_tr_b16 v[54:55], v12 offset:1024
    v_mfma_f32_16x16x32_bf16 v[220:223], v[76:79], v[36:39], v[220:223]
    ds_read_b64_tr_b16 v[56:57], v9 offset:8192
    v_mfma_f32_16x16x32_bf16 v[216:219], v[72:75], v[36:39], v[216:219]
    ds_read_b64_tr_b16 v[58:59], v9 offset:9216
    v_mfma_f32_16x16x32_bf16 v[212:215], v[68:71], v[36:39], v[212:215]
    ds_read_b64_tr_b16 v[60:61], v12 offset:8192
    v_mfma_f32_16x16x32_bf16 v[208:211], v[64:67], v[36:39], v[208:211]
    ds_read_b64_tr_b16 v[62:63], v12 offset:9216
    v_mfma_f32_16x16x32_bf16 v[224:227], v[64:67], v[40:43], v[224:227]
    ds_read_b128 v[16:19], v6 offset:0
    v_mfma_f32_16x16x32_bf16 v[228:231], v[68:71], v[40:43], v[228:231]
    ds_read_b128 v[20:23], v6 offset:1024
    v_mfma_f32_16x16x32_bf16 v[232:235], v[72:75], v[40:43], v[232:235]
    ds_read_b128 v[24:27], v6 offset:2048
    v_mfma_f32_16x16x32_bf16 v[236:239], v[76:79], v[40:43], v[236:239]
    ds_read_b128 v[28:31], v6 offset:3072
    v_mfma_f32_16x16x32_bf16 v[252:255], v[76:79], v[44:47], v[252:255]
    v_mfma_f32_16x16x32_bf16 v[248:251], v[72:75], v[44:47], v[248:251]
    v_mfma_f32_16x16x32_bf16 v[244:247], v[68:71], v[44:47], v[244:247]
    v_mfma_f32_16x16x32_bf16 v[240:243], v[64:67], v[44:47], v[240:243]
    s_nop 0
    s_waitcnt lgkmcnt(0)
    v_mfma_f32_16x16x32_bf16 v[128:131], v[48:51], v[16:19], v[128:131]
    ds_read_b128 v[32:35], v6 offset:4096
    v_mfma_f32_16x16x32_bf16 v[132:135], v[52:55], v[16:19], v[132:135]
    ds_read_b128 v[36:39], v6 offset:5120
    v_mfma_f32_16x16x32_bf16 v[136:139], v[56:59], v[16:19], v[136:139]
    ds_read_b128 v[40:43], v6 offset:6144
    v_mfma_f32_16x16x32_bf16 v[140:143], v[60:63], v[16:19], v[140:143]
    ds_read_b128 v[44:47], v6 offset:7168
    v_mfma_f32_16x16x32_bf16 v[156:159], v[60:63], v[20:23], v[156:159]
    s_add_u32 m0, s35, 49152
    v_mfma_f32_16x16x32_bf16 v[152:155], v[56:59], v[20:23], v[152:155]
    buffer_load_dwordx4 v3, s[12:15], s33 offen lds
    v_mfma_f32_16x16x32_bf16 v[148:151], v[52:55], v[20:23], v[148:151]
    v_mfma_f32_16x16x32_bf16 v[144:147], v[48:51], v[20:23], v[144:147]
    s_add_u32 m0, s35, 57344
    v_mfma_f32_16x16x32_bf16 v[160:163], v[48:51], v[24:27], v[160:163]
    buffer_load_dwordx4 v3, s[16:19], s33 offen lds
    s_add_u32 s33, s33, 32*7168
    v_mfma_f32_16x16x32_bf16 v[164:167], v[52:55], v[24:27], v[164:167]
    v_mfma_f32_16x16x32_bf16 v[168:171], v[56:59], v[24:27], v[168:171]
    s_add_u32 m0, s34, 33792
    v_mfma_f32_16x16x32_bf16 v[172:175], v[60:63], v[24:27], v[172:175]
    buffer_load_dwordx4 v2, s[8:11], s32 offen sc1 lds
    v_mfma_f32_16x16x32_bf16 v[188:191], v[60:63], v[28:31], v[188:191]
    v_mfma_f32_16x16x32_bf16 v[184:187], v[56:59], v[28:31], v[184:187]
    v_mfma_f32_16x16x32_bf16 v[180:183], v[52:55], v[28:31], v[180:183]
    buffer_load_dwordx4 v2, s[8:11], s32 offen offset:1024 sc1 lds
    s_add_u32 s32, s32, 2048
    v_mfma_f32_16x16x32_bf16 v[176:179], v[48:51], v[28:31], v[176:179]
    buffer_load_dwordx4 v[108:111], v14, s[24:27], s56 offen offset:384
    s_waitcnt vmcnt(11) lgkmcnt(0)
    s_barrier
    v_mfma_f32_16x16x32_bf16 v[192:195], v[48:51], v[32:35], v[192:195]
    ds_read_b64_tr_b16 v[64:65], v9 offset:32768
    v_mfma_f32_16x16x32_bf16 v[196:199], v[52:55], v[32:35], v[196:199]
    ds_read_b64_tr_b16 v[66:67], v9 offset:33792
    v_mfma_f32_16x16x32_bf16 v[200:203], v[56:59], v[32:35], v[200:203]
    ds_read_b64_tr_b16 v[68:69], v12 offset:32768
    v_mfma_f32_16x16x32_bf16 v[204:207], v[60:63], v[32:35], v[204:207]
    ds_read_b64_tr_b16 v[70:71], v12 offset:33792
    v_mfma_f32_16x16x32_bf16 v[220:223], v[60:63], v[36:39], v[220:223]
    ds_read_b64_tr_b16 v[72:73], v9 offset:40960
    v_mfma_f32_16x16x32_bf16 v[216:219], v[56:59], v[36:39], v[216:219]
    ds_read_b64_tr_b16 v[74:75], v9 offset:41984
    v_mfma_f32_16x16x32_bf16 v[212:215], v[52:55], v[36:39], v[212:215]
    ds_read_b64_tr_b16 v[76:77], v12 offset:40960
    v_mfma_f32_16x16x32_bf16 v[208:211], v[48:51], v[36:39], v[208:211]
    ds_read_b64_tr_b16 v[78:79], v12 offset:41984
    v_mfma_f32_16x16x32_bf16 v[224:227], v[48:51], v[40:43], v[224:227]
    ds_read_b128 v[16:19], v6 offset:32768
    v_mfma_f32_16x16x32_bf16 v[228:231], v[52:55], v[40:43], v[228:231]
    ds_read_b128 v[20:23], v6 offset:33792
    v_mfma_f32_16x16x32_bf16 v[232:235], v[56:59], v[40:43], v[232:235]
    ds_read_b128 v[24:27], v6 offset:34816
    v_mfma_f32_16x16x32_bf16 v[236:239], v[60:63], v[40:43], v[236:239]
    ds_read_b128 v[28:31], v6 offset:35840
    v_mfma_f32_16x16x32_bf16 v[252:255], v[60:63], v[44:47], v[252:255]
    v_mfma_f32_16x16x32_bf16 v[248:251], v[56:59], v[44:47], v[248:251]
    v_mfma_f32_16x16x32_bf16 v[244:247], v[52:55], v[44:47], v[244:247]
    v_mfma_f32_16x16x32_bf16 v[240:243], v[48:51], v[44:47], v[240:243]
    s_nop 0
    s_waitcnt lgkmcnt(0)
    v_mfma_f32_16x16x32_bf16 v[128:131], v[64:67], v[16:19], v[128:131]
    ds_read_b128 v[32:35], v6 offset:36864
    v_mfma_f32_16x16x32_bf16 v[132:135], v[68:71], v[16:19], v[132:135]
    ds_read_b128 v[36:39], v6 offset:37888
    v_mfma_f32_16x16x32_bf16 v[136:139], v[72:75], v[16:19], v[136:139]
    ds_read_b128 v[40:43], v6 offset:38912
    v_mfma_f32_16x16x32_bf16 v[140:143], v[76:79], v[16:19], v[140:143]
    ds_read_b128 v[44:47], v6 offset:39936
    v_mfma_f32_16x16x32_bf16 v[156:159], v[76:79], v[20:23], v[156:159]
    s_add_u32 m0, s35, 81920
    v_mfma_f32_16x16x32_bf16 v[152:155], v[72:75], v[20:23], v[152:155]
    buffer_load_dwordx4 v3, s[12:15], s33 offen lds
    v_mfma_f32_16x16x32_bf16 v[148:151], v[68:71], v[20:23], v[148:151]
    v_mfma_f32_16x16x32_bf16 v[144:147], v[64:67], v[20:23], v[144:147]
    s_add_u32 m0, s35, 90112
    v_mfma_f32_16x16x32_bf16 v[160:163], v[64:67], v[24:27], v[160:163]
    buffer_load_dwordx4 v3, s[16:19], s33 offen lds
    s_add_u32 s33, s33, 32*7168
    v_mfma_f32_16x16x32_bf16 v[164:167], v[68:71], v[24:27], v[164:167]
    v_mfma_f32_16x16x32_bf16 v[168:171], v[72:75], v[24:27], v[168:171]
    s_add_u32 m0, s34, 66560
    v_mfma_f32_16x16x32_bf16 v[172:175], v[76:79], v[24:27], v[172:175]
    buffer_load_dwordx4 v2, s[8:11], s32 offen sc1 lds
    v_mfma_f32_16x16x32_bf16 v[188:191], v[76:79], v[28:31], v[188:191]
    v_mfma_f32_16x16x32_bf16 v[184:187], v[72:75], v[28:31], v[184:187]
    v_mfma_f32_16x16x32_bf16 v[180:183], v[68:71], v[28:31], v[180:183]
    buffer_load_dwordx4 v2, s[8:11], s32 offen offset:1024 sc1 lds
    s_add_u32 s32, s32, 2048
    v_mfma_f32_16x16x32_bf16 v[176:179], v[64:67], v[28:31], v[176:179]
    buffer_store_dwordx4 v[96:99], v2, s[52:55], s57 offen sc1
    s_add_u32 s57, s57, 458752
    s_waitcnt vmcnt(11) lgkmcnt(0)
    s_barrier
    v_mfma_f32_16x16x32_bf16 v[192:195], v[64:67], v[32:35], v[192:195]
    ds_read_b64_tr_b16 v[48:49], v8 offset:0
    v_mfma_f32_16x16x32_bf16 v[196:199], v[68:71], v[32:35], v[196:199]
    ds_read_b64_tr_b16 v[50:51], v8 offset:1024
    v_mfma_f32_16x16x32_bf16 v[200:203], v[72:75], v[32:35], v[200:203]
    ds_read_b64_tr_b16 v[52:53], v11 offset:0
    v_mfma_f32_16x16x32_bf16 v[204:207], v[76:79], v[32:35], v[204:207]
    ds_read_b64_tr_b16 v[54:55], v11 offset:1024
    v_mfma_f32_16x16x32_bf16 v[220:223], v[76:79], v[36:39], v[220:223]
    ds_read_b64_tr_b16 v[56:57], v8 offset:8192
    v_mfma_f32_16x16x32_bf16 v[216:219], v[72:75], v[36:39], v[216:219]
    ds_read_b64_tr_b16 v[58:59], v8 offset:9216
    v_mfma_f32_16x16x32_bf16 v[212:215], v[68:71], v[36:39], v[212:215]
    ds_read_b64_tr_b16 v[60:61], v11 offset:8192
    v_mfma_f32_16x16x32_bf16 v[208:211], v[64:67], v[36:39], v[208:211]
    ds_read_b64_tr_b16 v[62:63], v11 offset:9216
    v_mfma_f32_16x16x32_bf16 v[224:227], v[64:67], v[40:43], v[224:227]
    ds_read_b128 v[16:19], v5 offset:0
    v_mfma_f32_16x16x32_bf16 v[228:231], v[68:71], v[40:43], v[228:231]
    ds_read_b128 v[20:23], v5 offset:1024
    v_mfma_f32_16x16x32_bf16 v[232:235], v[72:75], v[40:43], v[232:235]
    ds_read_b128 v[24:27], v5 offset:2048
    v_mfma_f32_16x16x32_bf16 v[236:239], v[76:79], v[40:43], v[236:239]
    ds_read_b128 v[28:31], v5 offset:3072
    v_mfma_f32_16x16x32_bf16 v[252:255], v[76:79], v[44:47], v[252:255]
    v_mfma_f32_16x16x32_bf16 v[248:251], v[72:75], v[44:47], v[248:251]
    v_mfma_f32_16x16x32_bf16 v[244:247], v[68:71], v[44:47], v[244:247]
    v_mfma_f32_16x16x32_bf16 v[240:243], v[64:67], v[44:47], v[240:243]
    s_nop 0
    s_waitcnt lgkmcnt(0)
    v_mfma_f32_16x16x32_bf16 v[128:131], v[48:51], v[16:19], v[128:131]
    ds_read_b128 v[32:35], v5 offset:4096
    v_mfma_f32_16x16x32_bf16 v[132:135], v[52:55], v[16:19], v[132:135]
    ds_read_b128 v[36:39], v5 offset:5120
    v_mfma_f32_16x16x32_bf16 v[136:139], v[56:59], v[16:19], v[136:139]
    ds_read_b128 v[40:43], v5 offset:6144
    v_mfma_f32_16x16x32_bf16 v[140:143], v[60:63], v[16:19], v[140:143]
    ds_read_b128 v[44:47], v5 offset:7168
    v_mfma_f32_16x16x32_bf16 v[156:159], v[60:63], v[20:23], v[156:159]
    s_add_u32 m0, s35, 114688
    v_mfma_f32_16x16x32_bf16 v[152:155], v[56:59], v[20:23], v[152:155]
    buffer_load_dwordx4 v3, s[12:15], s33 offen lds
    v_mfma_f32_16x16x32_bf16 v[148:151], v[52:55], v[20:23], v[148:151]
    v_mfma_f32_16x16x32_bf16 v[144:147], v[48:51], v[20:23], v[144:147]
    s_add_u32 m0, s35, 122880
    v_mfma_f32_16x16x32_bf16 v[160:163], v[48:51], v[24:27], v[160:163]
    buffer_load_dwordx4 v3, s[16:19], s33 offen lds
    s_add_u32 s33, s33, 32*7168
    v_mfma_f32_16x16x32_bf16 v[164:167], v[52:55], v[24:27], v[164:167]
    v_mfma_f32_16x16x32_bf16 v[168:171], v[56:59], v[24:27], v[168:171]
    s_add_u32 m0, s34, 99328
    v_mfma_f32_16x16x32_bf16 v[172:175], v[60:63], v[24:27], v[172:175]
    buffer_load_dwordx4 v2, s[8:11], s32 offen sc1 lds
    v_mfma_f32_16x16x32_bf16 v[188:191], v[60:63], v[28:31], v[188:191]
    v_mfma_f32_16x16x32_bf16 v[184:187], v[56:59], v[28:31], v[184:187]
    v_mfma_f32_16x16x32_bf16 v[180:183], v[52:55], v[28:31], v[180:183]
    buffer_load_dwordx4 v2, s[8:11], s32 offen offset:1024 sc1 lds
    s_add_u32 s32, s32, 2048
    v_mfma_f32_16x16x32_bf16 v[176:179], v[48:51], v[28:31], v[176:179]
    buffer_store_dwordx4 v[100:103], v2, s[52:55], s57 offen sc1
    s_add_u32 s57, s57, 458752
    s_waitcnt vmcnt(11) lgkmcnt(0)
    s_barrier
    v_mfma_f32_16x16x32_bf16 v[192:195], v[48:51], v[32:35], v[192:195]
    ds_read_b64_tr_b16 v[64:65], v8 offset:32768
    v_mfma_f32_16x16x32_bf16 v[196:199], v[52:55], v[32:35], v[196:199]
    ds_read_b64_tr_b16 v[66:67], v8 offset:33792
    v_mfma_f32_16x16x32_bf16 v[200:203], v[56:59], v[32:35], v[200:203]
    ds_read_b64_tr_b16 v[68:69], v11 offset:32768
    v_mfma_f32_16x16x32_bf16 v[204:207], v[60:63], v[32:35], v[204:207]
    ds_read_b64_tr_b16 v[70:71], v11 offset:33792
    v_mfma_f32_16x16x32_bf16 v[220:223], v[60:63], v[36:39], v[220:223]
    ds_read_b64_tr_b16 v[72:73], v8 offset:40960
    v_mfma_f32_16x16x32_bf16 v[216:219], v[56:59], v[36:39], v[216:219]
    ds_read_b64_tr_b16 v[74:75], v8 offset:41984
    v_mfma_f32_16x16x32_bf16 v[212:215], v[52:55], v[36:39], v[212:215]
    ds_read_b64_tr_b16 v[76:77], v11 offset:40960
    v_mfma_f32_16x16x32_bf16 v[208:211], v[48:51], v[36:39], v[208:211]
    ds_read_b64_tr_b16 v[78:79], v11 offset:41984
    v_mfma_f32_16x16x32_bf16 v[224:227], v[48:51], v[40:43], v[224:227]
    ds_read_b128 v[16:19], v5 offset:32768
    v_mfma_f32_16x16x32_bf16 v[228:231], v[52:55], v[40:43], v[228:231]
    ds_read_b128 v[20:23], v5 offset:33792
    v_mfma_f32_16x16x32_bf16 v[232:235], v[56:59], v[40:43], v[232:235]
    ds_read_b128 v[24:27], v5 offset:34816
    v_mfma_f32_16x16x32_bf16 v[236:239], v[60:63], v[40:43], v[236:239]
    ds_read_b128 v[28:31], v5 offset:35840
    v_mfma_f32_16x16x32_bf16 v[252:255], v[60:63], v[44:47], v[252:255]
    v_mfma_f32_16x16x32_bf16 v[248:251], v[56:59], v[44:47], v[248:251]
    v_mfma_f32_16x16x32_bf16 v[244:247], v[52:55], v[44:47], v[244:247]
    v_mfma_f32_16x16x32_bf16 v[240:243], v[48:51], v[44:47], v[240:243]
    s_nop 0
    s_waitcnt lgkmcnt(0)
    v_mfma_f32_16x16x32_bf16 v[128:131], v[64:67], v[16:19], v[128:131]
    ds_read_b128 v[32:35], v5 offset:36864
    v_mfma_f32_16x16x32_bf16 v[132:135], v[68:71], v[16:19], v[132:135]
    ds_read_b128 v[36:39], v5 offset:37888
    v_mfma_f32_16x16x32_bf16 v[136:139], v[72:75], v[16:19], v[136:139]
    ds_read_b128 v[40:43], v5 offset:38912
    v_mfma_f32_16x16x32_bf16 v[140:143], v[76:79], v[16:19], v[140:143]
    ds_read_b128 v[44:47], v5 offset:39936
    v_mfma_f32_16x16x32_bf16 v[156:159], v[76:79], v[20:23], v[156:159]
    s_add_u32 m0, s35, 16384
    v_mfma_f32_16x16x32_bf16 v[152:155], v[72:75], v[20:23], v[152:155]
    buffer_load_dwordx4 v3, s[12:15], s33 offen lds
    v_mfma_f32_16x16x32_bf16 v[148:151], v[68:71], v[20:23], v[148:151]
    v_mfma_f32_16x16x32_bf16 v[144:147], v[64:67], v[20:23], v[144:147]
    s_add_u32 m0, s35, 24576
    v_mfma_f32_16x16x32_bf16 v[160:163], v[64:67], v[24:27], v[160:163]
    buffer_load_dwordx4 v3, s[16:19], s33 offen lds
    s_add_u32 s33, s33, 32*7168
    v_mfma_f32_16x16x32_bf16 v[164:167], v[68:71], v[24:27], v[164:167]
    v_mfma_f32_16x16x32_bf16 v[168:171], v[72:75], v[24:27], v[168:171]
    s_add_u32 m0, s34, 1024
    v_mfma_f32_16x16x32_bf16 v[172:175], v[76:79], v[24:27], v[172:175]
    buffer_load_dwordx4 v2, s[8:11], s32 offen sc1 lds
    v_mfma_f32_16x16x32_bf16 v[188:191], v[76:79], v[28:31], v[188:191]
    v_mfma_f32_16x16x32_bf16 v[184:187], v[72:75], v[28:31], v[184:187]
    v_mfma_f32_16x16x32_bf16 v[180:183], v[68:71], v[28:31], v[180:183]
    buffer_load_dwordx4 v2, s[8:11], s32 offen offset:1024 sc1 lds
    s_add_u32 s32, s32, 2048
    v_mfma_f32_16x16x32_bf16 v[176:179], v[64:67], v[28:31], v[176:179]
    buffer_store_dwordx4 v[104:107], v2, s[52:55], s57 offen sc1
    s_add_u32 s57, s57, 458752
    s_waitcnt vmcnt(11) lgkmcnt(0)
    s_barrier
    v_mfma_f32_16x16x32_bf16 v[192:195], v[64:67], v[32:35], v[192:195]
    ds_read_b64_tr_b16 v[48:49], v9 offset:0
    v_mfma_f32_16x16x32_bf16 v[196:199], v[68:71], v[32:35], v[196:199]
    ds_read_b64_tr_b16 v[50:51], v9 offset:1024
    v_mfma_f32_16x16x32_bf16 v[200:203], v[72:75], v[32:35], v[200:203]
    ds_read_b64_tr_b16 v[52:53], v12 offset:0
    v_mfma_f32_16x16x32_bf16 v[204:207], v[76:79], v[32:35], v[204:207]
    ds_read_b64_tr_b16 v[54:55], v12 offset:1024
    v_mfma_f32_16x16x32_bf16 v[220:223], v[76:79], v[36:39], v[220:223]
    ds_read_b64_tr_b16 v[56:57], v9 offset:8192
    v_mfma_f32_16x16x32_bf16 v[216:219], v[72:75], v[36:39], v[216:219]
    ds_read_b64_tr_b16 v[58:59], v9 offset:9216
    v_mfma_f32_16x16x32_bf16 v[212:215], v[68:71], v[36:39], v[212:215]
    ds_read_b64_tr_b16 v[60:61], v12 offset:8192
    v_mfma_f32_16x16x32_bf16 v[208:211], v[64:67], v[36:39], v[208:211]
    ds_read_b64_tr_b16 v[62:63], v12 offset:9216
    v_mfma_f32_16x16x32_bf16 v[224:227], v[64:67], v[40:43], v[224:227]
    ds_read_b128 v[16:19], v6 offset:0
    v_mfma_f32_16x16x32_bf16 v[228:231], v[68:71], v[40:43], v[228:231]
    ds_read_b128 v[20:23], v6 offset:1024
    v_mfma_f32_16x16x32_bf16 v[232:235], v[72:75], v[40:43], v[232:235]
    ds_read_b128 v[24:27], v6 offset:2048
    v_mfma_f32_16x16x32_bf16 v[236:239], v[76:79], v[40:43], v[236:239]
    ds_read_b128 v[28:31], v6 offset:3072
    v_mfma_f32_16x16x32_bf16 v[252:255], v[76:79], v[44:47], v[252:255]
    v_mfma_f32_16x16x32_bf16 v[248:251], v[72:75], v[44:47], v[248:251]
    v_mfma_f32_16x16x32_bf16 v[244:247], v[68:71], v[44:47], v[244:247]
    v_mfma_f32_16x16x32_bf16 v[240:243], v[64:67], v[44:47], v[240:243]
    s_nop 0
    s_waitcnt lgkmcnt(0)
    v_mfma_f32_16x16x32_bf16 v[128:131], v[48:51], v[16:19], v[128:131]
    ds_read_b128 v[32:35], v6 offset:4096
    v_mfma_f32_16x16x32_bf16 v[132:135], v[52:55], v[16:19], v[132:135]
    ds_read_b128 v[36:39], v6 offset:5120
    v_mfma_f32_16x16x32_bf16 v[136:139], v[56:59], v[16:19], v[136:139]
    ds_read_b128 v[40:43], v6 offset:6144
    v_mfma_f32_16x16x32_bf16 v[140:143], v[60:63], v[16:19], v[140:143]
    ds_read_b128 v[44:47], v6 offset:7168
    v_mfma_f32_16x16x32_bf16 v[156:159], v[60:63], v[20:23], v[156:159]
    s_add_u32 m0, s35, 49152
    v_mfma_f32_16x16x32_bf16 v[152:155], v[56:59], v[20:23], v[152:155]
    buffer_load_dwordx4 v3, s[12:15], s33 offen lds
    v_mfma_f32_16x16x32_bf16 v[148:151], v[52:55], v[20:23], v[148:151]
    v_mfma_f32_16x16x32_bf16 v[144:147], v[48:51], v[20:23], v[144:147]
    s_add_u32 m0, s35, 57344
    v_mfma_f32_16x16x32_bf16 v[160:163], v[48:51], v[24:27], v[160:163]
    buffer_load_dwordx4 v3, s[16:19], s33 offen lds
    s_add_u32 s33, s33, 32*7168
    v_mfma_f32_16x16x32_bf16 v[164:167], v[52:55], v[24:27], v[164:167]
    v_mfma_f32_16x16x32_bf16 v[168:171], v[56:59], v[24:27], v[168:171]
    s_add_u32 m0, s34, 33792
    v_mfma_f32_16x16x32_bf16 v[172:175], v[60:63], v[24:27], v[172:175]
    buffer_load_dwordx4 v2, s[8:11], s32 offen sc1 lds
    v_mfma_f32_16x16x32_bf16 v[188:191], v[60:63], v[28:31], v[188:191]
    v_mfma_f32_16x16x32_bf16 v[184:187], v[56:59], v[28:31], v[184:187]
    v_mfma_f32_16x16x32_bf16 v[180:183], v[52:55], v[28:31], v[180:183]
    buffer_load_dwordx4 v2, s[8:11], s32 offen offset:1024 sc1 lds
    s_add_u32 s32, s32, 2048
    v_mfma_f32_16x16x32_bf16 v[176:179], v[48:51], v[28:31], v[176:179]
    buffer_store_dwordx4 v[108:111], v2, s[52:55], s57 offen sc1
    s_add_u32 s57, s57, 458752
    s_waitcnt vmcnt(11) lgkmcnt(0)
    s_barrier
    v_mfma_f32_16x16x32_bf16 v[192:195], v[48:51], v[32:35], v[192:195]
    ds_read_b64_tr_b16 v[64:65], v9 offset:32768
    v_mfma_f32_16x16x32_bf16 v[196:199], v[52:55], v[32:35], v[196:199]
    ds_read_b64_tr_b16 v[66:67], v9 offset:33792
    v_mfma_f32_16x16x32_bf16 v[200:203], v[56:59], v[32:35], v[200:203]
    ds_read_b64_tr_b16 v[68:69], v12 offset:32768
    v_mfma_f32_16x16x32_bf16 v[204:207], v[60:63], v[32:35], v[204:207]
    ds_read_b64_tr_b16 v[70:71], v12 offset:33792
    v_mfma_f32_16x16x32_bf16 v[220:223], v[60:63], v[36:39], v[220:223]
    ds_read_b64_tr_b16 v[72:73], v9 offset:40960
    v_mfma_f32_16x16x32_bf16 v[216:219], v[56:59], v[36:39], v[216:219]
    ds_read_b64_tr_b16 v[74:75], v9 offset:41984
    v_mfma_f32_16x16x32_bf16 v[212:215], v[52:55], v[36:39], v[212:215]
    ds_read_b64_tr_b16 v[76:77], v12 offset:40960
    v_mfma_f32_16x16x32_bf16 v[208:211], v[48:51], v[36:39], v[208:211]
    ds_read_b64_tr_b16 v[78:79], v12 offset:41984
    v_mfma_f32_16x16x32_bf16 v[224:227], v[48:51], v[40:43], v[224:227]
    ds_read_b128 v[16:19], v6 offset:32768
    v_mfma_f32_16x16x32_bf16 v[228:231], v[52:55], v[40:43], v[228:231]
    ds_read_b128 v[20:23], v6 offset:33792
    v_mfma_f32_16x16x32_bf16 v[232:235], v[56:59], v[40:43], v[232:235]
    ds_read_b128 v[24:27], v6 offset:34816
    v_mfma_f32_16x16x32_bf16 v[236:239], v[60:63], v[40:43], v[236:239]
    ds_read_b128 v[28:31], v6 offset:35840
    v_mfma_f32_16x16x32_bf16 v[252:255], v[60:63], v[44:47], v[252:255]
    v_mfma_f32_16x16x32_bf16 v[248:251], v[56:59], v[44:47], v[248:251]
    v_mfma_f32_16x16x32_bf16 v[244:247], v[52:55], v[44:47], v[244:247]
    v_mfma_f32_16x16x32_bf16 v[240:243], v[48:51], v[44:47], v[240:243]
    s_nop 0
    s_waitcnt lgkmcnt(0)
    v_mfma_f32_16x16x32_bf16 v[128:131], v[64:67], v[16:19], v[128:131]
    ds_read_b128 v[32:35], v6 offset:36864
    v_mfma_f32_16x16x32_bf16 v[132:135], v[68:71], v[16:19], v[132:135]
    ds_read_b128 v[36:39], v6 offset:37888
    v_mfma_f32_16x16x32_bf16 v[136:139], v[72:75], v[16:19], v[136:139]
    ds_read_b128 v[40:43], v6 offset:38912
    v_mfma_f32_16x16x32_bf16 v[140:143], v[76:79], v[16:19], v[140:143]
    ds_read_b128 v[44:47], v6 offset:39936
    v_mfma_f32_16x16x32_bf16 v[156:159], v[76:79], v[20:23], v[156:159]
    s_add_u32 m0, s35, 81920
    v_mfma_f32_16x16x32_bf16 v[152:155], v[72:75], v[20:23], v[152:155]
    buffer_load_dwordx4 v3, s[12:15], s33 offen lds
    v_mfma_f32_16x16x32_bf16 v[148:151], v[68:71], v[20:23], v[148:151]
    v_mfma_f32_16x16x32_bf16 v[144:147], v[64:67], v[20:23], v[144:147]
    s_add_u32 m0, s35, 90112
    v_mfma_f32_16x16x32_bf16 v[160:163], v[64:67], v[24:27], v[160:163]
    buffer_load_dwordx4 v3, s[16:19], s33 offen lds
    s_add_u32 s33, s33, 32*7168
    v_mfma_f32_16x16x32_bf16 v[164:167], v[68:71], v[24:27], v[164:167]
    v_mfma_f32_16x16x32_bf16 v[168:171], v[72:75], v[24:27], v[168:171]
    s_add_u32 m0, s34, 66560
    v_mfma_f32_16x16x32_bf16 v[172:175], v[76:79], v[24:27], v[172:175]
    buffer_load_dwordx4 v2, s[8:11], s32 offen sc1 lds
    v_mfma_f32_16x16x32_bf16 v[188:191], v[76:79], v[28:31], v[188:191]
    v_mfma_f32_16x16x32_bf16 v[184:187], v[72:75], v[28:31], v[184:187]
    v_mfma_f32_16x16x32_bf16 v[180:183], v[68:71], v[28:31], v[180:183]
    buffer_load_dwordx4 v2, s[8:11], s32 offen offset:1024 sc1 lds
    s_add_u32 s32, s32, 2048
    v_mfma_f32_16x16x32_bf16 v[176:179], v[64:67], v[28:31], v[176:179]
    s_waitcnt vmcnt(10) lgkmcnt(0)
    s_barrier
    v_mfma_f32_16x16x32_bf16 v[192:195], v[64:67], v[32:35], v[192:195]
    ds_read_b64_tr_b16 v[48:49], v8 offset:0
    v_mfma_f32_16x16x32_bf16 v[196:199], v[68:71], v[32:35], v[196:199]
    ds_read_b64_tr_b16 v[50:51], v8 offset:1024
    v_mfma_f32_16x16x32_bf16 v[200:203], v[72:75], v[32:35], v[200:203]
    ds_read_b64_tr_b16 v[52:53], v11 offset:0
    v_mfma_f32_16x16x32_bf16 v[204:207], v[76:79], v[32:35], v[204:207]
    ds_read_b64_tr_b16 v[54:55], v11 offset:1024
    v_mfma_f32_16x16x32_bf16 v[220:223], v[76:79], v[36:39], v[220:223]
    ds_read_b64_tr_b16 v[56:57], v8 offset:8192
    v_mfma_f32_16x16x32_bf16 v[216:219], v[72:75], v[36:39], v[216:219]
    ds_read_b64_tr_b16 v[58:59], v8 offset:9216
    v_mfma_f32_16x16x32_bf16 v[212:215], v[68:71], v[36:39], v[212:215]
    ds_read_b64_tr_b16 v[60:61], v11 offset:8192
    v_mfma_f32_16x16x32_bf16 v[208:211], v[64:67], v[36:39], v[208:211]
    ds_read_b64_tr_b16 v[62:63], v11 offset:9216
    v_mfma_f32_16x16x32_bf16 v[224:227], v[64:67], v[40:43], v[224:227]
    ds_read_b128 v[16:19], v5 offset:0
    v_mfma_f32_16x16x32_bf16 v[228:231], v[68:71], v[40:43], v[228:231]
    ds_read_b128 v[20:23], v5 offset:1024
    v_mfma_f32_16x16x32_bf16 v[232:235], v[72:75], v[40:43], v[232:235]
    ds_read_b128 v[24:27], v5 offset:2048
    v_mfma_f32_16x16x32_bf16 v[236:239], v[76:79], v[40:43], v[236:239]
    ds_read_b128 v[28:31], v5 offset:3072
    v_mfma_f32_16x16x32_bf16 v[252:255], v[76:79], v[44:47], v[252:255]
    v_mfma_f32_16x16x32_bf16 v[248:251], v[72:75], v[44:47], v[248:251]
    v_mfma_f32_16x16x32_bf16 v[244:247], v[68:71], v[44:47], v[244:247]
    v_mfma_f32_16x16x32_bf16 v[240:243], v[64:67], v[44:47], v[240:243]
    s_nop 0
    s_waitcnt lgkmcnt(0)
    v_mfma_f32_16x16x32_bf16 v[128:131], v[48:51], v[16:19], v[128:131]
    ds_read_b128 v[32:35], v5 offset:4096
    v_mfma_f32_16x16x32_bf16 v[132:135], v[52:55], v[16:19], v[132:135]
    ds_read_b128 v[36:39], v5 offset:5120
    v_mfma_f32_16x16x32_bf16 v[136:139], v[56:59], v[16:19], v[136:139]
    ds_read_b128 v[40:43], v5 offset:6144
    v_mfma_f32_16x16x32_bf16 v[140:143], v[60:63], v[16:19], v[140:143]
    ds_read_b128 v[44:47], v5 offset:7168
    v_mfma_f32_16x16x32_bf16 v[156:159], v[60:63], v[20:23], v[156:159]
    s_add_u32 m0, s35, 114688
    v_mfma_f32_16x16x32_bf16 v[152:155], v[56:59], v[20:23], v[152:155]
    buffer_load_dwordx4 v3, s[12:15], s33 offen lds
    v_mfma_f32_16x16x32_bf16 v[148:151], v[52:55], v[20:23], v[148:151]
    v_mfma_f32_16x16x32_bf16 v[144:147], v[48:51], v[20:23], v[144:147]
    s_add_u32 m0, s35, 122880
    v_mfma_f32_16x16x32_bf16 v[160:163], v[48:51], v[24:27], v[160:163]
    buffer_load_dwordx4 v3, s[16:19], s33 offen lds
    s_add_u32 s33, s33, 32*7168
    v_mfma_f32_16x16x32_bf16 v[164:167], v[52:55], v[24:27], v[164:167]
    v_mfma_f32_16x16x32_bf16 v[168:171], v[56:59], v[24:27], v[168:171]
    s_add_u32 m0, s34, 99328
    v_mfma_f32_16x16x32_bf16 v[172:175], v[60:63], v[24:27], v[172:175]
    buffer_load_dwordx4 v2, s[8:11], s32 offen sc1 lds
    v_mfma_f32_16x16x32_bf16 v[188:191], v[60:63], v[28:31], v[188:191]
    v_mfma_f32_16x16x32_bf16 v[184:187], v[56:59], v[28:31], v[184:187]
    v_mfma_f32_16x16x32_bf16 v[180:183], v[52:55], v[28:31], v[180:183]
    buffer_load_dwordx4 v2, s[8:11], s32 offen offset:1024 sc1 lds
    s_add_u32 s32, s32, 2048
    v_mfma_f32_16x16x32_bf16 v[176:179], v[48:51], v[28:31], v[176:179]
    s_waitcnt vmcnt(9) lgkmcnt(0)
    s_barrier
    v_mfma_f32_16x16x32_bf16 v[192:195], v[48:51], v[32:35], v[192:195]
    ds_read_b64_tr_b16 v[64:65], v8 offset:32768
    v_mfma_f32_16x16x32_bf16 v[196:199], v[52:55], v[32:35], v[196:199]
    ds_read_b64_tr_b16 v[66:67], v8 offset:33792
    v_mfma_f32_16x16x32_bf16 v[200:203], v[56:59], v[32:35], v[200:203]
    ds_read_b64_tr_b16 v[68:69], v11 offset:32768
    v_mfma_f32_16x16x32_bf16 v[204:207], v[60:63], v[32:35], v[204:207]
    ds_read_b64_tr_b16 v[70:71], v11 offset:33792
    v_mfma_f32_16x16x32_bf16 v[220:223], v[60:63], v[36:39], v[220:223]
    ds_read_b64_tr_b16 v[72:73], v8 offset:40960
    v_mfma_f32_16x16x32_bf16 v[216:219], v[56:59], v[36:39], v[216:219]
    ds_read_b64_tr_b16 v[74:75], v8 offset:41984
    v_mfma_f32_16x16x32_bf16 v[212:215], v[52:55], v[36:39], v[212:215]
    ds_read_b64_tr_b16 v[76:77], v11 offset:40960
    v_mfma_f32_16x16x32_bf16 v[208:211], v[48:51], v[36:39], v[208:211]
    ds_read_b64_tr_b16 v[78:79], v11 offset:41984
    v_mfma_f32_16x16x32_bf16 v[224:227], v[48:51], v[40:43], v[224:227]
    ds_read_b128 v[16:19], v5 offset:32768
    v_mfma_f32_16x16x32_bf16 v[228:231], v[52:55], v[40:43], v[228:231]
    ds_read_b128 v[20:23], v5 offset:33792
    v_mfma_f32_16x16x32_bf16 v[232:235], v[56:59], v[40:43], v[232:235]
    ds_read_b128 v[24:27], v5 offset:34816
    v_mfma_f32_16x16x32_bf16 v[236:239], v[60:63], v[40:43], v[236:239]
    ds_read_b128 v[28:31], v5 offset:35840
    v_mfma_f32_16x16x32_bf16 v[252:255], v[60:63], v[44:47], v[252:255]
    v_mfma_f32_16x16x32_bf16 v[248:251], v[56:59], v[44:47], v[248:251]
    v_mfma_f32_16x16x32_bf16 v[244:247], v[52:55], v[44:47], v[244:247]
    v_mfma_f32_16x16x32_bf16 v[240:243], v[48:51], v[44:47], v[240:243]
    s_nop 0
    s_waitcnt lgkmcnt(0)
    v_mfma_f32_16x16x32_bf16 v[128:131], v[64:67], v[16:19], v[128:131]
    ds_read_b128 v[32:35], v5 offset:36864
    v_mfma_f32_16x16x32_bf16 v[132:135], v[68:71], v[16:19], v[132:135]
    ds_read_b128 v[36:39], v5 offset:37888
    v_mfma_f32_16x16x32_bf16 v[136:139], v[72:75], v[16:19], v[136:139]
    ds_read_b128 v[40:43], v5 offset:38912
    v_mfma_f32_16x16x32_bf16 v[140:143], v[76:79], v[16:19], v[140:143]
    ds_read_b128 v[44:47], v5 offset:39936
    v_mfma_f32_16x16x32_bf16 v[156:159], v[76:79], v[20:23], v[156:159]
    s_add_u32 m0, s35, 16384
    v_mfma_f32_16x16x32_bf16 v[152:155], v[72:75], v[20:23], v[152:155]
    buffer_load_dwordx4 v3, s[12:15], s33 offen lds
    v_mfma_f32_16x16x32_bf16 v[148:151], v[68:71], v[20:23], v[148:151]
    v_mfma_f32_16x16x32_bf16 v[144:147], v[64:67], v[20:23], v[144:147]
    s_add_u32 m0, s35, 24576
    v_mfma_f32_16x16x32_bf16 v[160:163], v[64:67], v[24:27], v[160:163]
    buffer_load_dwordx4 v3, s[16:19], s33 offen lds
    s_add_u32 s33, s33, 32*7168
    v_mfma_f32_16x16x32_bf16 v[164:167], v[68:71], v[24:27], v[164:167]
    v_mfma_f32_16x16x32_bf16 v[168:171], v[72:75], v[24:27], v[168:171]
    s_add_u32 m0, s34, 1024
    v_mfma_f32_16x16x32_bf16 v[172:175], v[76:79], v[24:27], v[172:175]
    buffer_load_dwordx4 v2, s[8:11], s32 offen sc1 lds
    v_mfma_f32_16x16x32_bf16 v[188:191], v[76:79], v[28:31], v[188:191]
    v_mfma_f32_16x16x32_bf16 v[184:187], v[72:75], v[28:31], v[184:187]
    v_mfma_f32_16x16x32_bf16 v[180:183], v[68:71], v[28:31], v[180:183]
    buffer_load_dwordx4 v2, s[8:11], s32 offen offset:1024 sc1 lds
    s_add_u32 s32, s32, 2048
    v_mfma_f32_16x16x32_bf16 v[176:179], v[64:67], v[28:31], v[176:179]
    s_waitcnt vmcnt(8) lgkmcnt(0)
    s_barrier
    v_mfma_f32_16x16x32_bf16 v[192:195], v[64:67], v[32:35], v[192:195]
    ds_read_b64_tr_b16 v[48:49], v9 offset:0
    v_mfma_f32_16x16x32_bf16 v[196:199], v[68:71], v[32:35], v[196:199]
    ds_read_b64_tr_b16 v[50:51], v9 offset:1024
    v_mfma_f32_16x16x32_bf16 v[200:203], v[72:75], v[32:35], v[200:203]
    ds_read_b64_tr_b16 v[52:53], v12 offset:0
    v_mfma_f32_16x16x32_bf16 v[204:207], v[76:79], v[32:35], v[204:207]
    ds_read_b64_tr_b16 v[54:55], v12 offset:1024
    v_mfma_f32_16x16x32_bf16 v[220:223], v[76:79], v[36:39], v[220:223]
    ds_read_b64_tr_b16 v[56:57], v9 offset:8192
    v_mfma_f32_16x16x32_bf16 v[216:219], v[72:75], v[36:39], v[216:219]
    ds_read_b64_tr_b16 v[58:59], v9 offset:9216
    v_mfma_f32_16x16x32_bf16 v[212:215], v[68:71], v[36:39], v[212:215]
    ds_read_b64_tr_b16 v[60:61], v12 offset:8192
    v_mfma_f32_16x16x32_bf16 v[208:211], v[64:67], v[36:39], v[208:211]
    ds_read_b64_tr_b16 v[62:63], v12 offset:9216
    v_mfma_f32_16x16x32_bf16 v[224:227], v[64:67], v[40:43], v[224:227]
    ds_read_b128 v[16:19], v6 offset:0
    v_mfma_f32_16x16x32_bf16 v[228:231], v[68:71], v[40:43], v[228:231]
    ds_read_b128 v[20:23], v6 offset:1024
    v_mfma_f32_16x16x32_bf16 v[232:235], v[72:75], v[40:43], v[232:235]
    ds_read_b128 v[24:27], v6 offset:2048
    v_mfma_f32_16x16x32_bf16 v[236:239], v[76:79], v[40:43], v[236:239]
    ds_read_b128 v[28:31], v6 offset:3072
    v_mfma_f32_16x16x32_bf16 v[252:255], v[76:79], v[44:47], v[252:255]
    v_mfma_f32_16x16x32_bf16 v[248:251], v[72:75], v[44:47], v[248:251]
    v_mfma_f32_16x16x32_bf16 v[244:247], v[68:71], v[44:47], v[244:247]
    v_mfma_f32_16x16x32_bf16 v[240:243], v[64:67], v[44:47], v[240:243]
    s_nop 0
    s_waitcnt lgkmcnt(0)
    v_mfma_f32_16x16x32_bf16 v[128:131], v[48:51], v[16:19], v[128:131]
    ds_read_b128 v[32:35], v6 offset:4096
    v_mfma_f32_16x16x32_bf16 v[132:135], v[52:55], v[16:19], v[132:135]
    ds_read_b128 v[36:39], v6 offset:5120
    v_mfma_f32_16x16x32_bf16 v[136:139], v[56:59], v[16:19], v[136:139]
    ds_read_b128 v[40:43], v6 offset:6144
    v_mfma_f32_16x16x32_bf16 v[140:143], v[60:63], v[16:19], v[140:143]
    ds_read_b128 v[44:47], v6 offset:7168
    v_mfma_f32_16x16x32_bf16 v[156:159], v[60:63], v[20:23], v[156:159]
    s_add_u32 m0, s35, 49152
    v_mfma_f32_16x16x32_bf16 v[152:155], v[56:59], v[20:23], v[152:155]
    buffer_load_dwordx4 v3, s[12:15], s33 offen lds
    v_mfma_f32_16x16x32_bf16 v[148:151], v[52:55], v[20:23], v[148:151]
    v_mfma_f32_16x16x32_bf16 v[144:147], v[48:51], v[20:23], v[144:147]
    s_add_u32 m0, s35, 57344
    v_mfma_f32_16x16x32_bf16 v[160:163], v[48:51], v[24:27], v[160:163]
    buffer_load_dwordx4 v3, s[16:19], s33 offen lds
    s_add_u32 s33, s33, 32*7168
    v_mfma_f32_16x16x32_bf16 v[164:167], v[52:55], v[24:27], v[164:167]
    v_mfma_f32_16x16x32_bf16 v[168:171], v[56:59], v[24:27], v[168:171]
    s_add_u32 m0, s34, 33792
    v_mfma_f32_16x16x32_bf16 v[172:175], v[60:63], v[24:27], v[172:175]
    buffer_load_dwordx4 v2, s[8:11], s32 offen sc1 lds
    v_mfma_f32_16x16x32_bf16 v[188:191], v[60:63], v[28:31], v[188:191]
    v_mfma_f32_16x16x32_bf16 v[184:187], v[56:59], v[28:31], v[184:187]
    v_mfma_f32_16x16x32_bf16 v[180:183], v[52:55], v[28:31], v[180:183]
    buffer_load_dwordx4 v2, s[8:11], s32 offen offset:1024 sc1 lds
    s_add_u32 s32, s32, 2048
    v_mfma_f32_16x16x32_bf16 v[176:179], v[48:51], v[28:31], v[176:179]
    s_cmp_lg_u32 s3, 0
    s_cbranch_scc1 k2_fa
    s_lshl_b32 s59, s2, 2
    v_mov_b32_e64 v120, 1
    s_mov_b64 exec, 1
    buffer_store_dword v120, off, s[84:87], s59 offset:0 sc1
    s_mov_b64 exec, -1
k2_fa:
    s_nop 0
    s_waitcnt vmcnt(8) lgkmcnt(0)
    s_barrier
    v_mfma_f32_16x16x32_bf16 v[192:195], v[48:51], v[32:35], v[192:195]
    ds_read_b64_tr_b16 v[64:65], v9 offset:32768
    v_mfma_f32_16x16x32_bf16 v[196:199], v[52:55], v[32:35], v[196:199]
    ds_read_b64_tr_b16 v[66:67], v9 offset:33792
    v_mfma_f32_16x16x32_bf16 v[200:203], v[56:59], v[32:35], v[200:203]
    ds_read_b64_tr_b16 v[68:69], v12 offset:32768
    v_mfma_f32_16x16x32_bf16 v[204:207], v[60:63], v[32:35], v[204:207]
    ds_read_b64_tr_b16 v[70:71], v12 offset:33792
    v_mfma_f32_16x16x32_bf16 v[220:223], v[60:63], v[36:39], v[220:223]
    ds_read_b64_tr_b16 v[72:73], v9 offset:40960
    v_mfma_f32_16x16x32_bf16 v[216:219], v[56:59], v[36:39], v[216:219]
    ds_read_b64_tr_b16 v[74:75], v9 offset:41984
    v_mfma_f32_16x16x32_bf16 v[212:215], v[52:55], v[36:39], v[212:215]
    ds_read_b64_tr_b16 v[76:77], v12 offset:40960
    v_mfma_f32_16x16x32_bf16 v[208:211], v[48:51], v[36:39], v[208:211]
    ds_read_b64_tr_b16 v[78:79], v12 offset:41984
    v_mfma_f32_16x16x32_bf16 v[224:227], v[48:51], v[40:43], v[224:227]
    ds_read_b128 v[16:19], v6 offset:32768
    v_mfma_f32_16x16x32_bf16 v[228:231], v[52:55], v[40:43], v[228:231]
    ds_read_b128 v[20:23], v6 offset:33792
    v_mfma_f32_16x16x32_bf16 v[232:235], v[56:59], v[40:43], v[232:235]
    ds_read_b128 v[24:27], v6 offset:34816
    v_mfma_f32_16x16x32_bf16 v[236:239], v[60:63], v[40:43], v[236:239]
    ds_read_b128 v[28:31], v6 offset:35840
    v_mfma_f32_16x16x32_bf16 v[252:255], v[60:63], v[44:47], v[252:255]
    v_mfma_f32_16x16x32_bf16 v[248:251], v[56:59], v[44:47], v[248:251]
    v_mfma_f32_16x16x32_bf16 v[244:247], v[52:55], v[44:47], v[244:247]
    v_mfma_f32_16x16x32_bf16 v[240:243], v[48:51], v[44:47], v[240:243]
    s_mov_b32 s45, 1
    s_nop 0
k2_loop:
    s_nop 0
    s_waitcnt lgkmcnt(0)
    v_mfma_f32_16x16x32_bf16 v[128:131], v[64:67], v[16:19], v[128:131]
    ds_read_b128 v[32:35], v6 offset:36864
    v_mfma_f32_16x16x32_bf16 v[132:135], v[68:71], v[16:19], v[132:135]
    ds_read_b128 v[36:39], v6 offset:37888
    v_mfma_f32_16x16x32_bf16 v[136:139], v[72:75], v[16:19], v[136:139]
    ds_read_b128 v[40:43], v6 offset:38912
    v_mfma_f32_16x16x32_bf16 v[140:143], v[76:79], v[16:19], v[140:143]
    ds_read_b128 v[44:47], v6 offset:39936
    v_mfma_f32_16x16x32_bf16 v[156:159], v[76:79], v[20:23], v[156:159]
    s_add_u32 m0, s35, 81920
    v_mfma_f32_16x16x32_bf16 v[152:155], v[72:75], v[20:23], v[152:155]
    buffer_load_dwordx4 v3, s[12:15], s33 offen lds
    v_mfma_f32_16x16x32_bf16 v[148:151], v[68:71], v[20:23], v[148:151]
    v_mfma_f32_16x16x32_bf16 v[144:147], v[64:67], v[20:23], v[144:147]
    s_add_u32 m0, s35, 90112
    v_mfma_f32_16x16x32_bf16 v[160:163], v[64:67], v[24:27], v[160:163]
    buffer_load_dwordx4 v3, s[16:19], s33 offen lds
    s_add_u32 s33, s33, 32*7168
    v_mfma_f32_16x16x32_bf16 v[164:167], v[68:71], v[24:27], v[164:167]
    v_mfma_f32_16x16x32_bf16 v[168:171], v[72:75], v[24:27], v[168:171]
    s_add_u32 m0, s34, 66560
    v_mfma_f32_16x16x32_bf16 v[172:175], v[76:79], v[24:27], v[172:175]
    buffer_load_dwordx4 v2, s[8:11], s32 offen sc1 lds
    v_mfma_f32_16x16x32_bf16 v[188:191], v[76:79], v[28:31], v[188:191]
    v_mfma_f32_16x16x32_bf16 v[184:187], v[72:75], v[28:31], v[184:187]
    v_mfma_f32_16x16x32_bf16 v[180:183], v[68:71], v[28:31], v[180:183]
    buffer_load_dwordx4 v2, s[8:11], s32 offen offset:1024 sc1 lds
    s_add_u32 s32, s32, 2048
    v_mfma_f32_16x16x32_bf16 v[176:179], v[64:67], v[28:31], v[176:179]
    s_waitcnt vmcnt(8) lgkmcnt(0)
    s_barrier
    v_mfma_f32_16x16x32_bf16 v[192:195], v[64:67], v[32:35], v[192:195]
    ds_read_b64_tr_b16 v[48:49], v8 offset:0
    v_mfma_f32_16x16x32_bf16 v[196:199], v[68:71], v[32:35], v[196:199]
    ds_read_b64_tr_b16 v[50:51], v8 offset:1024
    v_mfma_f32_16x16x32_bf16 v[200:203], v[72:75], v[32:35], v[200:203]
    ds_read_b64_tr_b16 v[52:53], v11 offset:0
    v_mfma_f32_16x16x32_bf16 v[204:207], v[76:79], v[32:35], v[204:207]
    ds_read_b64_tr_b16 v[54:55], v11 offset:1024
    v_mfma_f32_16x16x32_bf16 v[220:223], v[76:79], v[36:39], v[220:223]
    ds_read_b64_tr_b16 v[56:57], v8 offset:8192
    v_mfma_f32_16x16x32_bf16 v[216:219], v[72:75], v[36:39], v[216:219]
    ds_read_b64_tr_b16 v[58:59], v8 offset:9216
    v_mfma_f32_16x16x32_bf16 v[212:215], v[68:71], v[36:39], v[212:215]
    ds_read_b64_tr_b16 v[60:61], v11 offset:8192
    v_mfma_f32_16x16x32_bf16 v[208:211], v[64:67], v[36:39], v[208:211]
    ds_read_b64_tr_b16 v[62:63], v11 offset:9216
    v_mfma_f32_16x16x32_bf16 v[224:227], v[64:67], v[40:43], v[224:227]
    ds_read_b128 v[16:19], v5 offset:0
    v_mfma_f32_16x16x32_bf16 v[228:231], v[68:71], v[40:43], v[228:231]
    ds_read_b128 v[20:23], v5 offset:1024
    v_mfma_f32_16x16x32_bf16 v[232:235], v[72:75], v[40:43], v[232:235]
    ds_read_b128 v[24:27], v5 offset:2048
    v_mfma_f32_16x16x32_bf16 v[236:239], v[76:79], v[40:43], v[236:239]
    ds_read_b128 v[28:31], v5 offset:3072
    v_mfma_f32_16x16x32_bf16 v[252:255], v[76:79], v[44:47], v[252:255]
    v_mfma_f32_16x16x32_bf16 v[248:251], v[72:75], v[44:47], v[248:251]
    v_mfma_f32_16x16x32_bf16 v[244:247], v[68:71], v[44:47], v[244:247]
    v_mfma_f32_16x16x32_bf16 v[240:243], v[64:67], v[44:47], v[240:243]
    s_nop 0
    s_waitcnt lgkmcnt(0)
    v_mfma_f32_16x16x32_bf16 v[128:131], v[48:51], v[16:19], v[128:131]
    ds_read_b128 v[32:35], v5 offset:4096
    v_mfma_f32_16x16x32_bf16 v[132:135], v[52:55], v[16:19], v[132:135]
    ds_read_b128 v[36:39], v5 offset:5120
    v_mfma_f32_16x16x32_bf16 v[136:139], v[56:59], v[16:19], v[136:139]
    ds_read_b128 v[40:43], v5 offset:6144
    v_mfma_f32_16x16x32_bf16 v[140:143], v[60:63], v[16:19], v[140:143]
    ds_read_b128 v[44:47], v5 offset:7168
    v_mfma_f32_16x16x32_bf16 v[156:159], v[60:63], v[20:23], v[156:159]
    s_add_u32 m0, s35, 114688
    v_mfma_f32_16x16x32_bf16 v[152:155], v[56:59], v[20:23], v[152:155]
    buffer_load_dwordx4 v3, s[12:15], s33 offen lds
    v_mfma_f32_16x16x32_bf16 v[148:151], v[52:55], v[20:23], v[148:151]
    v_mfma_f32_16x16x32_bf16 v[144:147], v[48:51], v[20:23], v[144:147]
    s_add_u32 m0, s35, 122880
    v_mfma_f32_16x16x32_bf16 v[160:163], v[48:51], v[24:27], v[160:163]
    buffer_load_dwordx4 v3, s[16:19], s33 offen lds
    s_add_u32 s33, s33, 32*7168
    v_mfma_f32_16x16x32_bf16 v[164:167], v[52:55], v[24:27], v[164:167]
    v_mfma_f32_16x16x32_bf16 v[168:171], v[56:59], v[24:27], v[168:171]
    s_add_u32 m0, s34, 99328
    v_mfma_f32_16x16x32_bf16 v[172:175], v[60:63], v[24:27], v[172:175]
    buffer_load_dwordx4 v2, s[8:11], s32 offen sc1 lds
    v_mfma_f32_16x16x32_bf16 v[188:191], v[60:63], v[28:31], v[188:191]
    v_mfma_f32_16x16x32_bf16 v[184:187], v[56:59], v[28:31], v[184:187]
    v_mfma_f32_16x16x32_bf16 v[180:183], v[52:55], v[28:31], v[180:183]
    buffer_load_dwordx4 v2, s[8:11], s32 offen offset:1024 sc1 lds
    s_add_u32 s32, s32, 2048
    v_mfma_f32_16x16x32_bf16 v[176:179], v[48:51], v[28:31], v[176:179]
    s_waitcnt vmcnt(8) lgkmcnt(0)
    s_barrier
    v_mfma_f32_16x16x32_bf16 v[192:195], v[48:51], v[32:35], v[192:195]
    ds_read_b64_tr_b16 v[64:65], v8 offset:32768
    v_mfma_f32_16x16x32_bf16 v[196:199], v[52:55], v[32:35], v[196:199]
    ds_read_b64_tr_b16 v[66:67], v8 offset:33792
    v_mfma_f32_16x16x32_bf16 v[200:203], v[56:59], v[32:35], v[200:203]
    ds_read_b64_tr_b16 v[68:69], v11 offset:32768
    v_mfma_f32_16x16x32_bf16 v[204:207], v[60:63], v[32:35], v[204:207]
    ds_read_b64_tr_b16 v[70:71], v11 offset:33792
    v_mfma_f32_16x16x32_bf16 v[220:223], v[60:63], v[36:39], v[220:223]
    ds_read_b64_tr_b16 v[72:73], v8 offset:40960
    v_mfma_f32_16x16x32_bf16 v[216:219], v[56:59], v[36:39], v[216:219]
    ds_read_b64_tr_b16 v[74:75], v8 offset:41984
    v_mfma_f32_16x16x32_bf16 v[212:215], v[52:55], v[36:39], v[212:215]
    ds_read_b64_tr_b16 v[76:77], v11 offset:40960
    v_mfma_f32_16x16x32_bf16 v[208:211], v[48:51], v[36:39], v[208:211]
    ds_read_b64_tr_b16 v[78:79], v11 offset:41984
    v_mfma_f32_16x16x32_bf16 v[224:227], v[48:51], v[40:43], v[224:227]
    ds_read_b128 v[16:19], v5 offset:32768
    v_mfma_f32_16x16x32_bf16 v[228:231], v[52:55], v[40:43], v[228:231]
    ds_read_b128 v[20:23], v5 offset:33792
    v_mfma_f32_16x16x32_bf16 v[232:235], v[56:59], v[40:43], v[232:235]
    ds_read_b128 v[24:27], v5 offset:34816
    v_mfma_f32_16x16x32_bf16 v[236:239], v[60:63], v[40:43], v[236:239]
    ds_read_b128 v[28:31], v5 offset:35840
    v_mfma_f32_16x16x32_bf16 v[252:255], v[60:63], v[44:47], v[252:255]
    v_mfma_f32_16x16x32_bf16 v[248:251], v[56:59], v[44:47], v[248:251]
    v_mfma_f32_16x16x32_bf16 v[244:247], v[52:55], v[44:47], v[244:247]
    v_mfma_f32_16x16x32_bf16 v[240:243], v[48:51], v[44:47], v[240:243]
    s_nop 0
    s_waitcnt lgkmcnt(0)
    v_mfma_f32_16x16x32_bf16 v[128:131], v[64:67], v[16:19], v[128:131]
    ds_read_b128 v[32:35], v5 offset:36864
    v_mfma_f32_16x16x32_bf16 v[132:135], v[68:71], v[16:19], v[132:135]
    ds_read_b128 v[36:39], v5 offset:37888
    v_mfma_f32_16x16x32_bf16 v[136:139], v[72:75], v[16:19], v[136:139]
    ds_read_b128 v[40:43], v5 offset:38912
    v_mfma_f32_16x16x32_bf16 v[140:143], v[76:79], v[16:19], v[140:143]
    ds_read_b128 v[44:47], v5 offset:39936
    v_mfma_f32_16x16x32_bf16 v[156:159], v[76:79], v[20:23], v[156:159]
    s_add_u32 m0, s35, 16384
    v_mfma_f32_16x16x32_bf16 v[152:155], v[72:75], v[20:23], v[152:155]
    buffer_load_dwordx4 v3, s[12:15], s33 offen lds
    v_mfma_f32_16x16x32_bf16 v[148:151], v[68:71], v[20:23], v[148:151]
    v_mfma_f32_16x16x32_bf16 v[144:147], v[64:67], v[20:23], v[144:147]
    s_add_u32 m0, s35, 24576
    v_mfma_f32_16x16x32_bf16 v[160:163], v[64:67], v[24:27], v[160:163]
    buffer_load_dwordx4 v3, s[16:19], s33 offen lds
    s_add_u32 s33, s33, 32*7168
    v_mfma_f32_16x16x32_bf16 v[164:167], v[68:71], v[24:27], v[164:167]
    v_mfma_f32_16x16x32_bf16 v[168:171], v[72:75], v[24:27], v[168:171]
    s_add_u32 m0, s34, 1024
    v_mfma_f32_16x16x32_bf16 v[172:175], v[76:79], v[24:27], v[172:175]
    buffer_load_dwordx4 v2, s[8:11], s32 offen sc1 lds
    v_mfma_f32_16x16x32_bf16 v[188:191], v[76:79], v[28:31], v[188:191]
    v_mfma_f32_16x16x32_bf16 v[184:187], v[72:75], v[28:31], v[184:187]
    v_mfma_f32_16x16x32_bf16 v[180:183], v[68:71], v[28:31], v[180:183]
    buffer_load_dwordx4 v2, s[8:11], s32 offen offset:1024 sc1 lds
    s_add_u32 s32, s32, 2048
    v_mfma_f32_16x16x32_bf16 v[176:179], v[64:67], v[28:31], v[176:179]
    s_waitcnt vmcnt(8) lgkmcnt(0)
    s_barrier
    v_mfma_f32_16x16x32_bf16 v[192:195], v[64:67], v[32:35], v[192:195]
    ds_read_b64_tr_b16 v[48:49], v9 offset:0
    v_mfma_f32_16x16x32_bf16 v[196:199], v[68:71], v[32:35], v[196:199]
    ds_read_b64_tr_b16 v[50:51], v9 offset:1024
    v_mfma_f32_16x16x32_bf16 v[200:203], v[72:75], v[32:35], v[200:203]
    ds_read_b64_tr_b16 v[52:53], v12 offset:0
    v_mfma_f32_16x16x32_bf16 v[204:207], v[76:79], v[32:35], v[204:207]
    ds_read_b64_tr_b16 v[54:55], v12 offset:1024
    v_mfma_f32_16x16x32_bf16 v[220:223], v[76:79], v[36:39], v[220:223]
    ds_read_b64_tr_b16 v[56:57], v9 offset:8192
    v_mfma_f32_16x16x32_bf16 v[216:219], v[72:75], v[36:39], v[216:219]
    ds_read_b64_tr_b16 v[58:59], v9 offset:9216
    v_mfma_f32_16x16x32_bf16 v[212:215], v[68:71], v[36:39], v[212:215]
    ds_read_b64_tr_b16 v[60:61], v12 offset:8192
    v_mfma_f32_16x16x32_bf16 v[208:211], v[64:67], v[36:39], v[208:211]
    ds_read_b64_tr_b16 v[62:63], v12 offset:9216
    v_mfma_f32_16x16x32_bf16 v[224:227], v[64:67], v[40:43], v[224:227]
    ds_read_b128 v[16:19], v6 offset:0
    v_mfma_f32_16x16x32_bf16 v[228:231], v[68:71], v[40:43], v[228:231]
    ds_read_b128 v[20:23], v6 offset:1024
    v_mfma_f32_16x16x32_bf16 v[232:235], v[72:75], v[40:43], v[232:235]
    ds_read_b128 v[24:27], v6 offset:2048
    v_mfma_f32_16x16x32_bf16 v[236:239], v[76:79], v[40:43], v[236:239]
    ds_read_b128 v[28:31], v6 offset:3072
    v_mfma_f32_16x16x32_bf16 v[252:255], v[76:79], v[44:47], v[252:255]
    v_mfma_f32_16x16x32_bf16 v[248:251], v[72:75], v[44:47], v[248:251]
    v_mfma_f32_16x16x32_bf16 v[244:247], v[68:71], v[44:47], v[244:247]
    v_mfma_f32_16x16x32_bf16 v[240:243], v[64:67], v[44:47], v[240:243]
    s_nop 0
    s_waitcnt lgkmcnt(0)
    v_mfma_f32_16x16x32_bf16 v[128:131], v[48:51], v[16:19], v[128:131]
    ds_read_b128 v[32:35], v6 offset:4096
    v_mfma_f32_16x16x32_bf16 v[132:135], v[52:55], v[16:19], v[132:135]
    ds_read_b128 v[36:39], v6 offset:5120
    v_mfma_f32_16x16x32_bf16 v[136:139], v[56:59], v[16:19], v[136:139]
    ds_read_b128 v[40:43], v6 offset:6144
    v_mfma_f32_16x16x32_bf16 v[140:143], v[60:63], v[16:19], v[140:143]
    ds_read_b128 v[44:47], v6 offset:7168
    v_mfma_f32_16x16x32_bf16 v[156:159], v[60:63], v[20:23], v[156:159]
    s_add_u32 m0, s35, 49152
    v_mfma_f32_16x16x32_bf16 v[152:155], v[56:59], v[20:23], v[152:155]
    buffer_load_dwordx4 v3, s[12:15], s33 offen lds
    v_mfma_f32_16x16x32_bf16 v[148:151], v[52:55], v[20:23], v[148:151]
    v_mfma_f32_16x16x32_bf16 v[144:147], v[48:51], v[20:23], v[144:147]
    s_add_u32 m0, s35, 57344
    v_mfma_f32_16x16x32_bf16 v[160:163], v[48:51], v[24:27], v[160:163]
    buffer_load_dwordx4 v3, s[16:19], s33 offen lds
    s_add_u32 s33, s33, 32*7168
    v_mfma_f32_16x16x32_bf16 v[164:167], v[52:55], v[24:27], v[164:167]
    v_mfma_f32_16x16x32_bf16 v[168:171], v[56:59], v[24:27], v[168:171]
    s_add_u32 m0, s34, 33792
    v_mfma_f32_16x16x32_bf16 v[172:175], v[60:63], v[24:27], v[172:175]
    buffer_load_dwordx4 v2, s[8:11], s32 offen sc1 lds
    v_mfma_f32_16x16x32_bf16 v[188:191], v[60:63], v[28:31], v[188:191]
    v_mfma_f32_16x16x32_bf16 v[184:187], v[56:59], v[28:31], v[184:187]
    v_mfma_f32_16x16x32_bf16 v[180:183], v[52:55], v[28:31], v[180:183]
    buffer_load_dwordx4 v2, s[8:11], s32 offen offset:1024 sc1 lds
    s_add_u32 s32, s32, 2048
    v_mfma_f32_16x16x32_bf16 v[176:179], v[48:51], v[28:31], v[176:179]
    s_waitcnt vmcnt(8) lgkmcnt(0)
    s_barrier
    v_mfma_f32_16x16x32_bf16 v[192:195], v[48:51], v[32:35], v[192:195]
    ds_read_b64_tr_b16 v[64:65], v9 offset:32768
    v_mfma_f32_16x16x32_bf16 v[196:199], v[52:55], v[32:35], v[196:199]
    ds_read_b64_tr_b16 v[66:67], v9 offset:33792
    v_mfma_f32_16x16x32_bf16 v[200:203], v[56:59], v[32:35], v[200:203]
    ds_read_b64_tr_b16 v[68:69], v12 offset:32768
    v_mfma_f32_16x16x32_bf16 v[204:207], v[60:63], v[32:35], v[204:207]
    ds_read_b64_tr_b16 v[70:71], v12 offset:33792
    v_mfma_f32_16x16x32_bf16 v[220:223], v[60:63], v[36:39], v[220:223]
    ds_read_b64_tr_b16 v[72:73], v9 offset:40960
    v_mfma_f32_16x16x32_bf16 v[216:219], v[56:59], v[36:39], v[216:219]
    ds_read_b64_tr_b16 v[74:75], v9 offset:41984
    v_mfma_f32_16x16x32_bf16 v[212:215], v[52:55], v[36:39], v[212:215]
    ds_read_b64_tr_b16 v[76:77], v12 offset:40960
    v_mfma_f32_16x16x32_bf16 v[208:211], v[48:51], v[36:39], v[208:211]
    ds_read_b64_tr_b16 v[78:79], v12 offset:41984
    v_mfma_f32_16x16x32_bf16 v[224:227], v[48:51], v[40:43], v[224:227]
    ds_read_b128 v[16:19], v6 offset:32768
    v_mfma_f32_16x16x32_bf16 v[228:231], v[52:55], v[40:43], v[228:231]
    ds_read_b128 v[20:23], v6 offset:33792
    v_mfma_f32_16x16x32_bf16 v[232:235], v[56:59], v[40:43], v[232:235]
    ds_read_b128 v[24:27], v6 offset:34816
    v_mfma_f32_16x16x32_bf16 v[236:239], v[60:63], v[40:43], v[236:239]
    ds_read_b128 v[28:31], v6 offset:35840
    v_mfma_f32_16x16x32_bf16 v[252:255], v[60:63], v[44:47], v[252:255]
    v_mfma_f32_16x16x32_bf16 v[248:251], v[56:59], v[44:47], v[248:251]
    v_mfma_f32_16x16x32_bf16 v[244:247], v[52:55], v[44:47], v[244:247]
    v_mfma_f32_16x16x32_bf16 v[240:243], v[48:51], v[44:47], v[240:243]
    s_sub_u32 s45, s45, 1
    s_cmp_lg_u32 s45, 0
    s_cbranch_scc1 k2_loop
    s_waitcnt lgkmcnt(0)
    v_mfma_f32_16x16x32_bf16 v[128:131], v[64:67], v[16:19], v[128:131]
    ds_read_b128 v[32:35], v6 offset:36864
    v_mfma_f32_16x16x32_bf16 v[132:135], v[68:71], v[16:19], v[132:135]
    ds_read_b128 v[36:39], v6 offset:37888
    v_mfma_f32_16x16x32_bf16 v[136:139], v[72:75], v[16:19], v[136:139]
    ds_read_b128 v[40:43], v6 offset:38912
    v_mfma_f32_16x16x32_bf16 v[140:143], v[76:79], v[16:19], v[140:143]
    ds_read_b128 v[44:47], v6 offset:39936
    v_mfma_f32_16x16x32_bf16 v[156:159], v[76:79], v[20:23], v[156:159]
    s_add_u32 m0, s35, 81920
    v_mfma_f32_16x16x32_bf16 v[152:155], v[72:75], v[20:23], v[152:155]
    buffer_load_dwordx4 v3, s[12:15], s33 offen lds
    v_mfma_f32_16x16x32_bf16 v[148:151], v[68:71], v[20:23], v[148:151]
    v_mfma_f32_16x16x32_bf16 v[144:147], v[64:67], v[20:23], v[144:147]
    s_add_u32 m0, s35, 90112
    v_mfma_f32_16x16x32_bf16 v[160:163], v[64:67], v[24:27], v[160:163]
    buffer_load_dwordx4 v3, s[16:19], s33 offen lds
    s_add_u32 s33, s33, 32*7168
    v_mfma_f32_16x16x32_bf16 v[164:167], v[68:71], v[24:27], v[164:167]
    v_mfma_f32_16x16x32_bf16 v[168:171], v[72:75], v[24:27], v[168:171]
    s_add_u32 m0, s34, 66560
    v_mfma_f32_16x16x32_bf16 v[172:175], v[76:79], v[24:27], v[172:175]
    buffer_load_dwordx4 v2, s[8:11], s32 offen sc1 lds
    v_mfma_f32_16x16x32_bf16 v[188:191], v[76:79], v[28:31], v[188:191]
    v_mfma_f32_16x16x32_bf16 v[184:187], v[72:75], v[28:31], v[184:187]
    v_mfma_f32_16x16x32_bf16 v[180:183], v[68:71], v[28:31], v[180:183]
    buffer_load_dwordx4 v2, s[8:11], s32 offen offset:1024 sc1 lds
    s_add_u32 s32, s32, 2048
    v_mfma_f32_16x16x32_bf16 v[176:179], v[64:67], v[28:31], v[176:179]
    s_waitcnt vmcnt(8) lgkmcnt(0)
    s_barrier
    v_mfma_f32_16x16x32_bf16 v[192:195], v[64:67], v[32:35], v[192:195]
    ds_read_b64_tr_b16 v[48:49], v8 offset:0
    v_mfma_f32_16x16x32_bf16 v[196:199], v[68:71], v[32:35], v[196:199]
    ds_read_b64_tr_b16 v[50:51], v8 offset:1024
    v_mfma_f32_16x16x32_bf16 v[200:203], v[72:75], v[32:35], v[200:203]
    ds_read_b64_tr_b16 v[52:53], v11 offset:0
    v_mfma_f32_16x16x32_bf16 v[204:207], v[76:79], v[32:35], v[204:207]
    ds_read_b64_tr_b16 v[54:55], v11 offset:1024
    v_mfma_f32_16x16x32_bf16 v[220:223], v[76:79], v[36:39], v[220:223]
    ds_read_b64_tr_b16 v[56:57], v8 offset:8192
    v_mfma_f32_16x16x32_bf16 v[216:219], v[72:75], v[36:39], v[216:219]
    ds_read_b64_tr_b16 v[58:59], v8 offset:9216
    v_mfma_f32_16x16x32_bf16 v[212:215], v[68:71], v[36:39], v[212:215]
    ds_read_b64_tr_b16 v[60:61], v11 offset:8192
    v_mfma_f32_16x16x32_bf16 v[208:211], v[64:67], v[36:39], v[208:211]
    ds_read_b64_tr_b16 v[62:63], v11 offset:9216
    v_mfma_f32_16x16x32_bf16 v[224:227], v[64:67], v[40:43], v[224:227]
    ds_read_b128 v[16:19], v5 offset:0
    v_mfma_f32_16x16x32_bf16 v[228:231], v[68:71], v[40:43], v[228:231]
    ds_read_b128 v[20:23], v5 offset:1024
    v_mfma_f32_16x16x32_bf16 v[232:235], v[72:75], v[40:43], v[232:235]
    ds_read_b128 v[24:27], v5 offset:2048
    v_mfma_f32_16x16x32_bf16 v[236:239], v[76:79], v[40:43], v[236:239]
    ds_read_b128 v[28:31], v5 offset:3072
    v_mfma_f32_16x16x32_bf16 v[252:255], v[76:79], v[44:47], v[252:255]
    v_mfma_f32_16x16x32_bf16 v[248:251], v[72:75], v[44:47], v[248:251]
    v_mfma_f32_16x16x32_bf16 v[244:247], v[68:71], v[44:47], v[244:247]
    v_mfma_f32_16x16x32_bf16 v[240:243], v[64:67], v[44:47], v[240:243]
    s_nop 0
    s_waitcnt lgkmcnt(0)
    v_mfma_f32_16x16x32_bf16 v[128:131], v[48:51], v[16:19], v[128:131]
    ds_read_b128 v[32:35], v5 offset:4096
    v_mfma_f32_16x16x32_bf16 v[132:135], v[52:55], v[16:19], v[132:135]
    ds_read_b128 v[36:39], v5 offset:5120
    v_mfma_f32_16x16x32_bf16 v[136:139], v[56:59], v[16:19], v[136:139]
    ds_read_b128 v[40:43], v5 offset:6144
    v_mfma_f32_16x16x32_bf16 v[140:143], v[60:63], v[16:19], v[140:143]
    ds_read_b128 v[44:47], v5 offset:7168
    v_mfma_f32_16x16x32_bf16 v[156:159], v[60:63], v[20:23], v[156:159]
    s_add_u32 m0, s35, 114688
    v_mfma_f32_16x16x32_bf16 v[152:155], v[56:59], v[20:23], v[152:155]
    buffer_load_dwordx4 v3, s[12:15], s33 offen lds
    v_mfma_f32_16x16x32_bf16 v[148:151], v[52:55], v[20:23], v[148:151]
    v_mfma_f32_16x16x32_bf16 v[144:147], v[48:51], v[20:23], v[144:147]
    s_add_u32 m0, s35, 122880
    v_mfma_f32_16x16x32_bf16 v[160:163], v[48:51], v[24:27], v[160:163]
    buffer_load_dwordx4 v3, s[16:19], s33 offen lds
    s_add_u32 s33, s33, 32*7168
    v_mfma_f32_16x16x32_bf16 v[164:167], v[52:55], v[24:27], v[164:167]
    v_mfma_f32_16x16x32_bf16 v[168:171], v[56:59], v[24:27], v[168:171]
    s_add_u32 m0, s34, 99328
    v_mfma_f32_16x16x32_bf16 v[172:175], v[60:63], v[24:27], v[172:175]
    buffer_load_dwordx4 v2, s[8:11], s32 offen sc1 lds
    v_mfma_f32_16x16x32_bf16 v[188:191], v[60:63], v[28:31], v[188:191]
    v_mfma_f32_16x16x32_bf16 v[184:187], v[56:59], v[28:31], v[184:187]
    v_mfma_f32_16x16x32_bf16 v[180:183], v[52:55], v[28:31], v[180:183]
    buffer_load_dwordx4 v2, s[8:11], s32 offen offset:1024 sc1 lds
    s_add_u32 s32, s32, 2048
    v_mfma_f32_16x16x32_bf16 v[176:179], v[48:51], v[28:31], v[176:179]
    s_waitcnt vmcnt(8) lgkmcnt(0)
    s_barrier
    v_mfma_f32_16x16x32_bf16 v[192:195], v[48:51], v[32:35], v[192:195]
    ds_read_b64_tr_b16 v[64:65], v8 offset:32768
    v_mfma_f32_16x16x32_bf16 v[196:199], v[52:55], v[32:35], v[196:199]
    ds_read_b64_tr_b16 v[66:67], v8 offset:33792
    v_mfma_f32_16x16x32_bf16 v[200:203], v[56:59], v[32:35], v[200:203]
    ds_read_b64_tr_b16 v[68:69], v11 offset:32768
    v_mfma_f32_16x16x32_bf16 v[204:207], v[60:63], v[32:35], v[204:207]
    ds_read_b64_tr_b16 v[70:71], v11 offset:33792
    v_mfma_f32_16x16x32_bf16 v[220:223], v[60:63], v[36:39], v[220:223]
    ds_read_b64_tr_b16 v[72:73], v8 offset:40960
    v_mfma_f32_16x16x32_bf16 v[216:219], v[56:59], v[36:39], v[216:219]
    ds_read_b64_tr_b16 v[74:75], v8 offset:41984
    v_mfma_f32_16x16x32_bf16 v[212:215], v[52:55], v[36:39], v[212:215]
    ds_read_b64_tr_b16 v[76:77], v11 offset:40960
    v_mfma_f32_16x16x32_bf16 v[208:211], v[48:51], v[36:39], v[208:211]
    ds_read_b64_tr_b16 v[78:79], v11 offset:41984
    v_mfma_f32_16x16x32_bf16 v[224:227], v[48:51], v[40:43], v[224:227]
    ds_read_b128 v[16:19], v5 offset:32768
    v_mfma_f32_16x16x32_bf16 v[228:231], v[52:55], v[40:43], v[228:231]
    ds_read_b128 v[20:23], v5 offset:33792
    v_mfma_f32_16x16x32_bf16 v[232:235], v[56:59], v[40:43], v[232:235]
    ds_read_b128 v[24:27], v5 offset:34816
    v_mfma_f32_16x16x32_bf16 v[236:239], v[60:63], v[40:43], v[236:239]
    ds_read_b128 v[28:31], v5 offset:35840
    v_mfma_f32_16x16x32_bf16 v[252:255], v[60:63], v[44:47], v[252:255]
    v_mfma_f32_16x16x32_bf16 v[248:251], v[56:59], v[44:47], v[248:251]
    v_mfma_f32_16x16x32_bf16 v[244:247], v[52:55], v[44:47], v[244:247]
    v_mfma_f32_16x16x32_bf16 v[240:243], v[48:51], v[44:47], v[240:243]
    s_nop 0
    s_waitcnt lgkmcnt(0)
    v_mfma_f32_16x16x32_bf16 v[128:131], v[64:67], v[16:19], v[128:131]
    ds_read_b128 v[32:35], v5 offset:36864
    v_mfma_f32_16x16x32_bf16 v[132:135], v[68:71], v[16:19], v[132:135]
    ds_read_b128 v[36:39], v5 offset:37888
    v_mfma_f32_16x16x32_bf16 v[136:139], v[72:75], v[16:19], v[136:139]
    ds_read_b128 v[40:43], v5 offset:38912
    v_mfma_f32_16x16x32_bf16 v[140:143], v[76:79], v[16:19], v[140:143]
    ds_read_b128 v[44:47], v5 offset:39936
    v_mfma_f32_16x16x32_bf16 v[156:159], v[76:79], v[20:23], v[156:159]
    v_mfma_f32_16x16x32_bf16 v[152:155], v[72:75], v[20:23], v[152:155]
    v_mfma_f32_16x16x32_bf16 v[148:151], v[68:71], v[20:23], v[148:151]
    v_mfma_f32_16x16x32_bf16 v[144:147], v[64:67], v[20:23], v[144:147]
    v_mfma_f32_16x16x32_bf16 v[160:163], v[64:67], v[24:27], v[160:163]
    v_mfma_f32_16x16x32_bf16 v[164:167], v[68:71], v[24:27], v[164:167]
    v_mfma_f32_16x16x32_bf16 v[168:171], v[72:75], v[24:27], v[168:171]
    v_mfma_f32_16x16x32_bf16 v[172:175], v[76:79], v[24:27], v[172:175]
    v_mfma_f32_16x16x32_bf16 v[188:191], v[76:79], v[28:31], v[188:191]
    v_mfma_f32_16x16x32_bf16 v[184:187], v[72:75], v[28:31], v[184:187]
    v_mfma_f32_16x16x32_bf16 v[180:183], v[68:71], v[28:31], v[180:183]
    v_mfma_f32_16x16x32_bf16 v[176:179], v[64:67], v[28:31], v[176:179]
    s_waitcnt vmcnt(4) lgkmcnt(0)
    s_barrier
    v_mfma_f32_16x16x32_bf16 v[192:195], v[64:67], v[32:35], v[192:195]
    ds_read_b64_tr_b16 v[48:49], v9 offset:0
    v_mfma_f32_16x16x32_bf16 v[196:199], v[68:71], v[32:35], v[196:199]
    ds_read_b64_tr_b16 v[50:51], v9 offset:1024
    v_mfma_f32_16x16x32_bf16 v[200:203], v[72:75], v[32:35], v[200:203]
    ds_read_b64_tr_b16 v[52:53], v12 offset:0
    v_mfma_f32_16x16x32_bf16 v[204:207], v[76:79], v[32:35], v[204:207]
    ds_read_b64_tr_b16 v[54:55], v12 offset:1024
    v_mfma_f32_16x16x32_bf16 v[220:223], v[76:79], v[36:39], v[220:223]
    ds_read_b64_tr_b16 v[56:57], v9 offset:8192
    v_mfma_f32_16x16x32_bf16 v[216:219], v[72:75], v[36:39], v[216:219]
    ds_read_b64_tr_b16 v[58:59], v9 offset:9216
    v_mfma_f32_16x16x32_bf16 v[212:215], v[68:71], v[36:39], v[212:215]
    ds_read_b64_tr_b16 v[60:61], v12 offset:8192
    v_mfma_f32_16x16x32_bf16 v[208:211], v[64:67], v[36:39], v[208:211]
    ds_read_b64_tr_b16 v[62:63], v12 offset:9216
    v_mfma_f32_16x16x32_bf16 v[224:227], v[64:67], v[40:43], v[224:227]
    ds_read_b128 v[16:19], v6 offset:0
    v_mfma_f32_16x16x32_bf16 v[228:231], v[68:71], v[40:43], v[228:231]
    ds_read_b128 v[20:23], v6 offset:1024
    v_mfma_f32_16x16x32_bf16 v[232:235], v[72:75], v[40:43], v[232:235]
    ds_read_b128 v[24:27], v6 offset:2048
    v_mfma_f32_16x16x32_bf16 v[236:239], v[76:79], v[40:43], v[236:239]
    ds_read_b128 v[28:31], v6 offset:3072
    v_mfma_f32_16x16x32_bf16 v[252:255], v[76:79], v[44:47], v[252:255]
    v_mfma_f32_16x16x32_bf16 v[248:251], v[72:75], v[44:47], v[248:251]
    v_mfma_f32_16x16x32_bf16 v[244:247], v[68:71], v[44:47], v[244:247]
    v_mfma_f32_16x16x32_bf16 v[240:243], v[64:67], v[44:47], v[240:243]
    s_nop 0
    s_waitcnt lgkmcnt(0)
    v_mfma_f32_16x16x32_bf16 v[128:131], v[48:51], v[16:19], v[128:131]
    ds_read_b128 v[32:35], v6 offset:4096
    v_mfma_f32_16x16x32_bf16 v[132:135], v[52:55], v[16:19], v[132:135]
    ds_read_b128 v[36:39], v6 offset:5120
    v_mfma_f32_16x16x32_bf16 v[136:139], v[56:59], v[16:19], v[136:139]
    ds_read_b128 v[40:43], v6 offset:6144
    v_mfma_f32_16x16x32_bf16 v[140:143], v[60:63], v[16:19], v[140:143]
    ds_read_b128 v[44:47], v6 offset:7168
    v_mfma_f32_16x16x32_bf16 v[156:159], v[60:63], v[20:23], v[156:159]
    v_mfma_f32_16x16x32_bf16 v[152:155], v[56:59], v[20:23], v[152:155]
    v_mfma_f32_16x16x32_bf16 v[148:151], v[52:55], v[20:23], v[148:151]
    v_mfma_f32_16x16x32_bf16 v[144:147], v[48:51], v[20:23], v[144:147]
    v_mfma_f32_16x16x32_bf16 v[160:163], v[48:51], v[24:27], v[160:163]
    v_mfma_f32_16x16x32_bf16 v[164:167], v[52:55], v[24:27], v[164:167]
    v_mfma_f32_16x16x32_bf16 v[168:171], v[56:59], v[24:27], v[168:171]
    v_mfma_f32_16x16x32_bf16 v[172:175], v[60:63], v[24:27], v[172:175]
    v_mfma_f32_16x16x32_bf16 v[188:191], v[60:63], v[28:31], v[188:191]
    v_mfma_f32_16x16x32_bf16 v[184:187], v[56:59], v[28:31], v[184:187]
    v_mfma_f32_16x16x32_bf16 v[180:183], v[52:55], v[28:31], v[180:183]
    v_mfma_f32_16x16x32_bf16 v[176:179], v[48:51], v[28:31], v[176:179]
    s_waitcnt vmcnt(0) lgkmcnt(0)
    s_barrier
    v_mfma_f32_16x16x32_bf16 v[192:195], v[48:51], v[32:35], v[192:195]
    ds_read_b64_tr_b16 v[64:65], v9 offset:32768
    v_mfma_f32_16x16x32_bf16 v[196:199], v[52:55], v[32:35], v[196:199]
    ds_read_b64_tr_b16 v[66:67], v9 offset:33792
    v_mfma_f32_16x16x32_bf16 v[200:203], v[56:59], v[32:35], v[200:203]
    ds_read_b64_tr_b16 v[68:69], v12 offset:32768
    v_mfma_f32_16x16x32_bf16 v[204:207], v[60:63], v[32:35], v[204:207]
    ds_read_b64_tr_b16 v[70:71], v12 offset:33792
    v_mfma_f32_16x16x32_bf16 v[220:223], v[60:63], v[36:39], v[220:223]
    ds_read_b64_tr_b16 v[72:73], v9 offset:40960
    v_mfma_f32_16x16x32_bf16 v[216:219], v[56:59], v[36:39], v[216:219]
    ds_read_b64_tr_b16 v[74:75], v9 offset:41984
    v_mfma_f32_16x16x32_bf16 v[212:215], v[52:55], v[36:39], v[212:215]
    ds_read_b64_tr_b16 v[76:77], v12 offset:40960
    v_mfma_f32_16x16x32_bf16 v[208:211], v[48:51], v[36:39], v[208:211]
    ds_read_b64_tr_b16 v[78:79], v12 offset:41984
    v_mfma_f32_16x16x32_bf16 v[224:227], v[48:51], v[40:43], v[224:227]
    ds_read_b128 v[16:19], v6 offset:32768
    v_mfma_f32_16x16x32_bf16 v[228:231], v[52:55], v[40:43], v[228:231]
    ds_read_b128 v[20:23], v6 offset:33792
    v_mfma_f32_16x16x32_bf16 v[232:235], v[56:59], v[40:43], v[232:235]
    ds_read_b128 v[24:27], v6 offset:34816
    v_mfma_f32_16x16x32_bf16 v[236:239], v[60:63], v[40:43], v[236:239]
    ds_read_b128 v[28:31], v6 offset:35840
    v_mfma_f32_16x16x32_bf16 v[252:255], v[60:63], v[44:47], v[252:255]
    v_mfma_f32_16x16x32_bf16 v[248:251], v[56:59], v[44:47], v[248:251]
    v_mfma_f32_16x16x32_bf16 v[244:247], v[52:55], v[44:47], v[244:247]
    v_mfma_f32_16x16x32_bf16 v[240:243], v[48:51], v[44:47], v[240:243]
    s_nop 0
    s_waitcnt lgkmcnt(0)
    v_mfma_f32_16x16x32_bf16 v[128:131], v[64:67], v[16:19], v[128:131]
    ds_read_b128 v[32:35], v6 offset:36864
    v_mfma_f32_16x16x32_bf16 v[132:135], v[68:71], v[16:19], v[132:135]
    ds_read_b128 v[36:39], v6 offset:37888
    v_mfma_f32_16x16x32_bf16 v[136:139], v[72:75], v[16:19], v[136:139]
    ds_read_b128 v[40:43], v6 offset:38912
    v_mfma_f32_16x16x32_bf16 v[140:143], v[76:79], v[16:19], v[140:143]
    ds_read_b128 v[44:47], v6 offset:39936
    v_mfma_f32_16x16x32_bf16 v[156:159], v[76:79], v[20:23], v[156:159]
    v_mfma_f32_16x16x32_bf16 v[152:155], v[72:75], v[20:23], v[152:155]
    v_mfma_f32_16x16x32_bf16 v[148:151], v[68:71], v[20:23], v[148:151]
    v_mfma_f32_16x16x32_bf16 v[144:147], v[64:67], v[20:23], v[144:147]
    v_mfma_f32_16x16x32_bf16 v[160:163], v[64:67], v[24:27], v[160:163]
    v_mfma_f32_16x16x32_bf16 v[164:167], v[68:71], v[24:27], v[164:167]
    v_mfma_f32_16x16x32_bf16 v[168:171], v[72:75], v[24:27], v[168:171]
    v_mfma_f32_16x16x32_bf16 v[172:175], v[76:79], v[24:27], v[172:175]
    v_mfma_f32_16x16x32_bf16 v[188:191], v[76:79], v[28:31], v[188:191]
    v_mfma_f32_16x16x32_bf16 v[184:187], v[72:75], v[28:31], v[184:187]
    v_mfma_f32_16x16x32_bf16 v[180:183], v[68:71], v[28:31], v[180:183]
    v_mfma_f32_16x16x32_bf16 v[176:179], v[64:67], v[28:31], v[176:179]
    s_waitcnt lgkmcnt(0)
    s_lshl_b32 s32, s28, 3
    s_lshl_b32 s33, s31, 2
    s_add_u32 s32, s32, s33
    s_mul_i32 s32, s32, 112
    s_lshl_b32 s33, s29, 2
    s_add_u32 s32, s32, s33
    s_add_u32 s32, s32, s30
    s_lshl_b32 s32, s32, 11
    buffer_load_dwordx4 v[116:119], v2, s[84:87], 0 offen sc1
    v_mfma_f32_16x16x32_bf16 v[192:195], v[64:67], v[32:35], v[192:195]
    v_mul_f32 v128, v128, v136
    v_mul_f32 v129, v129, v137
    v_mul_f32_e64 v130, v130, v138
    v_mfma_f32_16x16x32_bf16 v[196:199], v[68:71], v[32:35], v[196:199]
    v_mul_f32 v131, v131, v139
    v_mul_f32 v132, v132, v140
    v_mul_f32_e64 v133, v133, v141
    v_mfma_f32_16x16x32_bf16 v[200:203], v[72:75], v[32:35], v[200:203]
    v_mul_f32 v134, v134, v142
    v_mul_f32 v135, v135, v143
    v_cvt_pk_bf16_f32 v80, v128, v129
    v_mfma_f32_16x16x32_bf16 v[204:207], v[76:79], v[32:35], v[204:207]
    v_cvt_pk_bf16_f32 v81, v130, v131
    v_cvt_pk_bf16_f32 v82, v132, v133
    v_cvt_pk_bf16_f32 v83, v134, v135
    buffer_store_dwordx4 v[80:83], v2, s[20:23], s32 offen offset:0 sc1
    v_mfma_f32_16x16x32_bf16 v[220:223], v[76:79], v[36:39], v[220:223]
    v_mul_f32 v144, v144, v152
    v_mul_f32 v145, v145, v153
    v_mul_f32_e64 v146, v146, v154
    v_mfma_f32_16x16x32_bf16 v[216:219], v[72:75], v[36:39], v[216:219]
    v_mul_f32 v147, v147, v155
    v_mul_f32 v148, v148, v156
    v_mul_f32_e64 v149, v149, v157
    v_mfma_f32_16x16x32_bf16 v[212:215], v[68:71], v[36:39], v[212:215]
    v_mul_f32 v150, v150, v158
    v_mul_f32 v151, v151, v159
    v_cvt_pk_bf16_f32 v84, v144, v145
    v_mfma_f32_16x16x32_bf16 v[208:211], v[64:67], v[36:39], v[208:211]
    v_cvt_pk_bf16_f32 v85, v146, v147
    v_cvt_pk_bf16_f32 v86, v148, v149
    v_cvt_pk_bf16_f32 v87, v150, v151
    buffer_store_dwordx4 v[84:87], v2, s[20:23], s32 offen offset:1024 sc1
    s_add_u32 s32, s32, 224*1024
    v_mfma_f32_16x16x32_bf16 v[224:227], v[64:67], v[40:43], v[224:227]
    v_mul_f32 v160, v160, v168
    v_mul_f32 v161, v161, v169
    v_mul_f32_e64 v162, v162, v170
    v_mfma_f32_16x16x32_bf16 v[228:231], v[68:71], v[40:43], v[228:231]
    v_mul_f32 v163, v163, v171
    v_mul_f32 v164, v164, v172
    v_mul_f32_e64 v165, v165, v173
    v_mfma_f32_16x16x32_bf16 v[232:235], v[72:75], v[40:43], v[232:235]
    v_mul_f32 v166, v166, v174
    v_mul_f32 v167, v167, v175
    v_cvt_pk_bf16_f32 v88, v160, v161
    v_mfma_f32_16x16x32_bf16 v[236:239], v[76:79], v[40:43], v[236:239]
    v_cvt_pk_bf16_f32 v89, v162, v163
    v_cvt_pk_bf16_f32 v90, v164, v165
    v_cvt_pk_bf16_f32 v91, v166, v167
    buffer_store_dwordx4 v[88:91], v2, s[20:23], s32 offen offset:0 sc1
    v_mfma_f32_16x16x32_bf16 v[252:255], v[76:79], v[44:47], v[252:255]
    v_mul_f32 v176, v176, v184
    v_mul_f32 v177, v177, v185
    v_mul_f32_e64 v178, v178, v186
    v_mfma_f32_16x16x32_bf16 v[248:251], v[72:75], v[44:47], v[248:251]
    v_mul_f32 v179, v179, v187
    v_mul_f32 v180, v180, v188
    v_mul_f32_e64 v181, v181, v189
    v_mfma_f32_16x16x32_bf16 v[244:247], v[68:71], v[44:47], v[244:247]
    v_mul_f32 v182, v182, v190
    v_mul_f32 v183, v183, v191
    v_cvt_pk_bf16_f32 v92, v176, v177
    v_mfma_f32_16x16x32_bf16 v[240:243], v[64:67], v[44:47], v[240:243]
    v_cvt_pk_bf16_f32 v93, v178, v179
    v_cvt_pk_bf16_f32 v94, v180, v181
    v_cvt_pk_bf16_f32 v95, v182, v183
    buffer_store_dwordx4 v[92:95], v2, s[20:23], s32 offen offset:1024 sc1
    s_add_u32 s32, s32, 224*1024
    v_mul_f32 v192, v192, v200
    v_mul_f32 v193, v193, v201
    v_mul_f32 v194, v194, v202
    v_mul_f32 v195, v195, v203
    v_mul_f32 v196, v196, v204
    v_mul_f32 v197, v197, v205
    v_mul_f32 v198, v198, v206
    v_mul_f32 v199, v199, v207
    v_cvt_pk_bf16_f32 v96, v192, v193
    v_cvt_pk_bf16_f32 v97, v194, v195
    v_cvt_pk_bf16_f32 v98, v196, v197
    v_cvt_pk_bf16_f32 v99, v198, v199
    buffer_store_dwordx4 v[96:99], v2, s[20:23], s32 offen offset:0 sc1
    v_mul_f32 v208, v208, v216
    v_mul_f32 v209, v209, v217
    v_mul_f32 v210, v210, v218
    v_mul_f32 v211, v211, v219
    v_mul_f32 v212, v212, v220
    v_mul_f32 v213, v213, v221
    v_mul_f32 v214, v214, v222
    v_mul_f32 v215, v215, v223
    v_cvt_pk_bf16_f32 v100, v208, v209
    v_cvt_pk_bf16_f32 v101, v210, v211
    v_cvt_pk_bf16_f32 v102, v212, v213
    v_cvt_pk_bf16_f32 v103, v214, v215
    buffer_store_dwordx4 v[100:103], v2, s[20:23], s32 offen offset:1024 sc1
    s_add_u32 s32, s32, 224*1024
    v_mul_f32 v224, v224, v232
    v_mul_f32 v225, v225, v233
    v_mul_f32 v226, v226, v234
    v_mul_f32 v227, v227, v235
    v_mul_f32 v228, v228, v236
    v_mul_f32 v229, v229, v237
    v_mul_f32 v230, v230, v238
    v_mul_f32 v231, v231, v239
    v_cvt_pk_bf16_f32 v104, v224, v225
    v_cvt_pk_bf16_f32 v105, v226, v227
    v_cvt_pk_bf16_f32 v106, v228, v229
    v_cvt_pk_bf16_f32 v107, v230, v231
    buffer_store_dwordx4 v[104:107], v2, s[20:23], s32 offen offset:0 sc1
    v_mul_f32 v240, v240, v248
    v_mul_f32 v241, v241, v249
    v_mul_f32 v242, v242, v250
    v_mul_f32 v243, v243, v251
    v_mul_f32 v244, v244, v252
    v_mul_f32 v245, v245, v253
    v_mul_f32 v246, v246, v254
    v_mul_f32 v247, v247, v255
    v_cvt_pk_bf16_f32 v108, v240, v241
    v_cvt_pk_bf16_f32 v109, v242, v243
    v_cvt_pk_bf16_f32 v110, v244, v245
    v_cvt_pk_bf16_f32 v111, v246, v247
    buffer_store_dwordx4 v[108:111], v2, s[20:23], s32 offen offset:1024 sc1
    s_add_u32 s32, s32, 224*1024
    s_cmp_ge_u32 s29, 14
    s_nop 0
    s_cselect_b32 s57, 128-56, 0
    s_lshl_b32 s28, s28, 8
    s_lshl_b32 s29, s29, 2
    s_add_u32 s57, s57, s28
    s_add_u32 s57, s57, s29
    s_waitcnt vmcnt(8)
    v_mov_b32 v240, v116
    v_mov_b32 v241, v117
    v_mov_b32 v242, v118
    v_mov_b32 v243, v119
    s_branch k3_in
k2_end:
    s_endpgm
k2_fft:
    s_cmp_lg_u32 s3, 0
    s_cbranch_scc1 k2_wd_s
    v_mov_b32 v240, 0
    v_mov_b32 v241, 1
    v_mov_b32 v242, 1
    v_mov_b32 v243, 1
    v_lshlrev_b32 v244, 4, v0
    v_add_u32 v244, 4096, v244
    s_mov_b32 s59, 0x40000
    s_waitcnt vmcnt(63)
k2_wd:
    v_and_b32 v240, v240, v241
    v_and_b32 v242, v242, v243
    v_and_b32 v240, v240, v242
    v_cmp_ne_u32 vcc, 1, v240
    s_sub_u32 s59, s59, 1
    s_cbranch_scc1 k2_wd_x
    s_cbranch_vccz k2_wd_x
    buffer_load_dwordx4 v[240:243], v244, s[84:87], 0 offen offset:0 sc1
    s_waitcnt vmcnt(0)
    s_branch k2_wd
k2_wd_x:
k2_wd_s:
    s_barrier
    s_waitcnt lgkmcnt(0)
    s_add_u32 s8, s6, 4194304
    s_addc_u32 s9, s7, 0
    s_nop 0
    s_mov_b32 s10, 4194304
    s_mov_b32 s11, 0x20000
    s_mov_b32 s12, s40
    s_mov_b32 s13, s41
    s_mov_b32 s14, 2101248
    s_mov_b32 s15, 0x20000
    s_mov_b32 s16, s42
    s_mov_b32 s17, s43
    s_mov_b32 s18, 2101248
    s_mov_b32 s19, 0x20000
    s_add_u32 s20, s6, 25165824
    s_addc_u32 s21, s7, 0
    s_nop 0
    s_mov_b32 s22, 4194304
    s_mov_b32 s23, 0x20000
    v_lshrrev_b32 v2, 2, v0
    v_lshlrev_b32 v2, 11, v2
    v_and_b32_e64 v3, 3, v0
    v_lshl_add_u32 v2, v3, 4, v2
    s_lshl_b32 s28, s2, 17
    s_lshl_b32 s29, s3, 8
    s_add_u32 s28, s28, s29
    s_lshl_b32 s29, s3, 14
    s_add_u32 m0, s29, 0
    s_add_u32 s30, s28, 0
    buffer_load_dwordx4 v2, s[8:11], s30 offen sc1 lds
    s_add_u32 m0, s29, 1024
    s_add_u32 s30, s28, 32768
    buffer_load_dwordx4 v2, s[8:11], s30 offen sc1 lds
    s_add_u32 m0, s29, 2048
    s_add_u32 s30, s28, 65536
    buffer_load_dwordx4 v2, s[8:11], s30 offen sc1 lds
    s_add_u32 m0, s29, 3072
    s_add_u32 s30, s28, 98304
    buffer_load_dwordx4 v2, s[8:11], s30 offen sc1 lds
    s_add_u32 m0, s29, 4096
    s_add_u32 s30, s28, 64
    s_nop 0
    buffer_load_dwordx4 v2, s[8:11], s30 offen sc1 lds
    s_add_u32 m0, s29, 5120
    s_add_u32 s30, s28, 32832
    buffer_load_dwordx4 v2, s[8:11], s30 offen sc1 lds
    s_add_u32 m0, s29, 6144
    s_add_u32 s30, s28, 65600
    buffer_load_dwordx4 v2, s[8:11], s30 offen sc1 lds
    s_add_u32 m0, s29, 7168
    s_add_u32 s30, s28, 98368
    buffer_load_dwordx4 v2, s[8:11], s30 offen sc1 lds
    s_add_u32 m0, s29, 8192
    s_add_u32 s30, s28, 128
    buffer_load_dwordx4 v2, s[8:11], s30 offen sc1 lds
    s_add_u32 m0, s29, 9216
    s_add_u32 s30, s28, 32896
    buffer_load_dwordx4 v2, s[8:11], s30 offen sc1 lds
    s_add_u32 m0, s29, 10240
    s_add_u32 s30, s28, 65664
    buffer_load_dwordx4 v2, s[8:11], s30 offen sc1 lds
    s_add_u32 m0, s29, 11264
    s_add_u32 s30, s28, 98432
    buffer_load_dwordx4 v2, s[8:11], s30 offen sc1 lds
    s_add_u32 m0, s29, 12288
    s_add_u32 s30, s28, 192
    buffer_load_dwordx4 v2, s[8:11], s30 offen sc1 lds
    s_add_u32 m0, s29, 13312
    s_add_u32 s30, s28, 32960
    buffer_load_dwordx4 v2, s[8:11], s30 offen sc1 lds
    s_add_u32 m0, s29, 14336
    s_add_u32 s30, s28, 65728
    buffer_load_dwordx4 v2, s[8:11], s30 offen sc1 lds
    s_add_u32 m0, s29, 15360
    s_add_u32 s30, s28, 98496
    buffer_load_dwordx4 v2, s[8:11], s30 offen sc1 lds
    v_lshrrev_b32 v4, 5, v0
    v_and_b32 v5, 31, v0
    v_lshlrev_b32_e64 v6, 1, v5
    v_lshl_add_u32 v6, v4, 8, v6
    v_sub_u32 v7, 320, v6
    s_lshl_b32 s50, s3, 12
    s_nop 0
    s_add_u32 s50, s50, 131072
    s_and_b32 s51, s2, 1
    s_lshl_b32 s51, s51, 1
    s_sub_u32 s52, s50, s51
    v_add_u32 v7, s52, v7
    s_add_u32 s52, s52, 2048
    v_add_u32 v6, s52, v6
    v_lshlrev_b32 v8, 4, v0
    v_add_u32 v8, s51, v8
    v_and_b32 v9, 2, v0
    v_lshlrev_b32 v9, 9, v9
    v_and_b32 v10, 1, v0
    v_cmp_eq_u32 s[54:55], 1, v10
    s_mov_b64 s[56:57], 1
    s_lshl_b32 s31, s3, 8
    s_add_u32 s31, s31, s2
    s_mov_b32 s32, 4
    s_cmp_lg_u32 s2, 0
    s_cbranch_scc1 pb_0
    s_add_u32 s31, s31, 32
    s_cmp_lt_u32 s3, 4
    s_cbranch_scc1 pb_0
    s_nop 0
    s_sub_u32 s31, s31, 1056
    s_cmp_lg_u32 s3, 4
    s_cbranch_scc1 pb_0
    s_mov_b32 s32, 5
pb_0:
    v_mov_b32 v152, 0
    v_mov_b32 v153, 0
    v_mov_b32 v154, 0
    v_mov_b32 v155, 0
    v_mov_b32 v156, 0
    v_mov_b32 v157, 0
    v_mov_b32 v158, 0
    v_mov_b32 v159, 0
    v_mov_b32 v160, 0
    v_mov_b32 v161, 0
    v_mov_b32 v162, 0
    v_mov_b32 v163, 0
    v_mov_b32 v164, 0
    v_mov_b32 v165, 0
    v_mov_b32 v166, 0
    v_mov_b32 v167, 0
    v_mov_b32 v168, 0
    v_mov_b32 v169, 0
    v_mov_b32 v170, 0
    v_mov_b32 v171, 0
    v_mov_b32 v172, 0
    v_mov_b32 v173, 0
    v_mov_b32 v174, 0
    v_mov_b32 v175, 0
    v_mov_b32 v176, 0
    v_mov_b32 v177, 0
    v_mov_b32 v178, 0
    v_mov_b32 v179, 0
    v_mov_b32 v180, 0
    v_mov_b32 v181, 0
    v_mov_b32 v182, 0
    v_mov_b32 v183, 0
    v_mov_b32 v184, 0
    v_mov_b32 v185, 0
    v_mov_b32 v186, 0
    v_mov_b32_e64 v187, 0
    s_sub_u32 s34, 2048, s31
    s_and_b32 s34, s34, 2047
    s_mul_i32 s33, s31, 1026
    s_mul_i32 s34, s34, 1026
    s_add_u32 m0, s50, 0
    s_nop 0
    buffer_load_dwordx4 v8, s[12:15], s34 offen lds
    s_add_u32 m0, s50, 1024
    s_nop 0
    s_nop 0
    buffer_load_dwordx4 v8, s[16:19], s34 offen lds
    s_add_u32 m0, s50, 2048
    s_nop 0
    s_nop 0
    buffer_load_dwordx4 v8, s[12:15], s33 offen lds
    s_add_u32 m0, s50, 3072
    s_nop 0
    s_nop 0
    buffer_load_dwordx4 v8, s[16:19], s33 offen lds
    v_add_u32 v10, s33, v9
    v_add_u32 v186, s34, v9
    v_cndmask_b32 v10, v10, v186, s[54:55]
    buffer_load_short_d16_hi v184, v10, s[12:15], 0 offen
    buffer_load_short_d16_hi v185, v10, s[16:19], 0 offen
    v_lshlrev_b32 v11, 6, v5
    v_add_u32 v11, s2, v11
    s_cmp_lg_u32 s2, 0
    s_cbranch_scc1 pb_1
    v_add_u32_e64 v12, 32, v11
    v_subrev_u32 v11, 1024, v11
    v_cmp_gt_u32 vcc, 16, v5
    s_nop 1
    v_cndmask_b32 v11, v11, v12, vcc
pb_1:
    v_cvt_f32_u32 v11, v11
    v_mul_f32 v11, 0x3a000000, v11
    v_lshlrev_b32 v12, 3, v4
    v_cvt_f32_u32 v12, v12
    v_mul_f32_e64 v12, v12, v11
    v_fmamk_f32 v120, v11, 0x00000000, v12
    v_fmamk_f32 v121, v11, 0x3f800000, v12
    v_cos_f32 v122, v120
    v_cos_f32 v123, v121
    v_sin_f32 v124, v120
    v_sin_f32 v125, v121
    v_cvt_pk_bf16_f32 v16, v122, v123
    v_cvt_pk_bf16_f32 v24, v124, v125
    v_xor_b32 v32, 0x80008000, v24
    v_fmamk_f32 v120, v11, 0x40000000, v12
    v_fmamk_f32 v121, v11, 0x40400000, v12
    v_cos_f32 v122, v120
    v_cos_f32 v123, v121
    v_sin_f32 v124, v120
    v_sin_f32 v125, v121
    v_cvt_pk_bf16_f32 v17, v122, v123
    v_cvt_pk_bf16_f32 v25, v124, v125
    v_xor_b32 v33, 0x80008000, v25
    v_fmamk_f32 v120, v11, 0x40800000, v12
    v_fmamk_f32 v121, v11, 0x40a00000, v12
    v_cos_f32 v122, v120
    v_cos_f32 v123, v121
    v_sin_f32 v124, v120
    v_sin_f32 v125, v121
    v_cvt_pk_bf16_f32 v18, v122, v123
    v_cvt_pk_bf16_f32 v26, v124, v125
    v_xor_b32 v34, 0x80008000, v26
    v_fmamk_f32 v120, v11, 0x40c00000, v12
    v_fmamk_f32 v121, v11, 0x40e00000, v12
    v_cos_f32 v122, v120
    v_cos_f32 v123, v121
    v_sin_f32 v124, v120
    v_sin_f32 v125, v121
    v_cvt_pk_bf16_f32 v19, v122, v123
    v_cvt_pk_bf16_f32 v27, v124, v125
    v_xor_b32 v35, 0x80008000, v27
    v_fmamk_f32 v120, v11, 0x41800000, v12
    v_fmamk_f32 v121, v11, 0x41880000, v12
    v_cos_f32 v122, v120
    v_cos_f32 v123, v121
    v_sin_f32 v124, v120
    v_sin_f32 v125, v121
    v_cvt_pk_bf16_f32 v20, v122, v123
    v_cvt_pk_bf16_f32 v28, v124, v125
    v_xor_b32 v36, 0x80008000, v28
    v_fmamk_f32 v120, v11, 0x41900000, v12
    v_fmamk_f32 v121, v11, 0x41980000, v12
    v_cos_f32 v122, v120
    v_cos_f32 v123, v121
    v_sin_f32 v124, v120
    v_sin_f32 v125, v121
    v_cvt_pk_bf16_f32 v21, v122, v123
    v_cvt_pk_bf16_f32 v29, v124, v125
    v_xor_b32 v37, 0x80008000, v29
    v_fmamk_f32 v120, v11, 0x41a00000, v12
    v_fmamk_f32 v121, v11, 0x41a80000, v12
    v_cos_f32 v122, v120
    v_cos_f32 v123, v121
    v_sin_f32 v124, v120
    v_sin_f32 v125, v121
    v_cvt_pk_bf16_f32 v22, v122, v123
    v_cvt_pk_bf16_f32 v30, v124, v125
    v_xor_b32 v38, 0x80008000, v30
    v_fmamk_f32 v120, v11, 0x41b00000, v12
    v_fmamk_f32 v121, v11, 0x41b80000, v12
    v_cos_f32 v122, v120
    v_cos_f32 v123, v121
    v_sin_f32 v124, v120
    v_sin_f32 v125, v121
    v_cvt_pk_bf16_f32 v23, v122, v123
    v_cvt_pk_bf16_f32 v31, v124, v125
    v_xor_b32 v39, 0x80008000, v31
    v_mov_b32 v40, v16
    v_mov_b32 v41, v17
    v_mov_b32 v42, v18
    v_mov_b32 v43, v19
    v_mov_b32 v44, v20
    v_mov_b32 v45, v21
    v_mov_b32 v46, v22
    v_mov_b32 v47, v23
    s_cmp_lg_u32 s2, 0
    s_cbranch_scc1 pb_2
    v_cmp_gt_u32_e64 vcc, 16, v5
    v_cmp_eq_u32 s[46:47], 16, v5
    v_mov_b32 v13, 0xbf803f80
    v_cndmask_b32 v24, 0, v16, vcc
    v_cndmask_b32 v40, 0, v32, vcc
    v_cndmask_b32 v16, v16, 0, vcc
    v_cndmask_b32 v32, v32, 0, vcc
    v_cndmask_b32 v32, v32, v13, s[46:47]
    v_cndmask_b32 v25, 0, v17, vcc
    v_cndmask_b32 v41, 0, v33, vcc
    v_cndmask_b32 v17, v17, 0, vcc
    v_cndmask_b32 v33, v33, 0, vcc
    v_cndmask_b32 v33, v33, v13, s[46:47]
    v_cndmask_b32 v26, 0, v18, vcc
    v_cndmask_b32 v42, 0, v34, vcc
    v_cndmask_b32 v18, v18, 0, vcc
    v_cndmask_b32 v34, v34, 0, vcc
    v_cndmask_b32 v34, v34, v13, s[46:47]
    v_cndmask_b32 v27, 0, v19, vcc
    v_cndmask_b32 v43, 0, v35, vcc
    v_cndmask_b32 v19, v19, 0, vcc
    v_cndmask_b32 v35, v35, 0, vcc
    v_cndmask_b32 v35, v35, v13, s[46:47]
    v_cndmask_b32 v28, 0, v20, vcc
    v_cndmask_b32 v44, 0, v36, vcc
    v_cndmask_b32 v20, v20, 0, vcc
    v_cndmask_b32 v36, v36, 0, vcc
    v_cndmask_b32 v36, v36, v13, s[46:47]
    v_cndmask_b32 v29, 0, v21, vcc
    v_cndmask_b32 v45, 0, v37, vcc
    v_cndmask_b32 v21, v21, 0, vcc
    v_cndmask_b32 v37, v37, 0, vcc
    v_cndmask_b32 v37, v37, v13, s[46:47]
    v_cndmask_b32 v30, 0, v22, vcc
    v_cndmask_b32 v46, 0, v38, vcc
    v_cndmask_b32 v22, v22, 0, vcc
    v_cndmask_b32 v38, v38, 0, vcc
    v_cndmask_b32 v38, v38, v13, s[46:47]
    v_cndmask_b32 v31, 0, v23, vcc
    v_cndmask_b32 v47, 0, v39, vcc
    v_cndmask_b32 v23, v23, 0, vcc
    v_cndmask_b32 v39, v39, 0, vcc
    v_cndmask_b32 v39, v39, v13, s[46:47]
pb_2:
    v_cvt_f32_u32_e64 v11, v5
    v_mul_f32 v11, 0x3d000000, v11
    v_lshlrev_b32 v12, 2, v4
    v_cvt_f32_u32 v12, v12
    v_mul_f32_e64 v12, v12, v11
    v_fmamk_f32 v120, v11, 0x00000000, v12
    v_fmamk_f32 v121, v11, 0x3f800000, v12
    v_cos_f32 v122, v120
    v_cos_f32 v123, v121
    v_sin_f32 v124, v120
    v_sin_f32 v125, v121
    v_cvt_pk_bf16_f32 v48, v122, v123
    v_cvt_pk_bf16_f32 v56, v124, v125
    v_xor_b32 v64, 0x80008000, v56
    v_fmamk_f32 v120, v11, 0x40000000, v12
    v_fmamk_f32 v121, v11, 0x40400000, v12
    v_cos_f32 v122, v120
    v_cos_f32 v123, v121
    v_sin_f32 v124, v120
    v_sin_f32 v125, v121
    v_cvt_pk_bf16_f32 v49, v122, v123
    v_cvt_pk_bf16_f32 v57, v124, v125
    v_xor_b32 v65, 0x80008000, v57
    v_fmamk_f32 v120, v11, 0x41000000, v12
    v_fmamk_f32 v121, v11, 0x41100000, v12
    v_cos_f32 v122, v120
    v_cos_f32 v123, v121
    v_sin_f32 v124, v120
    v_sin_f32 v125, v121
    v_cvt_pk_bf16_f32 v50, v122, v123
    v_cvt_pk_bf16_f32 v58, v124, v125
    v_xor_b32 v66, 0x80008000, v58
    v_fmamk_f32 v120, v11, 0x41200000, v12
    v_fmamk_f32 v121, v11, 0x41300000, v12
    v_cos_f32 v122, v120
    v_cos_f32 v123, v121
    v_sin_f32 v124, v120
    v_sin_f32 v125, v121
    v_cvt_pk_bf16_f32 v51, v122, v123
    v_cvt_pk_bf16_f32 v59, v124, v125
    v_xor_b32 v67, 0x80008000, v59
    v_fmamk_f32 v120, v11, 0x41800000, v12
    v_fmamk_f32 v121, v11, 0x41880000, v12
    v_cos_f32 v122, v120
    v_cos_f32 v123, v121
    v_sin_f32 v124, v120
    v_sin_f32 v125, v121
    v_cvt_pk_bf16_f32 v52, v122, v123
    v_cvt_pk_bf16_f32 v60, v124, v125
    v_xor_b32 v68, 0x80008000, v60
    v_fmamk_f32 v120, v11, 0x41900000, v12
    v_fmamk_f32 v121, v11, 0x41980000, v12
    v_cos_f32 v122, v120
    v_cos_f32 v123, v121
    v_sin_f32 v124, v120
    v_sin_f32 v125, v121
    v_cvt_pk_bf16_f32 v53, v122, v123
    v_cvt_pk_bf16_f32 v61, v124, v125
    v_xor_b32 v69, 0x80008000, v61
    v_fmamk_f32 v120, v11, 0x41c00000, v12
    v_fmamk_f32 v121, v11, 0x41c80000, v12
    v_cos_f32 v122, v120
    v_cos_f32 v123, v121
    v_sin_f32 v124, v120
    v_sin_f32 v125, v121
    v_cvt_pk_bf16_f32 v54, v122, v123
    v_cvt_pk_bf16_f32 v62, v124, v125
    v_xor_b32 v70, 0x80008000, v62
    v_fmamk_f32 v120, v11, 0x41d00000, v12
    v_fmamk_f32 v121, v11, 0x41d80000, v12
    v_cos_f32 v122, v120
    v_cos_f32 v123, v121
    v_sin_f32 v124, v120
    v_sin_f32 v125, v121
    v_cvt_pk_bf16_f32 v55, v122, v123
    v_cvt_pk_bf16_f32 v63, v124, v125
    v_xor_b32 v71, 0x80008000, v63
    v_mul_f32 v11, 0x3d000000, v11
    v_mul_f32 v12, 0x3d000000, v12
    v_fmamk_f32 v120, v11, 0x00000000, v12
    v_cos_f32 v72, v120
    v_sin_f32 v88, v120
    v_fmamk_f32 v120, v11, 0x3f800000, v12
    v_cos_f32 v73, v120
    v_sin_f32 v89, v120
    v_fmamk_f32 v120, v11, 0x40000000, v12
    v_cos_f32 v74, v120
    v_sin_f32 v90, v120
    v_fmamk_f32 v120, v11, 0x40400000, v12
    v_cos_f32 v75, v120
    v_sin_f32 v91, v120
    v_fmamk_f32 v120, v11, 0x41000000, v12
    v_cos_f32 v76, v120
    v_sin_f32 v92, v120
    v_fmamk_f32 v120, v11, 0x41100000, v12
    v_cos_f32 v77, v120
    v_sin_f32 v93, v120
    v_fmamk_f32 v120, v11, 0x41200000, v12
    v_cos_f32 v78, v120
    v_sin_f32 v94, v120
    v_fmamk_f32 v120, v11, 0x41300000, v12
    v_cos_f32 v79, v120
    v_sin_f32 v95, v120
    v_fmamk_f32 v120, v11, 0x41800000, v12
    v_cos_f32 v80, v120
    v_sin_f32 v96, v120
    v_fmamk_f32 v120, v11, 0x41880000, v12
    v_cos_f32 v81, v120
    v_sin_f32 v97, v120
    v_fmamk_f32 v120, v11, 0x41900000, v12
    v_cos_f32 v82, v120
    v_sin_f32 v98, v120
    v_fmamk_f32 v120, v11, 0x41980000, v12
    v_cos_f32 v83, v120
    v_sin_f32 v99, v120
    v_fmamk_f32 v120, v11, 0x41c00000, v12
    v_cos_f32 v84, v120
    v_sin_f32 v100, v120
    v_fmamk_f32 v120, v11, 0x41c80000, v12
    v_cos_f32 v85, v120
    v_sin_f32 v101, v120
    v_fmamk_f32 v120, v11, 0x41d00000, v12
    v_cos_f32 v86, v120
    v_sin_f32 v102, v120
    v_fmamk_f32 v120, v11, 0x41d80000, v12
    v_cos_f32 v87, v120
    v_sin_f32 v103, v120
    v_lshrrev_b32_e64 v2, 5, v0
    v_mul_u32_u24 v2, 512, v2
    v_bfe_u32 v14, v0, 2, 2
    v_lshl_add_u32 v2, v14, 6, v2
    v_bfe_u32 v14, v0, 4, 1
    v_lshl_add_u32 v2, v14, 5, v2
    v_and_b32_e64 v14, 3, v0
    v_lshl_add_u32 v2, v14, 3, v2
    v_add_u32 v2, s29, v2
    s_lshl_b32 s30, s3, 4
    s_and_b32 s30, s30, 0x30
    s_or_b32 s35, s30, s29
    v_lshlrev_b32_e64 v3, 6, v5
    v_bfe_u32 v14, v5, 1, 3
    v_xor_b32_e64 v14, v14, v4
    v_lshl_add_u32 v3, v14, 3, v3
    v_and_b32 v12, 0xff, v3
    v_xor_b32_e64 v3, s35, v3
    v_lshl_add_u32 v12, v5, 12, v12
    s_lshl_b32 s44, s3, 8
    s_or_b32 s44, s44, s30
    v_xor_b32_e64 v12, s44, v12
    v_bfe_u32 v14, v0, 3, 1
    v_lshl_add_u32 v15, v4, 2, v14
    v_lshlrev_b32 v15, 3, v15
    v_xor_b32 v13, v2, v15
    v_xor_b32_e64 v13, s30, v13
    v_lshl_add_u32 v15, v4, 1, v14
    v_lshlrev_b32_e64 v15, 3, v15
    v_and_b32 v11, 0xff, v2
    v_xor_b32_e64 v11, v11, v15
    v_bfe_u32 v14, v0, 2, 2
    v_lshl_add_u32 v14, v4, 2, v14
    v_lshl_add_u32 v11, v14, 12, v11
    v_xor_b32 v11, s44, v11
    s_waitcnt vmcnt(18)
    ds_read_b64_tr_b16 v[104:105], v2 offset:0
    ds_read_b64_tr_b16 v[106:107], v2 offset:256
    ds_read_b64_tr_b16 v[108:109], v2 offset:1024
    ds_read_b64_tr_b16 v[110:111], v2 offset:1280
    ds_read_b64_tr_b16 v[112:113], v2 offset:2048
    ds_read_b64_tr_b16 v[114:115], v2 offset:2304
    ds_read_b64_tr_b16 v[116:117], v2 offset:3072
    ds_read_b64_tr_b16 v[118:119], v2 offset:3328
    s_waitcnt lgkmcnt(0)
    s_waitcnt vmcnt(14)
    ds_read_b64_tr_b16 v[188:189], v2 offset:4096
    ds_read_b64_tr_b16 v[190:191], v2 offset:4352
    ds_read_b64_tr_b16 v[192:193], v2 offset:5120
    ds_read_b64_tr_b16 v[194:195], v2 offset:5376
    ds_read_b64_tr_b16 v[196:197], v2 offset:6144
    ds_read_b64_tr_b16 v[198:199], v2 offset:6400
    ds_read_b64_tr_b16 v[200:201], v2 offset:7168
    ds_read_b64_tr_b16 v[202:203], v2 offset:7424
    v_mfma_f32_32x32x16_bf16 v[120:135], v[104:107], v[16:19], 0
    v_mfma_f32_32x32x16_bf16 v[120:135], v[108:111], v[20:23], v[120:135]
    v_mfma_f32_32x32x16_bf16 v[120:135], v[112:115], v[24:27], v[120:135]
    v_mfma_f32_32x32x16_bf16 v[120:135], v[116:119], v[28:31], v[120:135]
    v_mfma_f32_32x32x16_bf16 v[136:151], v[104:107], v[32:35], 0
    v_mfma_f32_32x32x16_bf16 v[136:151], v[108:111], v[36:39], v[136:151]
    v_mfma_f32_32x32x16_bf16 v[136:151], v[112:115], v[40:43], v[136:151]
    v_mfma_f32_32x32x16_bf16 v[136:151], v[116:119], v[44:47], v[136:151]
    s_waitcnt lgkmcnt(0)
    s_waitcnt vmcnt(10)
    ds_read_b64_tr_b16 v[104:105], v2 offset:8192
    ds_read_b64_tr_b16 v[106:107], v2 offset:8448
    ds_read_b64_tr_b16 v[108:109], v2 offset:9216
    ds_read_b64_tr_b16 v[110:111], v2 offset:9472
    ds_read_b64_tr_b16 v[112:113], v2 offset:10240
    ds_read_b64_tr_b16 v[114:115], v2 offset:10496
    ds_read_b64_tr_b16 v[116:117], v2 offset:11264
    ds_read_b64_tr_b16 v[118:119], v2 offset:11520
    v_mfma_f32_32x32x16_bf16 v[204:219], v[188:191], v[16:19], 0
    v_mfma_f32_32x32x16_bf16 v[204:219], v[192:195], v[20:23], v[204:219]
    v_mfma_f32_32x32x16_bf16 v[204:219], v[196:199], v[24:27], v[204:219]
    v_mfma_f32_32x32x16_bf16 v[204:219], v[200:203], v[28:31], v[204:219]
    v_mfma_f32_32x32x16_bf16 v[220:235], v[188:191], v[32:35], 0
    v_mfma_f32_32x32x16_bf16 v[220:235], v[192:195], v[36:39], v[220:235]
    v_mfma_f32_32x32x16_bf16 v[220:235], v[196:199], v[40:43], v[220:235]
    v_mfma_f32_32x32x16_bf16 v[220:235], v[200:203], v[44:47], v[220:235]
    v_cvt_pk_bf16_f32 v236, v120, v121
    v_cvt_pk_bf16_f32 v237, v122, v123
    v_cvt_pk_bf16_f32 v238, v124, v125
    v_cvt_pk_bf16_f32 v239, v126, v127
    v_cvt_pk_bf16_f32 v240, v128, v129
    v_cvt_pk_bf16_f32 v241, v130, v131
    v_cvt_pk_bf16_f32 v242, v132, v133
    v_cvt_pk_bf16_f32 v243, v134, v135
    v_cvt_pk_bf16_f32 v244, v136, v137
    v_cvt_pk_bf16_f32 v245, v138, v139
    v_cvt_pk_bf16_f32 v246, v140, v141
    v_cvt_pk_bf16_f32 v247, v142, v143
    v_cvt_pk_bf16_f32 v248, v144, v145
    v_cvt_pk_bf16_f32 v249, v146, v147
    v_cvt_pk_bf16_f32 v250, v148, v149
    v_cvt_pk_bf16_f32 v251, v150, v151
    v_xor_b32_e64 v14, 0, v3
    ds_write_b64 v14, v[236:237] offset:0
    ds_write_b64 v14, v[244:245] offset:2048
    v_xor_b32_e64 v14, 16, v3
    ds_write_b64 v14, v[238:239] offset:0
    ds_write_b64 v14, v[246:247] offset:2048
    v_xor_b32_e64 v14, 32, v3
    ds_write_b64 v14, v[240:241] offset:0
    ds_write_b64 v14, v[248:249] offset:2048
    v_xor_b32_e64 v14, 48, v3
    ds_write_b64 v14, v[242:243] offset:0
    ds_write_b64 v14, v[250:251] offset:2048
    s_waitcnt lgkmcnt(0)
    s_waitcnt vmcnt(6)
    ds_read_b64_tr_b16 v[188:189], v2 offset:12288
    ds_read_b64_tr_b16 v[190:191], v2 offset:12544
    ds_read_b64_tr_b16 v[192:193], v2 offset:13312
    ds_read_b64_tr_b16 v[194:195], v2 offset:13568
    ds_read_b64_tr_b16 v[196:197], v2 offset:14336
    ds_read_b64_tr_b16 v[198:199], v2 offset:14592
    ds_read_b64_tr_b16 v[200:201], v2 offset:15360
    ds_read_b64_tr_b16 v[202:203], v2 offset:15616
    v_mfma_f32_32x32x16_bf16 v[120:135], v[104:107], v[16:19], 0
    v_mfma_f32_32x32x16_bf16 v[120:135], v[108:111], v[20:23], v[120:135]
    v_mfma_f32_32x32x16_bf16 v[120:135], v[112:115], v[24:27], v[120:135]
    v_mfma_f32_32x32x16_bf16 v[120:135], v[116:119], v[28:31], v[120:135]
    v_mfma_f32_32x32x16_bf16 v[136:151], v[104:107], v[32:35], 0
    v_mfma_f32_32x32x16_bf16 v[136:151], v[108:111], v[36:39], v[136:151]
    v_mfma_f32_32x32x16_bf16 v[136:151], v[112:115], v[40:43], v[136:151]
    v_mfma_f32_32x32x16_bf16 v[136:151], v[116:119], v[44:47], v[136:151]
    v_cvt_pk_bf16_f32 v236, v204, v205
    v_cvt_pk_bf16_f32 v237, v206, v207
    v_cvt_pk_bf16_f32 v238, v208, v209
    v_cvt_pk_bf16_f32 v239, v210, v211
    v_cvt_pk_bf16_f32 v240, v212, v213
    v_cvt_pk_bf16_f32 v241, v214, v215
    v_cvt_pk_bf16_f32 v242, v216, v217
    v_cvt_pk_bf16_f32 v243, v218, v219
    v_cvt_pk_bf16_f32 v244, v220, v221
    v_cvt_pk_bf16_f32 v245, v222, v223
    v_cvt_pk_bf16_f32 v246, v224, v225
    v_cvt_pk_bf16_f32 v247, v226, v227
    v_cvt_pk_bf16_f32 v248, v228, v229
    v_cvt_pk_bf16_f32 v249, v230, v231
    v_cvt_pk_bf16_f32 v250, v232, v233
    v_cvt_pk_bf16_f32 v251, v234, v235
    v_xor_b32_e64 v14, 64, v3
    ds_write_b64 v14, v[236:237] offset:4096
    ds_write_b64 v14, v[244:245] offset:6144
    v_xor_b32 v14, 80, v3
    ds_write_b64 v14, v[238:239] offset:4096
    ds_write_b64 v14, v[246:247] offset:6144
    v_xor_b32 v14, 96, v3
    ds_write_b64 v14, v[240:241] offset:4096
    ds_write_b64 v14, v[248:249] offset:6144
    v_xor_b32 v14, 112, v3
    ds_write_b64 v14, v[242:243] offset:4096
    ds_write_b64 v14, v[250:251] offset:6144
    s_nop 0
    s_waitcnt lgkmcnt(0)
    v_mfma_f32_32x32x16_bf16 v[204:219], v[188:191], v[16:19], 0
    v_mfma_f32_32x32x16_bf16 v[204:219], v[192:195], v[20:23], v[204:219]
    v_mfma_f32_32x32x16_bf16 v[204:219], v[196:199], v[24:27], v[204:219]
    v_mfma_f32_32x32x16_bf16 v[204:219], v[200:203], v[28:31], v[204:219]
    v_mfma_f32_32x32x16_bf16 v[220:235], v[188:191], v[32:35], 0
    v_mfma_f32_32x32x16_bf16 v[220:235], v[192:195], v[36:39], v[220:235]
    v_mfma_f32_32x32x16_bf16 v[220:235], v[196:199], v[40:43], v[220:235]
    v_mfma_f32_32x32x16_bf16 v[220:235], v[200:203], v[44:47], v[220:235]
    v_cvt_pk_bf16_f32 v236, v120, v121
    v_cvt_pk_bf16_f32 v237, v122, v123
    v_cvt_pk_bf16_f32 v238, v124, v125
    v_cvt_pk_bf16_f32 v239, v126, v127
    v_cvt_pk_bf16_f32 v240, v128, v129
    v_cvt_pk_bf16_f32 v241, v130, v131
    v_cvt_pk_bf16_f32 v242, v132, v133
    v_cvt_pk_bf16_f32 v243, v134, v135
    v_cvt_pk_bf16_f32 v244, v136, v137
    v_cvt_pk_bf16_f32 v245, v138, v139
    v_cvt_pk_bf16_f32 v246, v140, v141
    v_cvt_pk_bf16_f32 v247, v142, v143
    v_cvt_pk_bf16_f32 v248, v144, v145
    v_cvt_pk_bf16_f32 v249, v146, v147
    v_cvt_pk_bf16_f32 v250, v148, v149
    v_cvt_pk_bf16_f32 v251, v150, v151
    v_xor_b32 v14, 136, v3
    ds_write_b64 v14, v[236:237] offset:8192
    ds_write_b64 v14, v[244:245] offset:10240
    v_xor_b32 v14, 152, v3
    ds_write_b64 v14, v[238:239] offset:8192
    ds_write_b64 v14, v[246:247] offset:10240
    v_xor_b32 v14, 168, v3
    ds_write_b64 v14, v[240:241] offset:8192
    ds_write_b64 v14, v[248:249] offset:10240
    v_xor_b32 v14, 184, v3
    ds_write_b64 v14, v[242:243] offset:8192
    ds_write_b64 v14, v[250:251] offset:10240
    v_cvt_pk_bf16_f32 v236, v204, v205
    v_cvt_pk_bf16_f32 v237, v206, v207
    v_cvt_pk_bf16_f32 v238, v208, v209
    v_cvt_pk_bf16_f32 v239, v210, v211
    v_cvt_pk_bf16_f32 v240, v212, v213
    v_cvt_pk_bf16_f32 v241, v214, v215
    v_cvt_pk_bf16_f32 v242, v216, v217
    v_cvt_pk_bf16_f32 v243, v218, v219
    v_cvt_pk_bf16_f32 v244, v220, v221
    v_cvt_pk_bf16_f32 v245, v222, v223
    v_cvt_pk_bf16_f32 v246, v224, v225
    v_cvt_pk_bf16_f32 v247, v226, v227
    v_cvt_pk_bf16_f32 v248, v228, v229
    v_cvt_pk_bf16_f32 v249, v230, v231
    v_cvt_pk_bf16_f32 v250, v232, v233
    v_cvt_pk_bf16_f32 v251, v234, v235
    v_xor_b32 v14, 200, v3
    ds_write_b64 v14, v[236:237] offset:12288
    ds_write_b64 v14, v[244:245] offset:14336
    v_xor_b32 v14, 216, v3
    ds_write_b64 v14, v[238:239] offset:12288
    ds_write_b64 v14, v[246:247] offset:14336
    v_xor_b32 v14, 232, v3
    ds_write_b64 v14, v[240:241] offset:12288
    ds_write_b64 v14, v[248:249] offset:14336
    v_xor_b32 v14, 248, v3
    ds_write_b64 v14, v[242:243] offset:12288
    ds_write_b64 v14, v[250:251] offset:14336
    s_mov_b32 s45, 0
    s_nop 0
    s_waitcnt lgkmcnt(0)
    s_barrier
pb_row:
    s_and_b32 s46, s45, 3
    s_lshr_b32 s47, s46, 1
    s_lshl_b32 s47, s47, 3
    s_lshl_b32 s46, s46, 6
    s_or_b32 s46, s46, s47
    v_xor_b32 v15, s46, v11
    v_xor_b32_e64 v14, 0, v15
    ds_read_b64_tr_b16 v[104:105], v14 offset:0
    ds_read_b64_tr_b16 v[112:113], v14 offset:2048
    v_xor_b32 v14, 32800, v15
    ds_read_b64_tr_b16 v[106:107], v14 offset:0
    ds_read_b64_tr_b16 v[114:115], v14 offset:2048
    v_xor_b32 v14, 65536, v15
    ds_read_b64_tr_b16 v[108:109], v14 offset:0
    ds_read_b64_tr_b16 v[116:117], v14 offset:2048
    v_xor_b32 v14, 98336, v15
    ds_read_b64_tr_b16 v[110:111], v14 offset:0
    ds_read_b64_tr_b16 v[118:119], v14 offset:2048
    s_waitcnt lgkmcnt(0)
    s_cmp_lg_u32 s45, 4
    s_cbranch_scc1 pb_6
    v_mov_b32 v104, 0
    v_mov_b32 v105, 0
    v_mov_b32 v106, 0
    v_mov_b32 v107, 0
    v_mov_b32 v108, 0
    v_mov_b32 v109, 0
    v_mov_b32 v110, 0
    v_mov_b32_e64 v111, 0
pb_6:
    v_mfma_f32_32x32x16_bf16 v[120:135], v[104:107], v[48:51], 0
    s_nop 0
    s_nop 0
    v_mfma_f32_32x32x16_bf16 v[120:135], v[108:111], v[52:55], v[120:135]
    v_mfma_f32_32x32x16_bf16 v[120:135], v[112:115], v[56:59], v[120:135]
    v_mfma_f32_32x32x16_bf16 v[120:135], v[116:119], v[60:63], v[120:135]
    v_mfma_f32_32x32x16_bf16 v[136:151], v[104:107], v[64:67], 0
    v_mfma_f32_32x32x16_bf16 v[136:151], v[108:111], v[68:71], v[136:151]
    v_mfma_f32_32x32x16_bf16 v[136:151], v[112:115], v[48:51], v[136:151]
    v_mfma_f32_32x32x16_bf16 v[136:151], v[116:119], v[52:55], v[136:151]
    s_nop 0
    s_waitcnt vmcnt(0)
    ds_read_u16_d16_hi v152, v6 offset:0
    ds_read_u16_d16_hi v168, v6 offset:1024
    ds_read_u16_d16_hi v153, v6 offset:64
    ds_read_u16_d16_hi v169, v6 offset:1088
    ds_read_u16_d16_hi v154, v6 offset:128
    ds_read_u16_d16_hi v170, v6 offset:1152
    ds_read_u16_d16_hi v155, v6 offset:192
    ds_read_u16_d16_hi v171, v6 offset:1216
    ds_read_u16_d16_hi v156, v6 offset:512
    ds_read_u16_d16_hi v172, v6 offset:1536
    ds_read_u16_d16_hi v157, v6 offset:576
    ds_read_u16_d16_hi v173, v6 offset:1600
    ds_read_u16_d16_hi v158, v6 offset:640
    ds_read_u16_d16_hi v174, v6 offset:1664
    ds_read_u16_d16_hi v159, v6 offset:704
    ds_read_u16_d16_hi v175, v6 offset:1728
    ds_read_u16_d16_hi v160, v7 offset:704
    ds_read_u16_d16_hi v176, v7 offset:1728
    ds_read_u16_d16_hi v161, v7 offset:640
    ds_read_u16_d16_hi v177, v7 offset:1664
    ds_read_u16_d16_hi v162, v7 offset:576
    ds_read_u16_d16_hi v178, v7 offset:1600
    ds_read_u16_d16_hi v163, v7 offset:512
    ds_read_u16_d16_hi v179, v7 offset:1536
    ds_read_u16_d16_hi v164, v7 offset:192
    ds_read_u16_d16_hi v180, v7 offset:1216
    ds_read_u16_d16_hi v165, v7 offset:128
    ds_read_u16_d16_hi v181, v7 offset:1152
    ds_read_u16_d16_hi v166, v7 offset:64
    ds_read_u16_d16_hi v182, v7 offset:1088
    ds_read_u16_d16_hi v167, v7 offset:0
    ds_read_u16_d16_hi v183, v7 offset:1024
    v_mul_f32 v236, v120, v72
    v_mul_f32 v238, v136, v72
    v_fma_f32 v236, v136, v88, v236
    v_fma_f32 v238, -v120, v88, v238
    v_mul_f32 v237, v121, v73
    v_mul_f32 v239, v137, v73
    v_fma_f32 v237, v137, v89, v237
    v_fma_f32 v239, -v121, v89, v239
    v_cvt_pk_bf16_f32 v104, v236, v237
    v_cvt_pk_bf16_f32 v112, v238, v239
    v_mul_f32 v236, v122, v74
    v_mul_f32 v238, v138, v74
    v_fma_f32 v236, v138, v90, v236
    v_fma_f32 v238, -v122, v90, v238
    v_mul_f32 v237, v123, v75
    v_mul_f32 v239, v139, v75
    v_fma_f32 v237, v139, v91, v237
    v_fma_f32 v239, -v123, v91, v239
    v_cvt_pk_bf16_f32 v105, v236, v237
    v_cvt_pk_bf16_f32 v113, v238, v239
    v_mul_f32 v236, v124, v76
    v_mul_f32 v238, v140, v76
    v_fma_f32 v236, v140, v92, v236
    v_fma_f32 v238, -v124, v92, v238
    v_mul_f32 v237, v125, v77
    v_mul_f32 v239, v141, v77
    v_fma_f32 v237, v141, v93, v237
    v_fma_f32 v239, -v125, v93, v239
    v_cvt_pk_bf16_f32 v106, v236, v237
    v_cvt_pk_bf16_f32 v114, v238, v239
    v_mul_f32 v236, v126, v78
    v_mul_f32 v238, v142, v78
    v_fma_f32 v236, v142, v94, v236
    v_fma_f32 v238, -v126, v94, v238
    v_mul_f32 v237, v127, v79
    v_mul_f32 v239, v143, v79
    v_fma_f32 v237, v143, v95, v237
    v_fma_f32 v239, -v127, v95, v239
    v_cvt_pk_bf16_f32 v107, v236, v237
    v_cvt_pk_bf16_f32 v115, v238, v239
    v_mul_f32 v236, v128, v80
    v_mul_f32 v238, v144, v80
    v_fma_f32 v236, v144, v96, v236
    v_fma_f32 v238, -v128, v96, v238
    v_mul_f32 v237, v129, v81
    v_mul_f32 v239, v145, v81
    v_fma_f32 v237, v145, v97, v237
    v_fma_f32 v239, -v129, v97, v239
    v_cvt_pk_bf16_f32 v108, v236, v237
    v_cvt_pk_bf16_f32 v116, v238, v239
    v_mul_f32 v236, v130, v82
    v_mul_f32 v238, v146, v82
    v_fma_f32 v236, v146, v98, v236
    v_fma_f32 v238, -v130, v98, v238
    v_mul_f32 v237, v131, v83
    v_mul_f32 v239, v147, v83
    v_fma_f32 v237, v147, v99, v237
    v_fma_f32 v239, -v131, v99, v239
    v_cvt_pk_bf16_f32 v109, v236, v237
    v_cvt_pk_bf16_f32 v117, v238, v239
    v_mul_f32 v236, v132, v84
    v_mul_f32 v238, v148, v84
    v_fma_f32 v236, v148, v100, v236
    v_fma_f32 v238, -v132, v100, v238
    v_mul_f32 v237, v133, v85
    v_mul_f32 v239, v149, v85
    v_fma_f32 v237, v149, v101, v237
    v_fma_f32 v239, -v133, v101, v239
    v_cvt_pk_bf16_f32 v110, v236, v237
    v_cvt_pk_bf16_f32 v118, v238, v239
    v_mul_f32 v236, v134, v86
    v_mul_f32 v238, v150, v86
    v_fma_f32 v236, v150, v102, v236
    v_fma_f32 v238, -v134, v102, v238
    v_mul_f32 v237, v135, v87
    v_mul_f32 v239, v151, v87
    v_fma_f32 v237, v151, v103, v237
    v_fma_f32 v239, -v135, v103, v239
    v_cvt_pk_bf16_f32 v111, v236, v237
    v_cvt_pk_bf16_f32 v119, v238, v239
    v_mfma_f32_32x32x16_bf16 v[120:135], v[48:51], v[104:107], 0
    v_mfma_f32_32x32x16_bf16 v[120:135], v[52:55], v[108:111], v[120:135]
    v_mfma_f32_32x32x16_bf16 v[120:135], v[56:59], v[112:115], v[120:135]
    v_mfma_f32_32x32x16_bf16 v[120:135], v[60:63], v[116:119], v[120:135]
    v_mfma_f32_32x32x16_bf16 v[136:151], v[64:67], v[104:107], 0
    v_mfma_f32_32x32x16_bf16 v[136:151], v[68:71], v[108:111], v[136:151]
    v_mfma_f32_32x32x16_bf16 v[136:151], v[48:51], v[112:115], v[136:151]
    v_mfma_f32_32x32x16_bf16 v[136:151], v[52:55], v[116:119], v[136:151]
    v_add_f32_dpp v236, v184, v184 quad_perm:[1,0,3,2] row_mask:0xf bank_mask:0xf
    v_subrev_f32_dpp v237, v185, v185 quad_perm:[1,0,3,2] row_mask:0xf bank_mask:0xf
    s_add_u32 s31, s31, 64
    s_cmp_eq_u32 s45, 3
    s_cselect_b32 s31, 1024, s31
    v_mul_f32 v236, 0.5, v236
    v_mul_f32_e64 v237, 0.5, v237
    s_waitcnt lgkmcnt(0)
    s_sub_u32 s34, 2048, s31
    s_and_b32 s34, s34, 2047
    s_mul_i32 s33, s31, 1026
    s_mul_i32 s34, s34, 1026
    s_add_u32 m0, s50, 0
    s_nop 0
    buffer_load_dwordx4 v8, s[12:15], s34 offen lds
    s_add_u32 m0, s50, 1024
    s_nop 0
    s_nop 0
    buffer_load_dwordx4 v8, s[16:19], s34 offen lds
    s_add_u32 m0, s50, 2048
    s_nop 0
    s_nop 0
    buffer_load_dwordx4 v8, s[12:15], s33 offen lds
    s_add_u32 m0, s50, 3072
    s_nop 0
    s_nop 0
    buffer_load_dwordx4 v8, s[16:19], s33 offen lds
    v_add_u32 v10, s33, v9
    v_add_u32 v186, s34, v9
    v_cndmask_b32 v10, v10, v186, s[54:55]
    buffer_load_short_d16_hi v184, v10, s[12:15], 0 offen
    buffer_load_short_d16_hi v185, v10, s[16:19], 0 offen
    v_mov_b32_dpp v238, v236 quad_perm:[3,3,3,3] row_mask:0xf bank_mask:0xf
    v_mov_b32_dpp v239, v237 quad_perm:[3,3,3,3] row_mask:0xf bank_mask:0xf
    v_cndmask_b32 v152, v152, v236, s[56:57]
    v_cndmask_b32 v168, v168, v237, s[56:57]
    v_cndmask_b32 v160, v160, v238, s[56:57]
    v_cndmask_b32 v176, v176, v239, s[56:57]
    v_mul_f32 v236, v120, v152
    v_mul_f32 v238, v136, v152
    v_fma_f32 v236, -v136, v168, v236
    v_fma_f32 v238, v120, v168, v238
    v_mul_f32 v237, v121, v153
    v_mul_f32 v239, v137, v153
    v_fma_f32 v237, -v137, v169, v237
    v_fma_f32 v239, v121, v169, v239
    v_cvt_pk_bf16_f32 v104, v236, v237
    v_cvt_pk_bf16_f32 v112, v238, v239
    v_mul_f32 v236, v122, v154
    v_mul_f32 v238, v138, v154
    v_fma_f32 v236, -v138, v170, v236
    v_fma_f32 v238, v122, v170, v238
    v_mul_f32 v237, v123, v155
    v_mul_f32 v239, v139, v155
    v_fma_f32 v237, -v139, v171, v237
    v_fma_f32 v239, v123, v171, v239
    v_cvt_pk_bf16_f32 v105, v236, v237
    v_cvt_pk_bf16_f32 v113, v238, v239
    v_mul_f32 v236, v124, v156
    v_mul_f32 v238, v140, v156
    v_fma_f32 v236, -v140, v172, v236
    v_fma_f32 v238, v124, v172, v238
    v_mul_f32 v237, v125, v157
    v_mul_f32 v239, v141, v157
    v_fma_f32 v237, -v141, v173, v237
    v_fma_f32 v239, v125, v173, v239
    v_cvt_pk_bf16_f32 v106, v236, v237
    v_cvt_pk_bf16_f32 v114, v238, v239
    v_mul_f32 v236, v126, v158
    v_mul_f32 v238, v142, v158
    v_fma_f32 v236, -v142, v174, v236
    v_fma_f32 v238, v126, v174, v238
    v_mul_f32 v237, v127, v159
    v_mul_f32 v239, v143, v159
    v_fma_f32 v237, -v143, v175, v237
    v_fma_f32 v239, v127, v175, v239
    v_cvt_pk_bf16_f32 v107, v236, v237
    v_cvt_pk_bf16_f32 v115, v238, v239
    v_mul_f32 v236, v128, v160
    v_mul_f32 v238, v144, v160
    v_fma_f32 v236, v144, v176, v236
    v_fma_f32 v238, -v128, v176, v238
    v_mul_f32 v237, v129, v161
    v_mul_f32 v239, v145, v161
    v_fma_f32 v237, v145, v177, v237
    v_fma_f32 v239, -v129, v177, v239
    v_cvt_pk_bf16_f32 v108, v236, v237
    v_cvt_pk_bf16_f32 v116, v238, v239
    v_mul_f32 v236, v130, v162
    v_mul_f32 v238, v146, v162
    v_fma_f32 v236, v146, v178, v236
    v_fma_f32 v238, -v130, v178, v238
    v_mul_f32 v237, v131, v163
    v_mul_f32 v239, v147, v163
    v_fma_f32 v237, v147, v179, v237
    v_fma_f32 v239, -v131, v179, v239
    v_cvt_pk_bf16_f32 v109, v236, v237
    v_cvt_pk_bf16_f32 v117, v238, v239
    v_mul_f32 v236, v132, v164
    v_mul_f32 v238, v148, v164
    v_fma_f32 v236, v148, v180, v236
    v_fma_f32 v238, -v132, v180, v238
    v_mul_f32 v237, v133, v165
    v_mul_f32 v239, v149, v165
    v_fma_f32 v237, v149, v181, v237
    v_fma_f32 v239, -v133, v181, v239
    v_cvt_pk_bf16_f32 v110, v236, v237
    v_cvt_pk_bf16_f32 v118, v238, v239
    v_mul_f32 v236, v134, v166
    v_mul_f32 v238, v150, v166
    v_fma_f32 v236, v150, v182, v236
    v_fma_f32 v238, -v134, v182, v238
    v_mul_f32 v237, v135, v167
    v_mul_f32 v239, v151, v167
    v_fma_f32 v237, v151, v183, v237
    v_fma_f32 v239, -v135, v183, v239
    v_cvt_pk_bf16_f32 v111, v236, v237
    v_cvt_pk_bf16_f32 v119, v238, v239
    v_mfma_f32_32x32x16_bf16 v[120:135], v[104:107], v[48:51], 0
    v_mfma_f32_32x32x16_bf16 v[120:135], v[108:111], v[52:55], v[120:135]
    v_mfma_f32_32x32x16_bf16 v[120:135], v[112:115], v[64:67], v[120:135]
    v_mfma_f32_32x32x16_bf16 v[120:135], v[116:119], v[68:71], v[120:135]
    v_mfma_f32_32x32x16_bf16 v[136:151], v[104:107], v[56:59], 0
    v_mfma_f32_32x32x16_bf16 v[136:151], v[108:111], v[60:63], v[136:151]
    v_mfma_f32_32x32x16_bf16 v[136:151], v[112:115], v[48:51], v[136:151]
    v_mfma_f32_32x32x16_bf16 v[136:151], v[116:119], v[52:55], v[136:151]
    s_nop 7
    v_mul_f32 v236, v120, v72
    s_nop 2
    v_mul_f32 v238, v136, v72
    v_fma_f32 v236, -v136, v88, v236
    v_fma_f32 v238, v120, v88, v238
    v_mul_f32 v237, v121, v73
    v_mul_f32 v239, v137, v73
    v_fma_f32 v237, -v137, v89, v237
    v_fma_f32 v239, v121, v89, v239
    v_cvt_pk_bf16_f32 v104, v236, v237
    v_cvt_pk_bf16_f32 v112, v238, v239
    v_mul_f32 v236, v122, v74
    v_mul_f32 v238, v138, v74
    v_fma_f32 v236, -v138, v90, v236
    v_fma_f32 v238, v122, v90, v238
    v_mul_f32 v237, v123, v75
    v_mul_f32 v239, v139, v75
    v_fma_f32 v237, -v139, v91, v237
    v_fma_f32 v239, v123, v91, v239
    v_cvt_pk_bf16_f32 v105, v236, v237
    v_cvt_pk_bf16_f32 v113, v238, v239
    v_mul_f32 v236, v124, v76
    v_mul_f32 v238, v140, v76
    v_fma_f32 v236, -v140, v92, v236
    v_fma_f32 v238, v124, v92, v238
    v_mul_f32 v237, v125, v77
    v_mul_f32 v239, v141, v77
    v_fma_f32 v237, -v141, v93, v237
    v_fma_f32 v239, v125, v93, v239
    v_cvt_pk_bf16_f32 v106, v236, v237
    v_cvt_pk_bf16_f32 v114, v238, v239
    v_mul_f32 v236, v126, v78
    v_mul_f32 v238, v142, v78
    v_fma_f32 v236, -v142, v94, v236
    v_fma_f32 v238, v126, v94, v238
    v_mul_f32 v237, v127, v79
    v_mul_f32 v239, v143, v79
    v_fma_f32 v237, -v143, v95, v237
    v_fma_f32 v239, v127, v95, v239
    v_cvt_pk_bf16_f32 v107, v236, v237
    v_cvt_pk_bf16_f32 v115, v238, v239
    v_mul_f32 v236, v128, v80
    v_mul_f32 v238, v144, v80
    v_fma_f32 v236, -v144, v96, v236
    v_fma_f32 v238, v128, v96, v238
    v_mul_f32 v237, v129, v81
    v_mul_f32 v239, v145, v81
    v_fma_f32 v237, -v145, v97, v237
    v_fma_f32 v239, v129, v97, v239
    v_cvt_pk_bf16_f32 v108, v236, v237
    v_cvt_pk_bf16_f32 v116, v238, v239
    v_mul_f32 v236, v130, v82
    v_mul_f32 v238, v146, v82
    v_fma_f32 v236, -v146, v98, v236
    v_fma_f32 v238, v130, v98, v238
    v_mul_f32 v237, v131, v83
    v_mul_f32 v239, v147, v83
    v_fma_f32 v237, -v147, v99, v237
    v_fma_f32 v239, v131, v99, v239
    v_cvt_pk_bf16_f32 v109, v236, v237
    v_cvt_pk_bf16_f32 v117, v238, v239
    v_mul_f32 v236, v132, v84
    v_mul_f32 v238, v148, v84
    v_fma_f32 v236, -v148, v100, v236
    v_fma_f32 v238, v132, v100, v238
    v_mul_f32 v237, v133, v85
    v_mul_f32 v239, v149, v85
    v_fma_f32 v237, -v149, v101, v237
    v_fma_f32 v239, v133, v101, v239
    v_cvt_pk_bf16_f32 v110, v236, v237
    v_cvt_pk_bf16_f32 v118, v238, v239
    v_mul_f32 v236, v134, v86
    v_mul_f32 v238, v150, v86
    v_fma_f32 v236, -v150, v102, v236
    v_fma_f32 v238, v134, v102, v238
    v_mul_f32 v237, v135, v87
    v_mul_f32 v239, v151, v87
    v_fma_f32 v237, -v151, v103, v237
    v_fma_f32 v239, v135, v103, v239
    v_cvt_pk_bf16_f32 v111, v236, v237
    v_cvt_pk_bf16_f32 v119, v238, v239
    v_mfma_f32_32x32x16_bf16 v[120:135], v[104:107], v[48:51], 0
    v_mfma_f32_32x32x16_bf16 v[120:135], v[108:111], v[52:55], v[120:135]
    v_mfma_f32_32x32x16_bf16 v[120:135], v[112:115], v[64:67], v[120:135]
    v_mfma_f32_32x32x16_bf16 v[120:135], v[116:119], v[68:71], v[120:135]
    v_mfma_f32_32x32x16_bf16 v[136:151], v[104:107], v[56:59], 0
    v_mfma_f32_32x32x16_bf16 v[136:151], v[108:111], v[60:63], v[136:151]
    v_mfma_f32_32x32x16_bf16 v[136:151], v[112:115], v[48:51], v[136:151]
    v_mfma_f32_32x32x16_bf16 v[136:151], v[116:119], v[52:55], v[136:151]
    v_xor_b32 v15, s46, v12
    s_nop 6
    v_cvt_pk_bf16_f32 v104, v120, v121
    v_cvt_pk_bf16_f32 v105, v122, v123
    v_cvt_pk_bf16_f32 v106, v124, v125
    v_cvt_pk_bf16_f32 v107, v126, v127
    v_cvt_pk_bf16_f32 v108, v128, v129
    v_cvt_pk_bf16_f32 v109, v130, v131
    v_cvt_pk_bf16_f32 v110, v132, v133
    v_cvt_pk_bf16_f32 v111, v134, v135
    v_cvt_pk_bf16_f32 v112, v136, v137
    v_cvt_pk_bf16_f32 v113, v138, v139
    v_cvt_pk_bf16_f32 v114, v140, v141
    v_cvt_pk_bf16_f32 v115, v142, v143
    v_cvt_pk_bf16_f32 v116, v144, v145
    v_cvt_pk_bf16_f32 v117, v146, v147
    v_cvt_pk_bf16_f32 v118, v148, v149
    v_cvt_pk_bf16_f32 v119, v150, v151
    s_cmp_eq_u32 s45, 4
    s_cbranch_scc1 pb_3
    v_xor_b32_e64 v14, 0, v15
    ds_write_b64 v14, v[104:105]
    v_xor_b32_e64 v14, 16, v15
    ds_write_b64 v14, v[106:107]
    v_xor_b32_e64 v14, 32, v15
    ds_write_b64 v14, v[108:109]
    v_xor_b32_e64 v14, 48, v15
    ds_write_b64 v14, v[110:111]
pb_3:
    s_sub_u32 s47, s32, s45
    s_cmp_eq_u32 s47, 5
    s_cbranch_scc1 pb_4
    v_xor_b32 v14, 0, v15
    ds_write_b64 v14, v[112:113] offset:2048
    v_xor_b32_e64 v14, 16, v15
    ds_write_b64 v14, v[114:115] offset:2048
    v_xor_b32_e64 v14, 32, v15
    ds_write_b64 v14, v[116:117] offset:2048
    v_xor_b32_e64 v14, 48, v15
    ds_write_b64 v14, v[118:119] offset:2048
pb_4:
    s_add_u32 s45, s45, 1
    s_cmp_lt_u32 s45, s32
    s_cbranch_scc1 pb_row
    s_nop 0
    s_add_u32 s47, s2, 1024
    s_cmp_eq_u32 s2, 0
    s_cselect_b32 s46, 32, s2
    s_cselect_b32 s47, 0, s47
    s_cselect_b32 s48, -1, 0
    s_mov_b32 s49, 0
    v_cvt_f32_u32 v11, v5
    v_mul_f32 v11, 0x3a000000, v11
    v_lshl_add_u32 v12, v4, 9, s46
    v_lshl_add_u32 v14, v4, 9, s47
    v_cvt_f32_u32 v12, v12
    v_cvt_f32_u32 v14, v14
    v_mul_f32 v12, v12, v11
    v_mul_f32 v14, v14, v11
    v_fmamk_f32 v120, v11, 0x00000000, v12
    v_fmamk_f32 v121, v11, 0x42800000, v12
    v_cos_f32 v122, v120
    v_cos_f32 v123, v121
    v_sin_f32 v124, v120
    v_sin_f32 v125, v121
    v_mul_f32 v122, 0x35800000, v122
    v_mul_f32 v123, 0x35800000, v123
    v_mul_f32 v124, 0x35800000, v124
    v_mul_f32 v125, 0x35800000, v125
    v_cvt_pk_bf16_f32 v16, v122, v123
    v_cvt_pk_bf16_f32 v32, v124, v125
    v_xor_b32 v24, 0x80008000, v32
    v_fmamk_f32 v120, v11, 0x43000000, v12
    v_fmamk_f32 v121, v11, 0x43400000, v12
    v_cos_f32 v122, v120
    v_cos_f32 v123, v121
    v_sin_f32 v124, v120
    v_sin_f32 v125, v121
    v_mul_f32 v122, 0x35800000, v122
    v_mul_f32 v123, 0x35800000, v123
    v_mul_f32 v124, 0x35800000, v124
    v_mul_f32 v125, 0x35800000, v125
    v_cvt_pk_bf16_f32 v17, v122, v123
    v_cvt_pk_bf16_f32 v33, v124, v125
    v_xor_b32 v25, 0x80008000, v33
    v_fmamk_f32 v120, v11, 0x43800000, v12
    v_fmamk_f32 v121, v11, 0x43a00000, v12
    v_cos_f32 v122, v120
    v_cos_f32 v123, v121
    v_sin_f32 v124, v120
    v_sin_f32 v125, v121
    v_mul_f32 v122, 0x35800000, v122
    v_mul_f32 v123, 0x35800000, v123
    v_mul_f32 v124, 0x35800000, v124
    v_mul_f32 v125, 0x35800000, v125
    v_cvt_pk_bf16_f32 v18, v122, v123
    v_cvt_pk_bf16_f32 v34, v124, v125
    v_xor_b32 v26, 0x80008000, v34
    v_fmamk_f32 v120, v11, 0x43c00000, v12
    v_fmamk_f32 v121, v11, 0x43e00000, v12
    v_cos_f32 v122, v120
    v_cos_f32 v123, v121
    v_sin_f32 v124, v120
    v_sin_f32 v125, v121
    v_mul_f32 v122, 0x35800000, v122
    v_mul_f32 v123, 0x35800000, v123
    v_mul_f32 v124, 0x35800000, v124
    v_mul_f32 v125, 0x35800000, v125
    v_cvt_pk_bf16_f32 v19, v122, v123
    v_cvt_pk_bf16_f32 v35, v124, v125
    v_xor_b32 v27, 0x80008000, v35
    v_fmamk_f32 v120, v11, 0x00000000, v14
    v_fmamk_f32 v121, v11, 0x42800000, v14
    v_cos_f32 v122, v120
    v_cos_f32 v123, v121
    v_sin_f32 v124, v120
    v_sin_f32 v125, v121
    v_mul_f32 v122, 0x35800000, v122
    v_mul_f32 v123, 0x35800000, v123
    v_mul_f32 v124, 0x35800000, v124
    v_mul_f32 v125, 0x35800000, v125
    v_lshlrev_b32_e64 v15, 31, v5
    v_xor_b32 v15, 0xb5000000, v15
    v_mov_b32 v2, 0x35000000
    v_cndmask_b32 v122, v122, v2, s[48:49]
    v_cndmask_b32 v124, v124, v15, s[48:49]
    v_cvt_pk_bf16_f32 v20, v122, v123
    v_cvt_pk_bf16_f32 v36, v124, v125
    v_xor_b32 v28, 0x80008000, v36
    v_fmamk_f32 v120, v11, 0x43000000, v14
    v_fmamk_f32 v121, v11, 0x43400000, v14
    v_cos_f32 v122, v120
    v_cos_f32 v123, v121
    v_sin_f32 v124, v120
    v_sin_f32 v125, v121
    v_mul_f32 v122, 0x35800000, v122
    v_mul_f32 v123, 0x35800000, v123
    v_mul_f32 v124, 0x35800000, v124
    v_mul_f32 v125, 0x35800000, v125
    v_cvt_pk_bf16_f32 v21, v122, v123
    v_cvt_pk_bf16_f32 v37, v124, v125
    v_xor_b32 v29, 0x80008000, v37
    v_fmamk_f32 v120, v11, 0x43800000, v14
    v_fmamk_f32 v121, v11, 0x43a00000, v14
    v_cos_f32 v122, v120
    v_cos_f32 v123, v121
    v_sin_f32 v124, v120
    v_sin_f32 v125, v121
    v_mul_f32 v122, 0x35800000, v122
    v_mul_f32 v123, 0x35800000, v123
    v_mul_f32 v124, 0x35800000, v124
    v_mul_f32 v125, 0x35800000, v125
    v_cvt_pk_bf16_f32 v22, v122, v123
    v_cvt_pk_bf16_f32 v38, v124, v125
    v_xor_b32 v30, 0x80008000, v38
    v_fmamk_f32 v120, v11, 0x43c00000, v14
    v_fmamk_f32 v121, v11, 0x43e00000, v14
    v_cos_f32 v122, v120
    v_cos_f32 v123, v121
    v_sin_f32 v124, v120
    v_sin_f32 v125, v121
    v_mul_f32 v122, 0x35800000, v122
    v_mul_f32 v123, 0x35800000, v123
    v_mul_f32 v124, 0x35800000, v124
    v_mul_f32 v125, 0x35800000, v125
    v_cvt_pk_bf16_f32 v23, v122, v123
    v_cvt_pk_bf16_f32 v39, v124, v125
    v_xor_b32 v31, 0x80008000, v39
    v_mov_b32 v40, v16
    v_mov_b32 v41, v17
    v_mov_b32 v42, v18
    v_mov_b32 v43, v19
    v_mov_b32 v44, v20
    v_mov_b32 v45, v21
    v_mov_b32 v46, v22
    v_mov_b32 v47, v23
    s_cmp_lg_u32 s2, 0
    s_cbranch_scc1 pb_5
    v_mov_b32 v32, v16
    v_mov_b32 v40, v24
    v_mov_b32 v16, 0
    v_mov_b32 v24, 0
    v_mov_b32 v36, 0
    v_mov_b32 v44, 0
    v_mov_b32 v33, v17
    v_mov_b32 v41, v25
    v_mov_b32 v17, 0
    v_mov_b32 v25, 0
    v_mov_b32 v37, 0
    v_mov_b32 v45, 0
    v_mov_b32 v34, v18
    v_mov_b32 v42, v26
    v_mov_b32 v18, 0
    v_mov_b32 v26, 0
    v_mov_b32 v38, 0
    v_mov_b32 v46, 0
    v_mov_b32 v35, v19
    v_mov_b32 v43, v27
    v_mov_b32 v19, 0
    v_mov_b32 v27, 0
    v_mov_b32 v39, 0
    v_mov_b32 v47, 0
pb_5:
    v_lshlrev_b32_e64 v3, 6, v5
    v_bfe_u32 v14, v5, 1, 2
    v_lshl_add_u32 v3, v14, 4, v3
    v_lshl_add_u32 v3, v4, 3, v3
    v_add_u32 v3, s29, v3
    v_lshrrev_b32 v14, 4, v0
    v_bfe_u32 v15, v0, 2, 2
    v_lshlrev_b32 v11, 17, v14
    v_xor_b32 v14, v14, v15
    v_lshlrev_b32_e64 v6, 12, v15
    v_lshl_add_u32 v6, v14, 6, v6
    v_and_b32 v14, 3, v0
    v_xor_b32 v14, v14, v4
    v_lshl_add_u32 v6, v14, 4, v6
    v_add_u32 v6, s29, v6
    v_xor_b32 v7, 32, v6
    v_and_b32_e64 v14, 15, v0
    v_lshl_add_u32 v11, v14, 4, v11
    s_lshl_b32 s28, s2, 12
    s_lshl_b32 s30, s3, 8
    s_add_u32 s28, s28, s30
    s_waitcnt lgkmcnt(0)
    s_barrier
    v_xor_b32 v14, 0, v13
    ds_read_b64_tr_b16 v[104:105], v14 offset:0
    ds_read_b64_tr_b16 v[108:109], v14 offset:1024
    ds_read_b64_tr_b16 v[112:113], v14 offset:2048
    ds_read_b64_tr_b16 v[116:117], v14 offset:3072
    v_xor_b32_e64 v14, 16, v13
    ds_read_b64_tr_b16 v[106:107], v14 offset:256
    ds_read_b64_tr_b16 v[110:111], v14 offset:1280
    ds_read_b64_tr_b16 v[114:115], v14 offset:2304
    ds_read_b64_tr_b16 v[118:119], v14 offset:3328
    s_waitcnt lgkmcnt(0)
    v_xor_b32 v14, 64, v13
    ds_read_b64_tr_b16 v[188:189], v14 offset:4096
    ds_read_b64_tr_b16 v[192:193], v14 offset:5120
    ds_read_b64_tr_b16 v[196:197], v14 offset:6144
    ds_read_b64_tr_b16 v[200:201], v14 offset:7168
    v_xor_b32 v14, 80, v13
    ds_read_b64_tr_b16 v[190:191], v14 offset:4352
    ds_read_b64_tr_b16 v[194:195], v14 offset:5376
    ds_read_b64_tr_b16 v[198:199], v14 offset:6400
    ds_read_b64_tr_b16 v[202:203], v14 offset:7424
    v_mfma_f32_32x32x16_bf16 v[120:135], v[104:107], v[16:19], 0
    v_mfma_f32_32x32x16_bf16 v[120:135], v[108:111], v[20:23], v[120:135]
    v_mfma_f32_32x32x16_bf16 v[120:135], v[112:115], v[24:27], v[120:135]
    v_mfma_f32_32x32x16_bf16 v[120:135], v[116:119], v[28:31], v[120:135]
    v_mfma_f32_32x32x16_bf16 v[136:151], v[104:107], v[32:35], 0
    v_mfma_f32_32x32x16_bf16 v[136:151], v[108:111], v[36:39], v[136:151]
    v_mfma_f32_32x32x16_bf16 v[136:151], v[112:115], v[40:43], v[136:151]
    v_mfma_f32_32x32x16_bf16 v[136:151], v[116:119], v[44:47], v[136:151]
    s_nop 0
    s_waitcnt lgkmcnt(0)
    v_xor_b32 v14, 136, v13
    ds_read_b64_tr_b16 v[104:105], v14 offset:8192
    ds_read_b64_tr_b16 v[108:109], v14 offset:9216
    ds_read_b64_tr_b16 v[112:113], v14 offset:10240
    ds_read_b64_tr_b16 v[116:117], v14 offset:11264
    v_xor_b32 v14, 152, v13
    ds_read_b64_tr_b16 v[106:107], v14 offset:8448
    ds_read_b64_tr_b16 v[110:111], v14 offset:9472
    ds_read_b64_tr_b16 v[114:115], v14 offset:10496
    ds_read_b64_tr_b16 v[118:119], v14 offset:11520
    v_mfma_f32_32x32x16_bf16 v[204:219], v[188:191], v[16:19], 0
    v_mfma_f32_32x32x16_bf16 v[204:219], v[192:195], v[20:23], v[204:219]
    v_mfma_f32_32x32x16_bf16 v[204:219], v[196:199], v[24:27], v[204:219]
    v_mfma_f32_32x32x16_bf16 v[204:219], v[200:203], v[28:31], v[204:219]
    v_mfma_f32_32x32x16_bf16 v[220:235], v[188:191], v[32:35], 0
    v_mfma_f32_32x32x16_bf16 v[220:235], v[192:195], v[36:39], v[220:235]
    v_mfma_f32_32x32x16_bf16 v[220:235], v[196:199], v[40:43], v[220:235]
    v_mfma_f32_32x32x16_bf16 v[220:235], v[200:203], v[44:47], v[220:235]
    v_cvt_pk_bf16_f32 v236, v120, v121
    v_cvt_pk_bf16_f32 v237, v122, v123
    v_cvt_pk_bf16_f32 v238, v124, v125
    v_cvt_pk_bf16_f32 v239, v126, v127
    v_cvt_pk_bf16_f32 v240, v128, v129
    v_cvt_pk_bf16_f32 v241, v130, v131
    v_cvt_pk_bf16_f32 v242, v132, v133
    v_cvt_pk_bf16_f32 v243, v134, v135
    v_cvt_pk_bf16_f32 v244, v136, v137
    v_cvt_pk_bf16_f32 v245, v138, v139
    v_cvt_pk_bf16_f32 v246, v140, v141
    v_cvt_pk_bf16_f32 v247, v142, v143
    v_cvt_pk_bf16_f32 v248, v144, v145
    v_cvt_pk_bf16_f32 v249, v146, v147
    v_cvt_pk_bf16_f32 v250, v148, v149
    v_cvt_pk_bf16_f32 v251, v150, v151
    v_xor_b32_e64 v14, 0, v3
    ds_write_b64 v14, v[236:237] offset:0
    ds_write_b64 v14, v[244:245] offset:2048
    v_xor_b32_e64 v14, 16, v3
    ds_write_b64 v14, v[238:239] offset:0
    ds_write_b64 v14, v[246:247] offset:2048
    v_xor_b32_e64 v14, 32, v3
    ds_write_b64 v14, v[240:241] offset:0
    ds_write_b64 v14, v[248:249] offset:2048
    v_xor_b32_e64 v14, 48, v3
    ds_write_b64 v14, v[242:243] offset:0
    ds_write_b64 v14, v[250:251] offset:2048
    s_nop 0
    s_waitcnt lgkmcnt(0)
    v_xor_b32 v14, 200, v13
    ds_read_b64_tr_b16 v[188:189], v14 offset:12288
    ds_read_b64_tr_b16 v[192:193], v14 offset:13312
    ds_read_b64_tr_b16 v[196:197], v14 offset:14336
    ds_read_b64_tr_b16 v[200:201], v14 offset:15360
    v_xor_b32 v14, 216, v13
    ds_read_b64_tr_b16 v[190:191], v14 offset:12544
    ds_read_b64_tr_b16 v[194:195], v14 offset:13568
    ds_read_b64_tr_b16 v[198:199], v14 offset:14592
    ds_read_b64_tr_b16 v[202:203], v14 offset:15616
    v_mfma_f32_32x32x16_bf16 v[120:135], v[104:107], v[16:19], 0
    v_mfma_f32_32x32x16_bf16 v[120:135], v[108:111], v[20:23], v[120:135]
    v_mfma_f32_32x32x16_bf16 v[120:135], v[112:115], v[24:27], v[120:135]
    v_mfma_f32_32x32x16_bf16 v[120:135], v[116:119], v[28:31], v[120:135]
    v_mfma_f32_32x32x16_bf16 v[136:151], v[104:107], v[32:35], 0
    v_mfma_f32_32x32x16_bf16 v[136:151], v[108:111], v[36:39], v[136:151]
    v_mfma_f32_32x32x16_bf16 v[136:151], v[112:115], v[40:43], v[136:151]
    v_mfma_f32_32x32x16_bf16 v[136:151], v[116:119], v[44:47], v[136:151]
    v_cvt_pk_bf16_f32 v236, v204, v205
    v_cvt_pk_bf16_f32 v237, v206, v207
    v_cvt_pk_bf16_f32 v238, v208, v209
    v_cvt_pk_bf16_f32 v239, v210, v211
    v_cvt_pk_bf16_f32 v240, v212, v213
    v_cvt_pk_bf16_f32 v241, v214, v215
    v_cvt_pk_bf16_f32 v242, v216, v217
    v_cvt_pk_bf16_f32 v243, v218, v219
    v_cvt_pk_bf16_f32 v244, v220, v221
    v_cvt_pk_bf16_f32 v245, v222, v223
    v_cvt_pk_bf16_f32 v246, v224, v225
    v_cvt_pk_bf16_f32 v247, v226, v227
    v_cvt_pk_bf16_f32 v248, v228, v229
    v_cvt_pk_bf16_f32 v249, v230, v231
    v_cvt_pk_bf16_f32 v250, v232, v233
    v_cvt_pk_bf16_f32 v251, v234, v235
    v_xor_b32_e64 v14, 64, v3
    ds_write_b64 v14, v[236:237] offset:4096
    ds_write_b64 v14, v[244:245] offset:6144
    v_xor_b32 v14, 80, v3
    ds_write_b64 v14, v[238:239] offset:4096
    ds_write_b64 v14, v[246:247] offset:6144
    v_xor_b32 v14, 96, v3
    ds_write_b64 v14, v[240:241] offset:4096
    ds_write_b64 v14, v[248:249] offset:6144
    v_xor_b32 v14, 112, v3
    ds_write_b64 v14, v[242:243] offset:4096
    ds_write_b64 v14, v[250:251] offset:6144
    s_nop 0
    s_waitcnt lgkmcnt(0)
    v_mfma_f32_32x32x16_bf16 v[204:219], v[188:191], v[16:19], 0
    v_mfma_f32_32x32x16_bf16 v[204:219], v[192:195], v[20:23], v[204:219]
    v_mfma_f32_32x32x16_bf16 v[204:219], v[196:199], v[24:27], v[204:219]
    v_mfma_f32_32x32x16_bf16 v[204:219], v[200:203], v[28:31], v[204:219]
    v_mfma_f32_32x32x16_bf16 v[220:235], v[188:191], v[32:35], 0
    v_mfma_f32_32x32x16_bf16 v[220:235], v[192:195], v[36:39], v[220:235]
    v_mfma_f32_32x32x16_bf16 v[220:235], v[196:199], v[40:43], v[220:235]
    v_mfma_f32_32x32x16_bf16 v[220:235], v[200:203], v[44:47], v[220:235]
    v_cvt_pk_bf16_f32 v236, v120, v121
    v_cvt_pk_bf16_f32 v237, v122, v123
    v_cvt_pk_bf16_f32 v238, v124, v125
    v_cvt_pk_bf16_f32 v239, v126, v127
    v_cvt_pk_bf16_f32 v240, v128, v129
    v_cvt_pk_bf16_f32 v241, v130, v131
    v_cvt_pk_bf16_f32 v242, v132, v133
    v_cvt_pk_bf16_f32 v243, v134, v135
    v_cvt_pk_bf16_f32 v244, v136, v137
    v_cvt_pk_bf16_f32 v245, v138, v139
    v_cvt_pk_bf16_f32 v246, v140, v141
    v_cvt_pk_bf16_f32 v247, v142, v143
    v_cvt_pk_bf16_f32 v248, v144, v145
    v_cvt_pk_bf16_f32 v249, v146, v147
    v_cvt_pk_bf16_f32 v250, v148, v149
    v_cvt_pk_bf16_f32 v251, v150, v151
    v_xor_b32 v14, 128, v3
    ds_write_b64 v14, v[236:237] offset:8192
    ds_write_b64 v14, v[244:245] offset:10240
    v_xor_b32 v14, 144, v3
    ds_write_b64 v14, v[238:239] offset:8192
    ds_write_b64 v14, v[246:247] offset:10240
    v_xor_b32 v14, 160, v3
    ds_write_b64 v14, v[240:241] offset:8192
    ds_write_b64 v14, v[248:249] offset:10240
    v_xor_b32 v14, 176, v3
    ds_write_b64 v14, v[242:243] offset:8192
    ds_write_b64 v14, v[250:251] offset:10240
    v_cvt_pk_bf16_f32 v236, v204, v205
    v_cvt_pk_bf16_f32 v237, v206, v207
    v_cvt_pk_bf16_f32 v238, v208, v209
    v_cvt_pk_bf16_f32 v239, v210, v211
    v_cvt_pk_bf16_f32 v240, v212, v213
    v_cvt_pk_bf16_f32 v241, v214, v215
    v_cvt_pk_bf16_f32 v242, v216, v217
    v_cvt_pk_bf16_f32 v243, v218, v219
    v_cvt_pk_bf16_f32 v244, v220, v221
    v_cvt_pk_bf16_f32 v245, v222, v223
    v_cvt_pk_bf16_f32 v246, v224, v225
    v_cvt_pk_bf16_f32 v247, v226, v227
    v_cvt_pk_bf16_f32 v248, v228, v229
    v_cvt_pk_bf16_f32 v249, v230, v231
    v_cvt_pk_bf16_f32 v250, v232, v233
    v_cvt_pk_bf16_f32 v251, v234, v235
    v_xor_b32 v14, 192, v3
    ds_write_b64 v14, v[236:237] offset:12288
    ds_write_b64 v14, v[244:245] offset:14336
    v_xor_b32 v14, 208, v3
    ds_write_b64 v14, v[238:239] offset:12288
    ds_write_b64 v14, v[246:247] offset:14336
    v_xor_b32 v14, 224, v3
    ds_write_b64 v14, v[240:241] offset:12288
    ds_write_b64 v14, v[248:249] offset:14336
    v_xor_b32 v14, 240, v3
    ds_write_b64 v14, v[242:243] offset:12288
    ds_write_b64 v14, v[250:251] offset:14336
    ds_read_b128 v[16:19], v6 offset:0
    ds_read_b128 v[20:23], v6 offset:2048
    ds_read_b128 v[24:27], v7 offset:256
    ds_read_b128 v[28:31], v7 offset:2304
    ds_read_b128 v[32:35], v6 offset:512
    ds_read_b128 v[36:39], v6 offset:2560
    ds_read_b128 v[40:43], v7 offset:768
    ds_read_b128 v[44:47], v7 offset:2816
    s_nop 0
    s_waitcnt lgkmcnt(7)
    buffer_store_dwordx4 v[16:19], v11, s[20:23], s28 offen offset:0 sc1
    s_nop 0
    s_waitcnt lgkmcnt(6)
    buffer_store_dwordx4 v[20:23], v11, s[20:23], s28 offen offset:2048 sc1
    s_add_u32 s28, s28, 0x80000
    s_nop 0
    s_waitcnt lgkmcnt(5)
    buffer_store_dwordx4 v[24:27], v11, s[20:23], s28 offen offset:0 sc1
    s_nop 0
    s_waitcnt lgkmcnt(4)
    buffer_store_dwordx4 v[28:31], v11, s[20:23], s28 offen offset:2048 sc1
    s_add_u32 s28, s28, 0x80000
    s_nop 0
    s_waitcnt lgkmcnt(3)
    buffer_store_dwordx4 v[32:35], v11, s[20:23], s28 offen offset:0 sc1
    s_nop 0
    s_waitcnt lgkmcnt(2)
    buffer_store_dwordx4 v[36:39], v11, s[20:23], s28 offen offset:2048 sc1
    s_add_u32 s28, s28, 0x80000
    s_nop 0
    s_waitcnt lgkmcnt(1)
    buffer_store_dwordx4 v[40:43], v11, s[20:23], s28 offen offset:0 sc1
    s_nop 0
    s_waitcnt lgkmcnt(0)
    buffer_store_dwordx4 v[44:47], v11, s[20:23], s28 offen offset:2048 sc1
    s_add_u32 s28, s28, 0x80000
    ds_read_b128 v[48:51], v6 offset:1024
    ds_read_b128 v[52:55], v6 offset:3072
    ds_read_b128 v[56:59], v7 offset:1280
    ds_read_b128 v[60:63], v7 offset:3328
    ds_read_b128 v[64:67], v6 offset:1536
    ds_read_b128 v[68:71], v6 offset:3584
    ds_read_b128 v[72:75], v7 offset:1792
    ds_read_b128 v[76:79], v7 offset:3840
    s_nop 0
    s_waitcnt lgkmcnt(7)
    buffer_store_dwordx4 v[48:51], v11, s[20:23], s28 offen offset:0 sc1
    s_nop 0
    s_waitcnt lgkmcnt(6)
    buffer_store_dwordx4 v[52:55], v11, s[20:23], s28 offen offset:2048 sc1
    s_add_u32 s28, s28, 0x80000
    s_nop 0
    s_waitcnt lgkmcnt(5)
    buffer_store_dwordx4 v[56:59], v11, s[20:23], s28 offen offset:0 sc1
    s_nop 0
    s_waitcnt lgkmcnt(4)
    buffer_store_dwordx4 v[60:63], v11, s[20:23], s28 offen offset:2048 sc1
    s_add_u32 s28, s28, 0x80000
    s_nop 0
    s_waitcnt lgkmcnt(3)
    buffer_store_dwordx4 v[64:67], v11, s[20:23], s28 offen offset:0 sc1
    s_nop 0
    s_waitcnt lgkmcnt(2)
    buffer_store_dwordx4 v[68:71], v11, s[20:23], s28 offen offset:2048 sc1
    s_add_u32 s28, s28, 0x80000
    s_nop 0
    s_waitcnt lgkmcnt(1)
    buffer_store_dwordx4 v[72:75], v11, s[20:23], s28 offen offset:0 sc1
    s_nop 0
    s_waitcnt lgkmcnt(0)
    buffer_store_dwordx4 v[76:79], v11, s[20:23], s28 offen offset:2048 sc1
    s_add_u32 s28, s28, 0x80000
    s_add_u32 s84, s6, 41943040
    s_addc_u32 s85, s7, 0
    s_nop 0
    s_mov_b32 s86, 4096
    s_mov_b32 s87, 0x20000
    v_mov_b32 v240, 0
    s_lshl_b32 s57, s2, 2
    s_add_u32 s57, s57, 2048
k3_in:
    s_load_dwordx2 s[4:5], s[0:1], 0
    s_load_dwordx4 s[36:39], s[0:1], 48
    s_load_dwordx2 s[6:7], s[0:1], 72
    s_and_b32 s47, s2, 1
    s_nop 0
    s_bfe_u32 s28, s2, 0x10001
    s_lshl_b32 s28, s28, 3
    s_nop 0
    s_bfe_u32 s29, s2, 0x30003
    s_add_u32 s28, s28, s29
    s_nop 0
    s_bfe_u32 s29, s2, 0x10002
    s_lshl_b32 s29, s29, 2
    s_lshr_b32 s30, s2, 6
    s_add_u32 s29, s29, s30
    s_lshl_b32 s29, s29, 1
    s_add_u32 s29, s29, s47
    s_lshr_b32 s30, s3, 2
    s_and_b32 s31, s3, 3
    s_nop 0
    s_bfe_u32 s28, s2, 0x20001
    s_lshl_b32 s28, s28, 2
    s_nop 0
    s_bfe_u32 s29, s2, 0x20003
    s_add_u32 s28, s28, s29
    s_lshr_b32 s29, s2, 5
    s_lshl_b32 s29, s29, 1
    s_add_u32 s29, s29, s47
    s_lshl_b32 s47, s47, 1
    s_add_u32 s47, s47, s30
    v_lshrrev_b32_e64 v4, 5, v0
    v_bfe_u32 v3, v0, 2, 2
    v_lshl_add_u32 v2, v4, 2, v3
    v_lshlrev_b32_e64 v2, 11, v2
    v_bfe_u32 v3, v0, 4, 1
    v_lshl_add_u32 v2, v3, 6, v2
    v_and_b32_e64 v3, 3, v0
    v_lshl_add_u32 v2, v3, 4, v2
    v_and_b32 v3, 32, v0
    v_xor_b32 v2, v2, v3
    s_lshl_b32 s32, s29, 7
    s_lshl_b32 s33, s31, 15
    s_add_u32 s32, s32, s33
    v_add_u32 v2, s32, v2
    v_add_u32 v5, 0x3c00, v2
    v_lshlrev_b32_e64 v6, 4, v0
    s_lshl_b32 s32, s28, 2
    s_add_u32 s32, s32, s31
    s_mul_i32 s40, s32, 224*1024
    s_mul_i32 s33, s47, 56*1024
    s_add_u32 s40, s40, s33
    s_lshl_b32 s42, s3, 11
    s_lshl_b32 s43, s28, 1
    s_add_u32 s33, s43, s30
    s_lshl_b32 s33, s33, 17
    s_lshr_b32 s34, s31, 1
    s_add_u32 s43, s43, s34
    s_and_b32 s35, s31, 1
    s_lshl_b32 s35, s35, 5
    v_and_b32 v8, 15, v0
    v_add_u32 v8, s35, v8
    v_lshrrev_b32 v7, 2, v0
    v_add_u32 v7, s35, v7
    v_lshlrev_b32 v7, 16, v7
    v_and_b32_e64 v3, 3, v0
    v_lshl_add_u32 v7, v3, 4, v7
    s_mov_b32 s46, 0x100000
    s_lshl_b32 s43, s43, 11
    s_lshl_b32 s35, s29, 7
    s_add_u32 s43, s43, s35
    s_lshl_b32 s35, s30, 6
    s_add_u32 s43, s43, s35
    v_add_u32_e64 v7, s43, v7
    s_waitcnt lgkmcnt(0)
    s_add_u32 s8, s6, 8388608
    s_addc_u32 s9, s7, 0
    s_nop 0
    s_mov_b32 s10, 14680064
    s_mov_b32 s11, 0x20000
    s_add_u32 s12, s6, 33554432
    s_addc_u32 s13, s7, 0
    s_nop 0
    s_mov_b32 s14, 7340032
    s_mov_b32 s15, 0x20000
    s_add_u32 s52, s6, 4194304
    s_addc_u32 s53, s7, 0
    s_nop 0
    s_mov_b32 s54, 4194304
    s_mov_b32 s55, 0x20000
    s_add_u32 s16, s6, 25165824
    s_addc_u32 s17, s7, 0
    s_nop 0
    s_mov_b32 s18, 4194304
    s_mov_b32 s19, 0x20000
    s_mov_b32 s20, s4
    s_mov_b32 s21, s5
    s_mov_b32 s22, 4194304
    s_mov_b32 s23, 0x20000
    s_mov_b32 s24, s38
    s_mov_b32 s25, s39
    s_mov_b32 s26, 4194304
    s_mov_b32 s27, 0x20000
    s_lshl_b32 s41, s31, 11
    s_nop 0
    s_mul_i32 s32, s47, 896*128
    s_add_u32 s32, s32, s41
    s_nop 0
    s_mul_i32 s41, s29, 458752
    s_add_u32 s41, s41, s32
    s_xor_b32 s48, s29, 1
    s_mul_i32 s48, s48, 458752
    s_add_u32 s48, s48, s32
    s_lshl_b32 s49, s2, 3
    s_add_u32 s49, s49, s3
    s_lshl_b32 s49, s49, 11
    s_xor_b32 s50, s49, 0x4000
    v_mov_b32_e64 v244, v6
    s_mov_b32 s59, 0x40000
    s_waitcnt vmcnt(63)
k3_wa:
    v_and_b32 v240, v240, v241
    v_and_b32 v242, v242, v243
    v_and_b32 v240, v240, v242
    v_cmp_ne_u32 vcc, 1, v240
    s_sub_u32 s59, s59, 1
    s_cbranch_scc1 k3_wa_x
    s_cbranch_vccz k3_wa_x
    buffer_load_dwordx4 v[240:243], v244, s[84:87], 0 offen offset:0 sc1
    s_waitcnt vmcnt(0)
    s_branch k3_wa
k3_wa_x:
    v_lshrrev_b32 v4, 4, v0
    v_lshlrev_b32 v9, 9, v4
    v_and_b32_e64 v3, 1, v4
    v_lshl_add_u32 v9, v3, 5, v9
    v_bfe_u32 v3, v0, 2, 2
    v_lshl_add_u32 v9, v3, 6, v9
    v_and_b32_e64 v3, 3, v0
    v_lshl_add_u32 v9, v3, 3, v9
    s_lshl_b32 s35, s34, 13
    s_lshl_b32 s44, s30, 8
    s_add_u32 s35, s35, s44
    s_nop 0
    s_add_u32 s35, s35, 131072
    v_add_u32 v1, s35, v9
    s_lshl_b32 s35, s30, 13
    v_add_u32 v9, s35, v9
    v_xor_b32 v10, 32, v9
    v_lshlrev_b32 v4, 1, v4
    v_cvt_f32_u32 v4, v4
    v_cmp_gt_u32 vcc, 16, v0
    v_add_u32 v11, 0, v8
    v_cvt_f32_u32_e64 v11, v11
    v_mul_f32 v11, 0x3c800000, v11
    v_mul_f32_e64 v12, v4, v11
    v_add_f32 v13, 0x3e800000, v12
    v_fmamk_f32 v14, v11, 0x00000000, v12
    v_fmamk_f32 v15, v11, 0x00000000, v13
    v_mul_f32 v3, 0x42000000, v11
    v_cndmask_b32 v15, v15, v3, vcc
    v_cos_f32 v14, v14
    v_cos_f32 v15, v15
    s_nop 0
    v_cvt_pk_bf16_f32 v184, v14, v15
    v_fmamk_f32 v14, v11, 0x3f800000, v12
    v_fmamk_f32 v15, v11, 0x3f800000, v13
    v_cos_f32 v14, v14
    v_cos_f32_e64 v15, v15
    s_nop 0
    v_cvt_pk_bf16_f32 v185, v14, v15
    v_fmamk_f32 v14, v11, 0x41000000, v12
    v_fmamk_f32 v15, v11, 0x41000000, v13
    v_cos_f32 v14, v14
    v_cos_f32_e64 v15, v15
    s_nop 0
    v_cvt_pk_bf16_f32 v186, v14, v15
    v_fmamk_f32 v14, v11, 0x41100000, v12
    v_fmamk_f32 v15, v11, 0x41100000, v13
    v_cos_f32 v14, v14
    v_cos_f32_e64 v15, v15
    s_nop 0
    v_cvt_pk_bf16_f32 v187, v14, v15
    v_fmamk_f32 v14, v11, 0x41800000, v12
    v_fmamk_f32 v15, v11, 0x41800000, v13
    v_cos_f32 v14, v14
    v_cos_f32_e64 v15, v15
    s_nop 0
    v_cvt_pk_bf16_f32 v188, v14, v15
    v_fmamk_f32 v14, v11, 0x41880000, v12
    v_fmamk_f32 v15, v11, 0x41880000, v13
    v_cos_f32 v14, v14
    v_cos_f32_e64 v15, v15
    s_nop 0
    v_cvt_pk_bf16_f32 v189, v14, v15
    v_fmamk_f32 v14, v11, 0x41c00000, v12
    v_fmamk_f32 v15, v11, 0x41c00000, v13
    v_cos_f32 v14, v14
    v_cos_f32_e64 v15, v15
    s_nop 0
    v_cvt_pk_bf16_f32 v190, v14, v15
    v_fmamk_f32 v14, v11, 0x41c80000, v12
    v_fmamk_f32 v15, v11, 0x41c80000, v13
    v_cos_f32 v14, v14
    v_cos_f32_e64 v15, v15
    s_nop 0
    v_cvt_pk_bf16_f32 v191, v14, v15
    v_add_u32 v11, 16, v8
    v_cvt_f32_u32 v11, v11
    v_mul_f32 v11, 0x3c800000, v11
    v_mul_f32_e64 v12, v4, v11
    v_add_f32 v13, 0x3e800000, v12
    v_fmamk_f32 v14, v11, 0x00000000, v12
    v_fmamk_f32 v15, v11, 0x00000000, v13
    v_mul_f32 v3, 0x42000000, v11
    v_cndmask_b32 v15, v15, v3, vcc
    v_cos_f32 v14, v14
    v_cos_f32 v15, v15
    s_nop 0
    v_cvt_pk_bf16_f32 v192, v14, v15
    v_fmamk_f32 v14, v11, 0x3f800000, v12
    v_fmamk_f32 v15, v11, 0x3f800000, v13
    v_cos_f32 v14, v14
    v_cos_f32_e64 v15, v15
    s_nop 0
    v_cvt_pk_bf16_f32 v193, v14, v15
    v_fmamk_f32 v14, v11, 0x41000000, v12
    v_fmamk_f32 v15, v11, 0x41000000, v13
    v_cos_f32 v14, v14
    v_cos_f32_e64 v15, v15
    s_nop 0
    v_cvt_pk_bf16_f32 v194, v14, v15
    v_fmamk_f32 v14, v11, 0x41100000, v12
    v_fmamk_f32 v15, v11, 0x41100000, v13
    v_cos_f32 v14, v14
    v_cos_f32_e64 v15, v15
    s_nop 0
    v_cvt_pk_bf16_f32 v195, v14, v15
    v_fmamk_f32 v14, v11, 0x41800000, v12
    v_fmamk_f32 v15, v11, 0x41800000, v13
    v_cos_f32 v14, v14
    v_cos_f32_e64 v15, v15
    s_nop 0
    v_cvt_pk_bf16_f32 v196, v14, v15
    v_fmamk_f32 v14, v11, 0x41880000, v12
    v_fmamk_f32 v15, v11, 0x41880000, v13
    v_cos_f32 v14, v14
    v_cos_f32_e64 v15, v15
    s_nop 0
    v_cvt_pk_bf16_f32 v197, v14, v15
    v_fmamk_f32 v14, v11, 0x41c00000, v12
    v_fmamk_f32 v15, v11, 0x41c00000, v13
    v_cos_f32 v14, v14
    v_cos_f32_e64 v15, v15
    s_nop 0
    v_cvt_pk_bf16_f32 v198, v14, v15
    v_fmamk_f32 v14, v11, 0x41c80000, v12
    v_fmamk_f32 v15, v11, 0x41c80000, v13
    v_cos_f32 v14, v14
    v_cos_f32_e64 v15, v15
    s_nop 0
    v_cvt_pk_bf16_f32 v199, v14, v15
    v_mov_b32 v16, 0
    v_mov_b32 v17, 0
    v_mov_b32 v18, 0
    v_mov_b32 v19, 0
    v_mov_b32 v20, 0
    v_mov_b32 v21, 0
    v_mov_b32 v22, 0
    v_mov_b32 v23, 0
    v_mov_b32 v24, 0
    v_mov_b32 v25, 0
    v_mov_b32 v26, 0
    v_mov_b32 v27, 0
    v_mov_b32 v28, 0
    v_mov_b32 v29, 0
    v_mov_b32 v30, 0
    v_mov_b32 v31, 0
    v_mov_b32 v32, 0
    v_mov_b32 v33, 0
    v_mov_b32 v34, 0
    v_mov_b32 v35, 0
    v_mov_b32 v36, 0
    v_mov_b32 v37, 0
    v_mov_b32 v38, 0
    v_mov_b32 v39, 0
    v_mov_b32 v40, 0
    v_mov_b32 v41, 0
    v_mov_b32 v42, 0
    v_mov_b32 v43, 0
    v_mov_b32 v44, 0
    v_mov_b32 v45, 0
    v_mov_b32 v46, 0
    v_mov_b32 v47, 0
    v_mov_b32 v48, 0
    v_mov_b32 v49, 0
    v_mov_b32 v50, 0
    v_mov_b32 v51, 0
    v_mov_b32 v52, 0
    v_mov_b32 v53, 0
    v_mov_b32 v54, 0
    v_mov_b32 v55, 0
    v_mov_b32 v56, 0
    v_mov_b32 v57, 0
    v_mov_b32 v58, 0
    v_mov_b32 v59, 0
    v_mov_b32 v60, 0
    v_mov_b32 v61, 0
    v_mov_b32 v62, 0
    v_mov_b32 v63, 0
    v_mov_b32 v64, 0
    v_mov_b32 v65, 0
    v_mov_b32 v66, 0
    v_mov_b32 v67, 0
    v_mov_b32 v68, 0
    v_mov_b32 v69, 0
    v_mov_b32 v70, 0
    v_mov_b32 v71, 0
    v_mov_b32 v72, 0
    v_mov_b32 v73, 0
    v_mov_b32 v74, 0
    v_mov_b32 v75, 0
    v_mov_b32 v76, 0
    v_mov_b32 v77, 0
    v_mov_b32 v78, 0
    v_mov_b32 v79, 0
    v_add_u32 v200, s44, v9
    v_xor_b32 v201, 32, v200
    v_xor_b32 v202, 256, v200
    v_xor_b32 v203, 288, v200
    v_xor_b32 v204, 65536, v200
    v_xor_b32 v205, 65568, v200
    v_xor_b32 v206, 65792, v200
    v_xor_b32 v207, 65824, v200
    s_lshl_b32 s35, s3, 12
    s_nop 0
    s_add_u32 s35, s35, 65536
    v_add_u32_e64 v11, s35, v6
    v_xor_b32 v12, 0x4000, v11
    v_xor_b32_e64 v10, 32, v1
    s_mov_b32 s56, 0x6f800000
    v_mov_b32 v15, 0x60000000
    s_movk_i32 s58, 0x6000
    s_and_b32 s35, s28, 14
    s_and_b32 s59, s2, 1
    s_add_u32 s35, s35, s59
    s_lshl_b32 s35, s35, 7
    v_min_u32 v244, 13, v0
    v_lshl_add_u32 v244, v244, 2, s35
    v_lshlrev_b32_e64 v245, 2, v0
    v_add_u32 v245, 1920, v245
    v_cmp_gt_u32 vcc, 32, v0
    s_nop 1
    v_cndmask_b32 v244, v245, v244, vcc
    s_waitcnt vmcnt(0)
    s_barrier
    s_cmp_lg_u32 s3, 0
    s_cbranch_scc1 k3_f0
    s_lshl_b32 s59, s2, 2
    v_mov_b32 v245, 1
    s_mov_b64 exec, 1
    buffer_store_dword v245, off, s[84:87], s57 offset:1024 sc1
    s_mov_b64 exec, -1
k3_f0:
    s_nop 0
    s_add_u32 m0, s42, 16384
    s_nop 0
    s_nop 0
    buffer_load_dwordx4 v6, s[12:15], s48 offen sc1 lds
    buffer_load_dwordx4 v6, s[12:15], s48 offen offset:1024 sc1 lds
    s_add_u32 s48, s48, 8192
    s_add_u32 m0, s42, 0
    s_nop 0
    buffer_load_dwordx4 v6, s[12:15], s41 offen sc1 lds
    buffer_load_dwordx4 v6, s[12:15], s41 offen offset:1024 sc1 lds
    s_add_u32 s41, s41, 8192
    s_add_u32 m0, s42, 49152
    s_nop 0
    s_nop 0
    buffer_load_dwordx4 v6, s[12:15], s48 offen sc1 lds
    buffer_load_dwordx4 v6, s[12:15], s48 offen offset:1024 sc1 lds
    s_add_u32 s48, s48, 8192
    s_add_u32 m0, s42, 32768
    s_nop 0
    s_nop 0
    buffer_load_dwordx4 v6, s[12:15], s41 offen sc1 lds
    buffer_load_dwordx4 v6, s[12:15], s41 offen offset:1024 sc1 lds
    s_add_u32 s41, s41, 8192
    s_add_u32 m0, s42, 81920
    s_nop 0
    s_nop 0
    buffer_load_dwordx4 v6, s[12:15], s48 offen sc1 lds
    buffer_load_dwordx4 v6, s[12:15], s48 offen offset:1024 sc1 lds
    s_add_u32 s48, s48, 8192
    s_add_u32 m0, s42, 65536
    s_nop 0
    s_nop 0
    buffer_load_dwordx4 v6, s[12:15], s41 offen sc1 lds
    buffer_load_dwordx4 v6, s[12:15], s41 offen offset:1024 sc1 lds
    s_add_u32 s41, s41, 8192
    s_cmp_lg_u32 s3, 0
    s_cbranch_scc1 k3_fb
    v_mov_b32_e64 v240, 0
    s_mov_b32 s59, 0x40000
    s_waitcnt vmcnt(63)
k3_wb:
    v_and_b32 v240, v240, v241
    v_and_b32 v242, v242, v243
    v_and_b32 v240, v240, v242
    v_cmp_ne_u32 vcc, 1, v240
    s_sub_u32 s59, s59, 1
    s_cbranch_scc1 k3_wb_x
    s_cbranch_vccz k3_wb_x
    buffer_load_dword v240, v244, s[84:87], 0 offen offset:1024 sc1
    s_waitcnt vmcnt(0)
    s_branch k3_wb
k3_wb_x:
k3_fb:
    s_nop 0
    s_barrier
    buffer_load_dwordx4 v[88:91], v6, s[8:11], s40 offen offset:0 sc1
    buffer_load_dwordx4 v[92:95], v6, s[8:11], s40 offen offset:1024 sc1
    buffer_load_dwordx4 v[96:99], v6, s[8:11], s40 offen offset:2048 sc1
    buffer_load_dwordx4 v[100:103], v6, s[8:11], s40 offen offset:3072 sc1
    s_add_u32 s40, s40, 4096
    buffer_load_dwordx4 v[104:107], v6, s[8:11], s40 offen offset:0 sc1
    buffer_load_dwordx4 v[108:111], v6, s[8:11], s40 offen offset:1024 sc1
    buffer_load_dwordx4 v[112:115], v6, s[8:11], s40 offen offset:2048 sc1
    buffer_load_dwordx4 v[116:119], v6, s[8:11], s40 offen offset:3072 sc1
    s_add_u32 s40, s40, 4096
    buffer_load_dwordx4 v[120:123], v6, s[8:11], s40 offen offset:0 sc1
    buffer_load_dwordx4 v[124:127], v6, s[8:11], s40 offen offset:1024 sc1
    buffer_load_dwordx4 v[128:131], v6, s[8:11], s40 offen offset:2048 sc1
    buffer_load_dwordx4 v[132:135], v6, s[8:11], s40 offen offset:3072 sc1
    s_add_u32 s40, s40, 4096
    s_waitcnt vmcnt(8)
    s_barrier
    ds_read_b64_tr_b16 v[152:153], v200 offset:16384
    ds_read_b64_tr_b16 v[154:155], v200 offset:18432
    ds_read_b64_tr_b16 v[156:157], v201 offset:16384
    ds_read_b64_tr_b16 v[158:159], v201 offset:18432
    ds_read_b64_tr_b16 v[160:161], v202 offset:16384
    ds_read_b64_tr_b16 v[162:163], v202 offset:18432
    ds_read_b64_tr_b16 v[164:165], v203 offset:16384
    ds_read_b64_tr_b16 v[166:167], v203 offset:18432
    s_nop 0
    s_waitcnt lgkmcnt(0)
    v_mfma_f32_16x16x32_bf16 v[48:51], v[152:155], v[88:91], v[48:51]
    ds_read_b64_tr_b16 v[168:169], v200 offset:20480
    ds_read_b64_tr_b16 v[170:171], v200 offset:22528
    v_mfma_f32_16x16x32_bf16 v[56:59], v[152:155], v[92:95], v[56:59]
    ds_read_b64_tr_b16 v[172:173], v201 offset:20480
    ds_read_b64_tr_b16 v[174:175], v201 offset:22528
    v_mfma_f32_16x16x32_bf16 v[60:63], v[156:159], v[92:95], v[60:63]
    ds_read_b64_tr_b16 v[176:177], v202 offset:20480
    ds_read_b64_tr_b16 v[178:179], v202 offset:22528
    v_mfma_f32_16x16x32_bf16 v[52:55], v[156:159], v[88:91], v[52:55]
    ds_read_b64_tr_b16 v[180:181], v203 offset:20480
    ds_read_b64_tr_b16 v[182:183], v203 offset:22528
    s_add_u32 m0, s42, 114688
    v_mfma_f32_16x16x32_bf16 v[64:67], v[160:163], v[88:91], v[64:67]
    buffer_load_dwordx4 v6, s[12:15], s48 offen sc1 lds
    v_mfma_f32_16x16x32_bf16 v[72:75], v[160:163], v[92:95], v[72:75]
    buffer_load_dwordx4 v6, s[12:15], s48 offen offset:1024 sc1 lds
    s_add_u32 s48, s48, 8192
    s_add_u32 m0, s42, 98304
    v_mfma_f32_16x16x32_bf16 v[76:79], v[164:167], v[92:95], v[76:79]
    buffer_load_dwordx4 v6, s[12:15], s41 offen sc1 lds
    v_mfma_f32_16x16x32_bf16 v[68:71], v[164:167], v[88:91], v[68:71]
    s_nop 0
    s_waitcnt lgkmcnt(0)
    v_mfma_f32_16x16x32_bf16 v[48:51], v[168:171], v[96:99], v[48:51]
    ds_read_b64_tr_b16 v[152:153], v200 offset:0
    ds_read_b64_tr_b16 v[154:155], v200 offset:2048
    v_mfma_f32_16x16x32_bf16 v[56:59], v[168:171], v[100:103], v[56:59]
    ds_read_b64_tr_b16 v[156:157], v201 offset:0
    ds_read_b64_tr_b16 v[158:159], v201 offset:2048
    v_mfma_f32_16x16x32_bf16 v[60:63], v[172:175], v[100:103], v[60:63]
    ds_read_b64_tr_b16 v[160:161], v202 offset:0
    ds_read_b64_tr_b16 v[162:163], v202 offset:2048
    v_mfma_f32_16x16x32_bf16 v[52:55], v[172:175], v[96:99], v[52:55]
    ds_read_b64_tr_b16 v[164:165], v203 offset:0
    ds_read_b64_tr_b16 v[166:167], v203 offset:2048
    v_mfma_f32_16x16x32_bf16 v[64:67], v[176:179], v[96:99], v[64:67]
    buffer_load_dwordx4 v6, s[12:15], s41 offen offset:1024 sc1 lds
    s_add_u32 s41, s41, 8192
    v_mfma_f32_16x16x32_bf16 v[72:75], v[176:179], v[100:103], v[72:75]
    buffer_load_dwordx4 v[136:139], v6, s[8:11], s40 offen offset:0 sc1
    v_mfma_f32_16x16x32_bf16 v[76:79], v[180:183], v[100:103], v[76:79]
    buffer_load_dwordx4 v[140:143], v6, s[8:11], s40 offen offset:1024 sc1
    v_mfma_f32_16x16x32_bf16 v[68:71], v[180:183], v[96:99], v[68:71]
    s_nop 0
    s_waitcnt lgkmcnt(0)
    v_mfma_f32_16x16x32_bf16 v[16:19], v[152:155], v[88:91], v[16:19]
    ds_read_b64_tr_b16 v[168:169], v200 offset:4096
    ds_read_b64_tr_b16 v[170:171], v200 offset:6144
    v_mfma_f32_16x16x32_bf16 v[24:27], v[152:155], v[92:95], v[24:27]
    ds_read_b64_tr_b16 v[172:173], v201 offset:4096
    ds_read_b64_tr_b16 v[174:175], v201 offset:6144
    v_mfma_f32_16x16x32_bf16 v[28:31], v[156:159], v[92:95], v[28:31]
    ds_read_b64_tr_b16 v[176:177], v202 offset:4096
    ds_read_b64_tr_b16 v[178:179], v202 offset:6144
    v_mfma_f32_16x16x32_bf16 v[20:23], v[156:159], v[88:91], v[20:23]
    ds_read_b64_tr_b16 v[180:181], v203 offset:4096
    ds_read_b64_tr_b16 v[182:183], v203 offset:6144
    v_mfma_f32_16x16x32_bf16 v[32:35], v[160:163], v[88:91], v[32:35]
    buffer_load_dwordx4 v[144:147], v6, s[8:11], s40 offen offset:2048 sc1
    v_mfma_f32_16x16x32_bf16 v[40:43], v[160:163], v[92:95], v[40:43]
    buffer_load_dwordx4 v[148:151], v6, s[8:11], s40 offen offset:3072 sc1
    s_add_u32 s40, s40, 4096
    v_mfma_f32_16x16x32_bf16 v[44:47], v[164:167], v[92:95], v[44:47]
    v_mfma_f32_16x16x32_bf16 v[36:39], v[164:167], v[88:91], v[36:39]
    s_waitcnt vmcnt(12) lgkmcnt(0)
    s_barrier
    v_mfma_f32_16x16x32_bf16 v[16:19], v[168:171], v[96:99], v[16:19]
    ds_read_b64_tr_b16 v[152:153], v200 offset:49152
    ds_read_b64_tr_b16 v[154:155], v200 offset:51200
    v_mfma_f32_16x16x32_bf16 v[24:27], v[168:171], v[100:103], v[24:27]
    ds_read_b64_tr_b16 v[156:157], v201 offset:49152
    ds_read_b64_tr_b16 v[158:159], v201 offset:51200
    v_mfma_f32_16x16x32_bf16 v[28:31], v[172:175], v[100:103], v[28:31]
    ds_read_b64_tr_b16 v[160:161], v202 offset:49152
    ds_read_b64_tr_b16 v[162:163], v202 offset:51200
    v_mfma_f32_16x16x32_bf16 v[20:23], v[172:175], v[96:99], v[20:23]
    ds_read_b64_tr_b16 v[164:165], v203 offset:49152
    ds_read_b64_tr_b16 v[166:167], v203 offset:51200
    v_mfma_f32_16x16x32_bf16 v[32:35], v[176:179], v[96:99], v[32:35]
    v_mfma_f32_16x16x32_bf16 v[40:43], v[176:179], v[100:103], v[40:43]
    v_mfma_f32_16x16x32_bf16 v[44:47], v[180:183], v[100:103], v[44:47]
    v_mfma_f32_16x16x32_bf16 v[36:39], v[180:183], v[96:99], v[36:39]
    s_nop 0
    s_waitcnt lgkmcnt(0)
    v_mfma_f32_16x16x32_bf16 v[48:51], v[152:155], v[104:107], v[48:51]
    ds_read_b64_tr_b16 v[168:169], v200 offset:53248
    ds_read_b64_tr_b16 v[170:171], v200 offset:55296
    v_mfma_f32_16x16x32_bf16 v[56:59], v[152:155], v[108:111], v[56:59]
    ds_read_b64_tr_b16 v[172:173], v201 offset:53248
    ds_read_b64_tr_b16 v[174:175], v201 offset:55296
    v_mfma_f32_16x16x32_bf16 v[60:63], v[156:159], v[108:111], v[60:63]
    ds_read_b64_tr_b16 v[176:177], v202 offset:53248
    ds_read_b64_tr_b16 v[178:179], v202 offset:55296
    v_mfma_f32_16x16x32_bf16 v[52:55], v[156:159], v[104:107], v[52:55]
    ds_read_b64_tr_b16 v[180:181], v203 offset:53248
    ds_read_b64_tr_b16 v[182:183], v203 offset:55296
    s_add_u32 m0, s42, 16384
    v_mfma_f32_16x16x32_bf16 v[64:67], v[160:163], v[104:107], v[64:67]
    buffer_load_dwordx4 v6, s[12:15], s48 offen sc1 lds
    v_mfma_f32_16x16x32_bf16 v[72:75], v[160:163], v[108:111], v[72:75]
    buffer_load_dwordx4 v6, s[12:15], s48 offen offset:1024 sc1 lds
    s_add_u32 s48, s48, 8192
    s_add_u32 m0, s42, 0
    s_nop 0
    v_mfma_f32_16x16x32_bf16 v[76:79], v[164:167], v[108:111], v[76:79]
    buffer_load_dwordx4 v6, s[12:15], s41 offen sc1 lds
    v_mfma_f32_16x16x32_bf16 v[68:71], v[164:167], v[104:107], v[68:71]
    s_nop 0
    s_waitcnt lgkmcnt(0)
    v_mfma_f32_16x16x32_bf16 v[48:51], v[168:171], v[112:115], v[48:51]
    ds_read_b64_tr_b16 v[152:153], v200 offset:32768
    ds_read_b64_tr_b16 v[154:155], v200 offset:34816
    v_mfma_f32_16x16x32_bf16 v[56:59], v[168:171], v[116:119], v[56:59]
    ds_read_b64_tr_b16 v[156:157], v201 offset:32768
    ds_read_b64_tr_b16 v[158:159], v201 offset:34816
    v_mfma_f32_16x16x32_bf16 v[60:63], v[172:175], v[116:119], v[60:63]
    ds_read_b64_tr_b16 v[160:161], v202 offset:32768
    ds_read_b64_tr_b16 v[162:163], v202 offset:34816
    v_mfma_f32_16x16x32_bf16 v[52:55], v[172:175], v[112:115], v[52:55]
    ds_read_b64_tr_b16 v[164:165], v203 offset:32768
    ds_read_b64_tr_b16 v[166:167], v203 offset:34816
    v_mfma_f32_16x16x32_bf16 v[64:67], v[176:179], v[112:115], v[64:67]
    buffer_load_dwordx4 v6, s[12:15], s41 offen offset:1024 sc1 lds
    s_add_u32 s41, s41, 8192
    v_mfma_f32_16x16x32_bf16 v[72:75], v[176:179], v[116:119], v[72:75]
    buffer_load_dwordx4 v[88:91], v6, s[8:11], s40 offen offset:0 sc1
    v_mfma_f32_16x16x32_bf16 v[76:79], v[180:183], v[116:119], v[76:79]
    buffer_load_dwordx4 v[92:95], v6, s[8:11], s40 offen offset:1024 sc1
    v_mfma_f32_16x16x32_bf16 v[68:71], v[180:183], v[112:115], v[68:71]
    s_nop 0
    s_waitcnt lgkmcnt(0)
    v_mfma_f32_16x16x32_bf16 v[16:19], v[152:155], v[104:107], v[16:19]
    ds_read_b64_tr_b16 v[168:169], v200 offset:36864
    ds_read_b64_tr_b16 v[170:171], v200 offset:38912
    v_mfma_f32_16x16x32_bf16 v[24:27], v[152:155], v[108:111], v[24:27]
    ds_read_b64_tr_b16 v[172:173], v201 offset:36864
    ds_read_b64_tr_b16 v[174:175], v201 offset:38912
    v_mfma_f32_16x16x32_bf16 v[28:31], v[156:159], v[108:111], v[28:31]
    ds_read_b64_tr_b16 v[176:177], v202 offset:36864
    ds_read_b64_tr_b16 v[178:179], v202 offset:38912
    v_mfma_f32_16x16x32_bf16 v[20:23], v[156:159], v[104:107], v[20:23]
    ds_read_b64_tr_b16 v[180:181], v203 offset:36864
    ds_read_b64_tr_b16 v[182:183], v203 offset:38912
    v_mfma_f32_16x16x32_bf16 v[32:35], v[160:163], v[104:107], v[32:35]
    buffer_load_dwordx4 v[96:99], v6, s[8:11], s40 offen offset:2048 sc1
    v_mfma_f32_16x16x32_bf16 v[40:43], v[160:163], v[108:111], v[40:43]
    buffer_load_dwordx4 v[100:103], v6, s[8:11], s40 offen offset:3072 sc1
    s_add_u32 s40, s40, 4096
    v_mfma_f32_16x16x32_bf16 v[44:47], v[164:167], v[108:111], v[44:47]
    v_mfma_f32_16x16x32_bf16 v[36:39], v[164:167], v[104:107], v[36:39]
    s_waitcnt vmcnt(16) lgkmcnt(0)
    s_barrier
    v_mfma_f32_16x16x32_bf16 v[16:19], v[168:171], v[112:115], v[16:19]
    ds_read_b64_tr_b16 v[152:153], v204 offset:16384
    ds_read_b64_tr_b16 v[154:155], v204 offset:18432
    v_mfma_f32_16x16x32_bf16 v[24:27], v[168:171], v[116:119], v[24:27]
    ds_read_b64_tr_b16 v[156:157], v205 offset:16384
    ds_read_b64_tr_b16 v[158:159], v205 offset:18432
    v_mfma_f32_16x16x32_bf16 v[28:31], v[172:175], v[116:119], v[28:31]
    ds_read_b64_tr_b16 v[160:161], v206 offset:16384
    ds_read_b64_tr_b16 v[162:163], v206 offset:18432
    v_mfma_f32_16x16x32_bf16 v[20:23], v[172:175], v[112:115], v[20:23]
    ds_read_b64_tr_b16 v[164:165], v207 offset:16384
    ds_read_b64_tr_b16 v[166:167], v207 offset:18432
    v_mfma_f32_16x16x32_bf16 v[32:35], v[176:179], v[112:115], v[32:35]
    v_mfma_f32_16x16x32_bf16 v[40:43], v[176:179], v[116:119], v[40:43]
    v_mfma_f32_16x16x32_bf16 v[44:47], v[180:183], v[116:119], v[44:47]
    v_mfma_f32_16x16x32_bf16 v[36:39], v[180:183], v[112:115], v[36:39]
    s_mov_b32 s45, 2
    s_nop 0
k3_loop:
    s_nop 0
    s_waitcnt lgkmcnt(0)
    v_mfma_f32_16x16x32_bf16 v[48:51], v[152:155], v[120:123], v[48:51]
    ds_read_b64_tr_b16 v[168:169], v204 offset:20480
    ds_read_b64_tr_b16 v[170:171], v204 offset:22528
    v_mfma_f32_16x16x32_bf16 v[56:59], v[152:155], v[124:127], v[56:59]
    ds_read_b64_tr_b16 v[172:173], v205 offset:20480
    ds_read_b64_tr_b16 v[174:175], v205 offset:22528
    v_mfma_f32_16x16x32_bf16 v[60:63], v[156:159], v[124:127], v[60:63]
    ds_read_b64_tr_b16 v[176:177], v206 offset:20480
    ds_read_b64_tr_b16 v[178:179], v206 offset:22528
    v_mfma_f32_16x16x32_bf16 v[52:55], v[156:159], v[120:123], v[52:55]
    ds_read_b64_tr_b16 v[180:181], v207 offset:20480
    ds_read_b64_tr_b16 v[182:183], v207 offset:22528
    s_add_u32 m0, s42, 49152
    v_mfma_f32_16x16x32_bf16 v[64:67], v[160:163], v[120:123], v[64:67]
    buffer_load_dwordx4 v6, s[12:15], s48 offen sc1 lds
    v_mfma_f32_16x16x32_bf16 v[72:75], v[160:163], v[124:127], v[72:75]
    buffer_load_dwordx4 v6, s[12:15], s48 offen offset:1024 sc1 lds
    s_add_u32 s48, s48, 8192
    s_add_u32 m0, s42, 32768
    v_mfma_f32_16x16x32_bf16 v[76:79], v[164:167], v[124:127], v[76:79]
    buffer_load_dwordx4 v6, s[12:15], s41 offen sc1 lds
    v_mfma_f32_16x16x32_bf16 v[68:71], v[164:167], v[120:123], v[68:71]
    s_nop 0
    s_waitcnt lgkmcnt(0)
    v_mfma_f32_16x16x32_bf16 v[48:51], v[168:171], v[128:131], v[48:51]
    ds_read_b64_tr_b16 v[152:153], v204 offset:0
    ds_read_b64_tr_b16 v[154:155], v204 offset:2048
    v_mfma_f32_16x16x32_bf16 v[56:59], v[168:171], v[132:135], v[56:59]
    ds_read_b64_tr_b16 v[156:157], v205 offset:0
    ds_read_b64_tr_b16 v[158:159], v205 offset:2048
    v_mfma_f32_16x16x32_bf16 v[60:63], v[172:175], v[132:135], v[60:63]
    ds_read_b64_tr_b16 v[160:161], v206 offset:0
    ds_read_b64_tr_b16 v[162:163], v206 offset:2048
    v_mfma_f32_16x16x32_bf16 v[52:55], v[172:175], v[128:131], v[52:55]
    ds_read_b64_tr_b16 v[164:165], v207 offset:0
    ds_read_b64_tr_b16 v[166:167], v207 offset:2048
    v_mfma_f32_16x16x32_bf16 v[64:67], v[176:179], v[128:131], v[64:67]
    buffer_load_dwordx4 v6, s[12:15], s41 offen offset:1024 sc1 lds
    s_add_u32 s41, s41, 8192
    v_mfma_f32_16x16x32_bf16 v[72:75], v[176:179], v[132:135], v[72:75]
    buffer_load_dwordx4 v[104:107], v6, s[8:11], s40 offen offset:0 sc1
    v_mfma_f32_16x16x32_bf16 v[76:79], v[180:183], v[132:135], v[76:79]
    buffer_load_dwordx4 v[108:111], v6, s[8:11], s40 offen offset:1024 sc1
    v_mfma_f32_16x16x32_bf16 v[68:71], v[180:183], v[128:131], v[68:71]
    s_nop 0
    s_waitcnt lgkmcnt(0)
    v_mfma_f32_16x16x32_bf16 v[16:19], v[152:155], v[120:123], v[16:19]
    ds_read_b64_tr_b16 v[168:169], v204 offset:4096
    ds_read_b64_tr_b16 v[170:171], v204 offset:6144
    v_mfma_f32_16x16x32_bf16 v[24:27], v[152:155], v[124:127], v[24:27]
    ds_read_b64_tr_b16 v[172:173], v205 offset:4096
    ds_read_b64_tr_b16 v[174:175], v205 offset:6144
    v_mfma_f32_16x16x32_bf16 v[28:31], v[156:159], v[124:127], v[28:31]
    ds_read_b64_tr_b16 v[176:177], v206 offset:4096
    ds_read_b64_tr_b16 v[178:179], v206 offset:6144
    v_mfma_f32_16x16x32_bf16 v[20:23], v[156:159], v[120:123], v[20:23]
    ds_read_b64_tr_b16 v[180:181], v207 offset:4096
    ds_read_b64_tr_b16 v[182:183], v207 offset:6144
    v_mfma_f32_16x16x32_bf16 v[32:35], v[160:163], v[120:123], v[32:35]
    buffer_load_dwordx4 v[112:115], v6, s[8:11], s40 offen offset:2048 sc1
    v_mfma_f32_16x16x32_bf16 v[40:43], v[160:163], v[124:127], v[40:43]
    buffer_load_dwordx4 v[116:119], v6, s[8:11], s40 offen offset:3072 sc1
    s_add_u32 s40, s40, 4096
    v_mfma_f32_16x16x32_bf16 v[44:47], v[164:167], v[124:127], v[44:47]
    v_mfma_f32_16x16x32_bf16 v[36:39], v[164:167], v[120:123], v[36:39]
    s_waitcnt vmcnt(16) lgkmcnt(0)
    s_barrier
    v_mfma_f32_16x16x32_bf16 v[16:19], v[168:171], v[128:131], v[16:19]
    ds_read_b64_tr_b16 v[152:153], v204 offset:49152
    ds_read_b64_tr_b16 v[154:155], v204 offset:51200
    v_mfma_f32_16x16x32_bf16 v[24:27], v[168:171], v[132:135], v[24:27]
    ds_read_b64_tr_b16 v[156:157], v205 offset:49152
    ds_read_b64_tr_b16 v[158:159], v205 offset:51200
    v_mfma_f32_16x16x32_bf16 v[28:31], v[172:175], v[132:135], v[28:31]
    ds_read_b64_tr_b16 v[160:161], v206 offset:49152
    ds_read_b64_tr_b16 v[162:163], v206 offset:51200
    v_mfma_f32_16x16x32_bf16 v[20:23], v[172:175], v[128:131], v[20:23]
    ds_read_b64_tr_b16 v[164:165], v207 offset:49152
    ds_read_b64_tr_b16 v[166:167], v207 offset:51200
    v_mfma_f32_16x16x32_bf16 v[32:35], v[176:179], v[128:131], v[32:35]
    v_mfma_f32_16x16x32_bf16 v[40:43], v[176:179], v[132:135], v[40:43]
    v_mfma_f32_16x16x32_bf16 v[44:47], v[180:183], v[132:135], v[44:47]
    v_mfma_f32_16x16x32_bf16 v[36:39], v[180:183], v[128:131], v[36:39]
    s_nop 0
    s_waitcnt lgkmcnt(0)
    v_mfma_f32_16x16x32_bf16 v[48:51], v[152:155], v[136:139], v[48:51]
    ds_read_b64_tr_b16 v[168:169], v204 offset:53248
    ds_read_b64_tr_b16 v[170:171], v204 offset:55296
    v_mfma_f32_16x16x32_bf16 v[56:59], v[152:155], v[140:143], v[56:59]
    ds_read_b64_tr_b16 v[172:173], v205 offset:53248
    ds_read_b64_tr_b16 v[174:175], v205 offset:55296
    v_mfma_f32_16x16x32_bf16 v[60:63], v[156:159], v[140:143], v[60:63]
    ds_read_b64_tr_b16 v[176:177], v206 offset:53248
    ds_read_b64_tr_b16 v[178:179], v206 offset:55296
    v_mfma_f32_16x16x32_bf16 v[52:55], v[156:159], v[136:139], v[52:55]
    ds_read_b64_tr_b16 v[180:181], v207 offset:53248
    ds_read_b64_tr_b16 v[182:183], v207 offset:55296
    s_add_u32 m0, s42, 81920
    v_mfma_f32_16x16x32_bf16 v[64:67], v[160:163], v[136:139], v[64:67]
    buffer_load_dwordx4 v6, s[12:15], s48 offen sc1 lds
    v_mfma_f32_16x16x32_bf16 v[72:75], v[160:163], v[140:143], v[72:75]
    buffer_load_dwordx4 v6, s[12:15], s48 offen offset:1024 sc1 lds
    s_add_u32 s48, s48, 8192
    s_add_u32 m0, s42, 65536
    v_mfma_f32_16x16x32_bf16 v[76:79], v[164:167], v[140:143], v[76:79]
    buffer_load_dwordx4 v6, s[12:15], s41 offen sc1 lds
    v_mfma_f32_16x16x32_bf16 v[68:71], v[164:167], v[136:139], v[68:71]
    s_nop 0
    s_waitcnt lgkmcnt(0)
    v_mfma_f32_16x16x32_bf16 v[48:51], v[168:171], v[144:147], v[48:51]
    ds_read_b64_tr_b16 v[152:153], v204 offset:32768
    ds_read_b64_tr_b16 v[154:155], v204 offset:34816
    v_mfma_f32_16x16x32_bf16 v[56:59], v[168:171], v[148:151], v[56:59]
    ds_read_b64_tr_b16 v[156:157], v205 offset:32768
    ds_read_b64_tr_b16 v[158:159], v205 offset:34816
    v_mfma_f32_16x16x32_bf16 v[60:63], v[172:175], v[148:151], v[60:63]
    ds_read_b64_tr_b16 v[160:161], v206 offset:32768
    ds_read_b64_tr_b16 v[162:163], v206 offset:34816
    v_mfma_f32_16x16x32_bf16 v[52:55], v[172:175], v[144:147], v[52:55]
    ds_read_b64_tr_b16 v[164:165], v207 offset:32768
    ds_read_b64_tr_b16 v[166:167], v207 offset:34816
    v_mfma_f32_16x16x32_bf16 v[64:67], v[176:179], v[144:147], v[64:67]
    buffer_load_dwordx4 v6, s[12:15], s41 offen offset:1024 sc1 lds
    s_add_u32 s41, s41, 8192
    v_mfma_f32_16x16x32_bf16 v[72:75], v[176:179], v[148:151], v[72:75]
    buffer_load_dwordx4 v[120:123], v6, s[8:11], s40 offen offset:0 sc1
    v_mfma_f32_16x16x32_bf16 v[76:79], v[180:183], v[148:151], v[76:79]
    buffer_load_dwordx4 v[124:127], v6, s[8:11], s40 offen offset:1024 sc1
    v_mfma_f32_16x16x32_bf16 v[68:71], v[180:183], v[144:147], v[68:71]
    s_nop 0
    s_waitcnt lgkmcnt(0)
    v_mfma_f32_16x16x32_bf16 v[16:19], v[152:155], v[136:139], v[16:19]
    ds_read_b64_tr_b16 v[168:169], v204 offset:36864
    ds_read_b64_tr_b16 v[170:171], v204 offset:38912
    v_mfma_f32_16x16x32_bf16 v[24:27], v[152:155], v[140:143], v[24:27]
    ds_read_b64_tr_b16 v[172:173], v205 offset:36864
    ds_read_b64_tr_b16 v[174:175], v205 offset:38912
    v_mfma_f32_16x16x32_bf16 v[28:31], v[156:159], v[140:143], v[28:31]
    ds_read_b64_tr_b16 v[176:177], v206 offset:36864
    ds_read_b64_tr_b16 v[178:179], v206 offset:38912
    v_mfma_f32_16x16x32_bf16 v[20:23], v[156:159], v[136:139], v[20:23]
    ds_read_b64_tr_b16 v[180:181], v207 offset:36864
    ds_read_b64_tr_b16 v[182:183], v207 offset:38912
    v_mfma_f32_16x16x32_bf16 v[32:35], v[160:163], v[136:139], v[32:35]
    buffer_load_dwordx4 v[128:131], v6, s[8:11], s40 offen offset:2048 sc1
    v_mfma_f32_16x16x32_bf16 v[40:43], v[160:163], v[140:143], v[40:43]
    buffer_load_dwordx4 v[132:135], v6, s[8:11], s40 offen offset:3072 sc1
    s_add_u32 s40, s40, 4096
    v_mfma_f32_16x16x32_bf16 v[44:47], v[164:167], v[140:143], v[44:47]
    v_mfma_f32_16x16x32_bf16 v[36:39], v[164:167], v[136:139], v[36:39]
    s_waitcnt vmcnt(16) lgkmcnt(0)
    s_barrier
    v_mfma_f32_16x16x32_bf16 v[16:19], v[168:171], v[144:147], v[16:19]
    ds_read_b64_tr_b16 v[152:153], v200 offset:16384
    ds_read_b64_tr_b16 v[154:155], v200 offset:18432
    v_mfma_f32_16x16x32_bf16 v[24:27], v[168:171], v[148:151], v[24:27]
    ds_read_b64_tr_b16 v[156:157], v201 offset:16384
    ds_read_b64_tr_b16 v[158:159], v201 offset:18432
    v_mfma_f32_16x16x32_bf16 v[28:31], v[172:175], v[148:151], v[28:31]
    ds_read_b64_tr_b16 v[160:161], v202 offset:16384
    ds_read_b64_tr_b16 v[162:163], v202 offset:18432
    v_mfma_f32_16x16x32_bf16 v[20:23], v[172:175], v[144:147], v[20:23]
    ds_read_b64_tr_b16 v[164:165], v203 offset:16384
    ds_read_b64_tr_b16 v[166:167], v203 offset:18432
    v_mfma_f32_16x16x32_bf16 v[32:35], v[176:179], v[144:147], v[32:35]
    v_mfma_f32_16x16x32_bf16 v[40:43], v[176:179], v[148:151], v[40:43]
    v_mfma_f32_16x16x32_bf16 v[44:47], v[180:183], v[148:151], v[44:47]
    v_mfma_f32_16x16x32_bf16 v[36:39], v[180:183], v[144:147], v[36:39]
    s_nop 0
    s_waitcnt lgkmcnt(0)
    v_mfma_f32_16x16x32_bf16 v[48:51], v[152:155], v[88:91], v[48:51]
    ds_read_b64_tr_b16 v[168:169], v200 offset:20480
    ds_read_b64_tr_b16 v[170:171], v200 offset:22528
    v_mfma_f32_16x16x32_bf16 v[56:59], v[152:155], v[92:95], v[56:59]
    ds_read_b64_tr_b16 v[172:173], v201 offset:20480
    ds_read_b64_tr_b16 v[174:175], v201 offset:22528
    v_mfma_f32_16x16x32_bf16 v[60:63], v[156:159], v[92:95], v[60:63]
    ds_read_b64_tr_b16 v[176:177], v202 offset:20480
    ds_read_b64_tr_b16 v[178:179], v202 offset:22528
    v_mfma_f32_16x16x32_bf16 v[52:55], v[156:159], v[88:91], v[52:55]
    ds_read_b64_tr_b16 v[180:181], v203 offset:20480
    ds_read_b64_tr_b16 v[182:183], v203 offset:22528
    s_add_u32 m0, s42, 114688
    v_mfma_f32_16x16x32_bf16 v[64:67], v[160:163], v[88:91], v[64:67]
    buffer_load_dwordx4 v6, s[12:15], s48 offen sc1 lds
    v_mfma_f32_16x16x32_bf16 v[72:75], v[160:163], v[92:95], v[72:75]
    buffer_load_dwordx4 v6, s[12:15], s48 offen offset:1024 sc1 lds
    s_add_u32 s48, s48, 8192
    s_add_u32 m0, s42, 98304
    v_mfma_f32_16x16x32_bf16 v[76:79], v[164:167], v[92:95], v[76:79]
    buffer_load_dwordx4 v6, s[12:15], s41 offen sc1 lds
    v_mfma_f32_16x16x32_bf16 v[68:71], v[164:167], v[88:91], v[68:71]
    s_nop 0
    s_waitcnt lgkmcnt(0)
    v_mfma_f32_16x16x32_bf16 v[48:51], v[168:171], v[96:99], v[48:51]
    ds_read_b64_tr_b16 v[152:153], v200 offset:0
    ds_read_b64_tr_b16 v[154:155], v200 offset:2048
    v_mfma_f32_16x16x32_bf16 v[56:59], v[168:171], v[100:103], v[56:59]
    ds_read_b64_tr_b16 v[156:157], v201 offset:0
    ds_read_b64_tr_b16 v[158:159], v201 offset:2048
    v_mfma_f32_16x16x32_bf16 v[60:63], v[172:175], v[100:103], v[60:63]
    ds_read_b64_tr_b16 v[160:161], v202 offset:0
    ds_read_b64_tr_b16 v[162:163], v202 offset:2048
    v_mfma_f32_16x16x32_bf16 v[52:55], v[172:175], v[96:99], v[52:55]
    ds_read_b64_tr_b16 v[164:165], v203 offset:0
    ds_read_b64_tr_b16 v[166:167], v203 offset:2048
    v_mfma_f32_16x16x32_bf16 v[64:67], v[176:179], v[96:99], v[64:67]
    buffer_load_dwordx4 v6, s[12:15], s41 offen offset:1024 sc1 lds
    s_add_u32 s41, s41, 8192
    v_mfma_f32_16x16x32_bf16 v[72:75], v[176:179], v[100:103], v[72:75]
    buffer_load_dwordx4 v[136:139], v6, s[8:11], s40 offen offset:0 sc1
    v_mfma_f32_16x16x32_bf16 v[76:79], v[180:183], v[100:103], v[76:79]
    buffer_load_dwordx4 v[140:143], v6, s[8:11], s40 offen offset:1024 sc1
    v_mfma_f32_16x16x32_bf16 v[68:71], v[180:183], v[96:99], v[68:71]
    s_nop 0
    s_waitcnt lgkmcnt(0)
    v_mfma_f32_16x16x32_bf16 v[16:19], v[152:155], v[88:91], v[16:19]
    ds_read_b64_tr_b16 v[168:169], v200 offset:4096
    ds_read_b64_tr_b16 v[170:171], v200 offset:6144
    v_mfma_f32_16x16x32_bf16 v[24:27], v[152:155], v[92:95], v[24:27]
    ds_read_b64_tr_b16 v[172:173], v201 offset:4096
    ds_read_b64_tr_b16 v[174:175], v201 offset:6144
    v_mfma_f32_16x16x32_bf16 v[28:31], v[156:159], v[92:95], v[28:31]
    ds_read_b64_tr_b16 v[176:177], v202 offset:4096
    ds_read_b64_tr_b16 v[178:179], v202 offset:6144
    v_mfma_f32_16x16x32_bf16 v[20:23], v[156:159], v[88:91], v[20:23]
    ds_read_b64_tr_b16 v[180:181], v203 offset:4096
    ds_read_b64_tr_b16 v[182:183], v203 offset:6144
    v_mfma_f32_16x16x32_bf16 v[32:35], v[160:163], v[88:91], v[32:35]
    buffer_load_dwordx4 v[144:147], v6, s[8:11], s40 offen offset:2048 sc1
    v_mfma_f32_16x16x32_bf16 v[40:43], v[160:163], v[92:95], v[40:43]
    buffer_load_dwordx4 v[148:151], v6, s[8:11], s40 offen offset:3072 sc1
    s_add_u32 s40, s40, 4096
    v_mfma_f32_16x16x32_bf16 v[44:47], v[164:167], v[92:95], v[44:47]
    v_mfma_f32_16x16x32_bf16 v[36:39], v[164:167], v[88:91], v[36:39]
    s_waitcnt vmcnt(16) lgkmcnt(0)
    s_barrier
    v_mfma_f32_16x16x32_bf16 v[16:19], v[168:171], v[96:99], v[16:19]
    ds_read_b64_tr_b16 v[152:153], v200 offset:49152
    ds_read_b64_tr_b16 v[154:155], v200 offset:51200
    v_mfma_f32_16x16x32_bf16 v[24:27], v[168:171], v[100:103], v[24:27]
    ds_read_b64_tr_b16 v[156:157], v201 offset:49152
    ds_read_b64_tr_b16 v[158:159], v201 offset:51200
    v_mfma_f32_16x16x32_bf16 v[28:31], v[172:175], v[100:103], v[28:31]
    ds_read_b64_tr_b16 v[160:161], v202 offset:49152
    ds_read_b64_tr_b16 v[162:163], v202 offset:51200
    v_mfma_f32_16x16x32_bf16 v[20:23], v[172:175], v[96:99], v[20:23]
    ds_read_b64_tr_b16 v[164:165], v203 offset:49152
    ds_read_b64_tr_b16 v[166:167], v203 offset:51200
    v_mfma_f32_16x16x32_bf16 v[32:35], v[176:179], v[96:99], v[32:35]
    v_mfma_f32_16x16x32_bf16 v[40:43], v[176:179], v[100:103], v[40:43]
    v_mfma_f32_16x16x32_bf16 v[44:47], v[180:183], v[100:103], v[44:47]
    v_mfma_f32_16x16x32_bf16 v[36:39], v[180:183], v[96:99], v[36:39]
    s_nop 0
    s_waitcnt lgkmcnt(0)
    v_mfma_f32_16x16x32_bf16 v[48:51], v[152:155], v[104:107], v[48:51]
    ds_read_b64_tr_b16 v[168:169], v200 offset:53248
    ds_read_b64_tr_b16 v[170:171], v200 offset:55296
    v_mfma_f32_16x16x32_bf16 v[56:59], v[152:155], v[108:111], v[56:59]
    ds_read_b64_tr_b16 v[172:173], v201 offset:53248
    ds_read_b64_tr_b16 v[174:175], v201 offset:55296
    v_mfma_f32_16x16x32_bf16 v[60:63], v[156:159], v[108:111], v[60:63]
    ds_read_b64_tr_b16 v[176:177], v202 offset:53248
    ds_read_b64_tr_b16 v[178:179], v202 offset:55296
    v_mfma_f32_16x16x32_bf16 v[52:55], v[156:159], v[104:107], v[52:55]
    ds_read_b64_tr_b16 v[180:181], v203 offset:53248
    ds_read_b64_tr_b16 v[182:183], v203 offset:55296
    s_add_u32 m0, s42, 16384
    v_mfma_f32_16x16x32_bf16 v[64:67], v[160:163], v[104:107], v[64:67]
    buffer_load_dwordx4 v6, s[12:15], s48 offen sc1 lds
    v_mfma_f32_16x16x32_bf16 v[72:75], v[160:163], v[108:111], v[72:75]
    buffer_load_dwordx4 v6, s[12:15], s48 offen offset:1024 sc1 lds
    s_add_u32 s48, s48, 8192
    s_add_u32 m0, s42, 0
    s_nop 0
    v_mfma_f32_16x16x32_bf16 v[76:79], v[164:167], v[108:111], v[76:79]
    buffer_load_dwordx4 v6, s[12:15], s41 offen sc1 lds
    v_mfma_f32_16x16x32_bf16 v[68:71], v[164:167], v[104:107], v[68:71]
    s_nop 0
    s_waitcnt lgkmcnt(0)
    v_mfma_f32_16x16x32_bf16 v[48:51], v[168:171], v[112:115], v[48:51]
    ds_read_b64_tr_b16 v[152:153], v200 offset:32768
    ds_read_b64_tr_b16 v[154:155], v200 offset:34816
    v_mfma_f32_16x16x32_bf16 v[56:59], v[168:171], v[116:119], v[56:59]
    ds_read_b64_tr_b16 v[156:157], v201 offset:32768
    ds_read_b64_tr_b16 v[158:159], v201 offset:34816
    v_mfma_f32_16x16x32_bf16 v[60:63], v[172:175], v[116:119], v[60:63]
    ds_read_b64_tr_b16 v[160:161], v202 offset:32768
    ds_read_b64_tr_b16 v[162:163], v202 offset:34816
    v_mfma_f32_16x16x32_bf16 v[52:55], v[172:175], v[112:115], v[52:55]
    ds_read_b64_tr_b16 v[164:165], v203 offset:32768
    ds_read_b64_tr_b16 v[166:167], v203 offset:34816
    v_mfma_f32_16x16x32_bf16 v[64:67], v[176:179], v[112:115], v[64:67]
    buffer_load_dwordx4 v6, s[12:15], s41 offen offset:1024 sc1 lds
    s_add_u32 s41, s41, 8192
    v_mfma_f32_16x16x32_bf16 v[72:75], v[176:179], v[116:119], v[72:75]
    buffer_load_dwordx4 v[88:91], v6, s[8:11], s40 offen offset:0 sc1
    v_mfma_f32_16x16x32_bf16 v[76:79], v[180:183], v[116:119], v[76:79]
    buffer_load_dwordx4 v[92:95], v6, s[8:11], s40 offen offset:1024 sc1
    v_mfma_f32_16x16x32_bf16 v[68:71], v[180:183], v[112:115], v[68:71]
    s_nop 0
    s_waitcnt lgkmcnt(0)
    v_mfma_f32_16x16x32_bf16 v[16:19], v[152:155], v[104:107], v[16:19]
    ds_read_b64_tr_b16 v[168:169], v200 offset:36864
    ds_read_b64_tr_b16 v[170:171], v200 offset:38912
    v_mfma_f32_16x16x32_bf16 v[24:27], v[152:155], v[108:111], v[24:27]
    ds_read_b64_tr_b16 v[172:173], v201 offset:36864
    ds_read_b64_tr_b16 v[174:175], v201 offset:38912
    v_mfma_f32_16x16x32_bf16 v[28:31], v[156:159], v[108:111], v[28:31]
    ds_read_b64_tr_b16 v[176:177], v202 offset:36864
    ds_read_b64_tr_b16 v[178:179], v202 offset:38912
    v_mfma_f32_16x16x32_bf16 v[20:23], v[156:159], v[104:107], v[20:23]
    ds_read_b64_tr_b16 v[180:181], v203 offset:36864
    ds_read_b64_tr_b16 v[182:183], v203 offset:38912
    v_mfma_f32_16x16x32_bf16 v[32:35], v[160:163], v[104:107], v[32:35]
    buffer_load_dwordx4 v[96:99], v6, s[8:11], s40 offen offset:2048 sc1
    v_mfma_f32_16x16x32_bf16 v[40:43], v[160:163], v[108:111], v[40:43]
    buffer_load_dwordx4 v[100:103], v6, s[8:11], s40 offen offset:3072 sc1
    s_add_u32 s40, s40, 4096
    v_mfma_f32_16x16x32_bf16 v[44:47], v[164:167], v[108:111], v[44:47]
    v_mfma_f32_16x16x32_bf16 v[36:39], v[164:167], v[104:107], v[36:39]
    s_waitcnt vmcnt(16) lgkmcnt(0)
    s_barrier
    v_mfma_f32_16x16x32_bf16 v[16:19], v[168:171], v[112:115], v[16:19]
    ds_read_b64_tr_b16 v[152:153], v204 offset:16384
    ds_read_b64_tr_b16 v[154:155], v204 offset:18432
    v_mfma_f32_16x16x32_bf16 v[24:27], v[168:171], v[116:119], v[24:27]
    ds_read_b64_tr_b16 v[156:157], v205 offset:16384
    ds_read_b64_tr_b16 v[158:159], v205 offset:18432
    v_mfma_f32_16x16x32_bf16 v[28:31], v[172:175], v[116:119], v[28:31]
    ds_read_b64_tr_b16 v[160:161], v206 offset:16384
    ds_read_b64_tr_b16 v[162:163], v206 offset:18432
    v_mfma_f32_16x16x32_bf16 v[20:23], v[172:175], v[112:115], v[20:23]
    ds_read_b64_tr_b16 v[164:165], v207 offset:16384
    ds_read_b64_tr_b16 v[166:167], v207 offset:18432
    v_mfma_f32_16x16x32_bf16 v[32:35], v[176:179], v[112:115], v[32:35]
    v_mfma_f32_16x16x32_bf16 v[40:43], v[176:179], v[116:119], v[40:43]
    v_mfma_f32_16x16x32_bf16 v[44:47], v[180:183], v[116:119], v[44:47]
    v_mfma_f32_16x16x32_bf16 v[36:39], v[180:183], v[112:115], v[36:39]
    s_sub_u32 s45, s45, 1
    s_cmp_lg_u32 s45, 0
    s_cbranch_scc1 k3_loop
    s_waitcnt lgkmcnt(0)
    v_mfma_f32_16x16x32_bf16 v[48:51], v[152:155], v[120:123], v[48:51]
    ds_read_b64_tr_b16 v[168:169], v204 offset:20480
    ds_read_b64_tr_b16 v[170:171], v204 offset:22528
    v_mfma_f32_16x16x32_bf16 v[56:59], v[152:155], v[124:127], v[56:59]
    ds_read_b64_tr_b16 v[172:173], v205 offset:20480
    ds_read_b64_tr_b16 v[174:175], v205 offset:22528
    v_mfma_f32_16x16x32_bf16 v[60:63], v[156:159], v[124:127], v[60:63]
    ds_read_b64_tr_b16 v[176:177], v206 offset:20480
    ds_read_b64_tr_b16 v[178:179], v206 offset:22528
    v_mfma_f32_16x16x32_bf16 v[52:55], v[156:159], v[120:123], v[52:55]
    ds_read_b64_tr_b16 v[180:181], v207 offset:20480
    ds_read_b64_tr_b16 v[182:183], v207 offset:22528
    s_add_u32 m0, s42, 49152
    v_mfma_f32_16x16x32_bf16 v[64:67], v[160:163], v[120:123], v[64:67]
    buffer_load_dwordx4 v6, s[12:15], s48 offen sc1 lds
    v_mfma_f32_16x16x32_bf16 v[72:75], v[160:163], v[124:127], v[72:75]
    buffer_load_dwordx4 v6, s[12:15], s48 offen offset:1024 sc1 lds
    s_add_u32 s48, s48, 8192
    s_add_u32 m0, s42, 32768
    v_mfma_f32_16x16x32_bf16 v[76:79], v[164:167], v[124:127], v[76:79]
    buffer_load_dwordx4 v6, s[12:15], s41 offen sc1 lds
    v_mfma_f32_16x16x32_bf16 v[68:71], v[164:167], v[120:123], v[68:71]
    s_nop 0
    s_waitcnt lgkmcnt(0)
    v_mfma_f32_16x16x32_bf16 v[48:51], v[168:171], v[128:131], v[48:51]
    ds_read_b64_tr_b16 v[152:153], v204 offset:0
    ds_read_b64_tr_b16 v[154:155], v204 offset:2048
    v_mfma_f32_16x16x32_bf16 v[56:59], v[168:171], v[132:135], v[56:59]
    ds_read_b64_tr_b16 v[156:157], v205 offset:0
    ds_read_b64_tr_b16 v[158:159], v205 offset:2048
    v_mfma_f32_16x16x32_bf16 v[60:63], v[172:175], v[132:135], v[60:63]
    ds_read_b64_tr_b16 v[160:161], v206 offset:0
    ds_read_b64_tr_b16 v[162:163], v206 offset:2048
    v_mfma_f32_16x16x32_bf16 v[52:55], v[172:175], v[128:131], v[52:55]
    ds_read_b64_tr_b16 v[164:165], v207 offset:0
    ds_read_b64_tr_b16 v[166:167], v207 offset:2048
    v_mfma_f32_16x16x32_bf16 v[64:67], v[176:179], v[128:131], v[64:67]
    buffer_load_dwordx4 v6, s[12:15], s41 offen offset:1024 sc1 lds
    s_add_u32 s41, s41, 8192
    v_mfma_f32_16x16x32_bf16 v[72:75], v[176:179], v[132:135], v[72:75]
    buffer_load_dwordx4 v[104:107], v6, s[8:11], s40 offen offset:0 sc1
    v_mfma_f32_16x16x32_bf16 v[76:79], v[180:183], v[132:135], v[76:79]
    buffer_load_dwordx4 v[108:111], v6, s[8:11], s40 offen offset:1024 sc1
    v_mfma_f32_16x16x32_bf16 v[68:71], v[180:183], v[128:131], v[68:71]
    s_nop 0
    s_waitcnt lgkmcnt(0)
    v_mfma_f32_16x16x32_bf16 v[16:19], v[152:155], v[120:123], v[16:19]
    ds_read_b64_tr_b16 v[168:169], v204 offset:4096
    ds_read_b64_tr_b16 v[170:171], v204 offset:6144
    v_mfma_f32_16x16x32_bf16 v[24:27], v[152:155], v[124:127], v[24:27]
    ds_read_b64_tr_b16 v[172:173], v205 offset:4096
    ds_read_b64_tr_b16 v[174:175], v205 offset:6144
    v_mfma_f32_16x16x32_bf16 v[28:31], v[156:159], v[124:127], v[28:31]
    ds_read_b64_tr_b16 v[176:177], v206 offset:4096
    ds_read_b64_tr_b16 v[178:179], v206 offset:6144
    v_mfma_f32_16x16x32_bf16 v[20:23], v[156:159], v[120:123], v[20:23]
    ds_read_b64_tr_b16 v[180:181], v207 offset:4096
    ds_read_b64_tr_b16 v[182:183], v207 offset:6144
    v_mfma_f32_16x16x32_bf16 v[32:35], v[160:163], v[120:123], v[32:35]
    buffer_load_dwordx4 v[112:115], v6, s[8:11], s40 offen offset:2048 sc1
    v_mfma_f32_16x16x32_bf16 v[40:43], v[160:163], v[124:127], v[40:43]
    buffer_load_dwordx4 v[116:119], v6, s[8:11], s40 offen offset:3072 sc1
    s_add_u32 s40, s40, 4096
    v_mfma_f32_16x16x32_bf16 v[44:47], v[164:167], v[124:127], v[44:47]
    v_mfma_f32_16x16x32_bf16 v[36:39], v[164:167], v[120:123], v[36:39]
    s_waitcnt vmcnt(16) lgkmcnt(0)
    s_barrier
    v_mfma_f32_16x16x32_bf16 v[16:19], v[168:171], v[128:131], v[16:19]
    ds_read_b64_tr_b16 v[152:153], v204 offset:49152
    ds_read_b64_tr_b16 v[154:155], v204 offset:51200
    v_mfma_f32_16x16x32_bf16 v[24:27], v[168:171], v[132:135], v[24:27]
    ds_read_b64_tr_b16 v[156:157], v205 offset:49152
    ds_read_b64_tr_b16 v[158:159], v205 offset:51200
    v_mfma_f32_16x16x32_bf16 v[28:31], v[172:175], v[132:135], v[28:31]
    ds_read_b64_tr_b16 v[160:161], v206 offset:49152
    ds_read_b64_tr_b16 v[162:163], v206 offset:51200
    v_mfma_f32_16x16x32_bf16 v[20:23], v[172:175], v[128:131], v[20:23]
    ds_read_b64_tr_b16 v[164:165], v207 offset:49152
    ds_read_b64_tr_b16 v[166:167], v207 offset:51200
    v_mfma_f32_16x16x32_bf16 v[32:35], v[176:179], v[128:131], v[32:35]
    v_mfma_f32_16x16x32_bf16 v[40:43], v[176:179], v[132:135], v[40:43]
    v_mfma_f32_16x16x32_bf16 v[44:47], v[180:183], v[132:135], v[44:47]
    v_mfma_f32_16x16x32_bf16 v[36:39], v[180:183], v[128:131], v[36:39]
    s_nop 0
    s_waitcnt lgkmcnt(0)
    v_mfma_f32_16x16x32_bf16 v[48:51], v[152:155], v[136:139], v[48:51]
    ds_read_b64_tr_b16 v[168:169], v204 offset:53248
    ds_read_b64_tr_b16 v[170:171], v204 offset:55296
    v_mfma_f32_16x16x32_bf16 v[56:59], v[152:155], v[140:143], v[56:59]
    ds_read_b64_tr_b16 v[172:173], v205 offset:53248
    ds_read_b64_tr_b16 v[174:175], v205 offset:55296
    v_mfma_f32_16x16x32_bf16 v[60:63], v[156:159], v[140:143], v[60:63]
    ds_read_b64_tr_b16 v[176:177], v206 offset:53248
    ds_read_b64_tr_b16 v[178:179], v206 offset:55296
    v_mfma_f32_16x16x32_bf16 v[52:55], v[156:159], v[136:139], v[52:55]
    ds_read_b64_tr_b16 v[180:181], v207 offset:53248
    ds_read_b64_tr_b16 v[182:183], v207 offset:55296
    s_add_u32 m0, s42, 131072
    v_mfma_f32_16x16x32_bf16 v[64:67], v[160:163], v[136:139], v[64:67]
    buffer_load_dwordx4 v2, s[16:19], s33 offen sc1 lds
    v_mfma_f32_16x16x32_bf16 v[72:75], v[160:163], v[140:143], v[72:75]
    buffer_load_dwordx4 v5, s[16:19], s33 offen offset:1024 sc1 lds
    v_mfma_f32_16x16x32_bf16 v[76:79], v[164:167], v[140:143], v[76:79]
    buffer_load_dwordx4 v[80:83], v7, s[20:23], 0 offen
    v_mfma_f32_16x16x32_bf16 v[68:71], v[164:167], v[136:139], v[68:71]
    buffer_load_dwordx4 v[84:87], v7, s[20:23], s46 offen
    s_waitcnt vmcnt(12) lgkmcnt(0)
    s_barrier
    v_mfma_f32_16x16x32_bf16 v[48:51], v[168:171], v[144:147], v[48:51]
    ds_read_b64_tr_b16 v[152:153], v200 offset:16384
    ds_read_b64_tr_b16 v[154:155], v200 offset:18432
    v_mfma_f32_16x16x32_bf16 v[56:59], v[168:171], v[148:151], v[56:59]
    ds_read_b64_tr_b16 v[156:157], v201 offset:16384
    ds_read_b64_tr_b16 v[158:159], v201 offset:18432
    v_mfma_f32_16x16x32_bf16 v[60:63], v[172:175], v[148:151], v[60:63]
    ds_read_b64_tr_b16 v[160:161], v202 offset:16384
    ds_read_b64_tr_b16 v[162:163], v202 offset:18432
    v_mfma_f32_16x16x32_bf16 v[52:55], v[172:175], v[144:147], v[52:55]
    ds_read_b64_tr_b16 v[164:165], v203 offset:16384
    ds_read_b64_tr_b16 v[166:167], v203 offset:18432
    v_mfma_f32_16x16x32_bf16 v[64:67], v[176:179], v[144:147], v[64:67]
    v_mfma_f32_16x16x32_bf16 v[72:75], v[176:179], v[148:151], v[72:75]
    v_mfma_f32_16x16x32_bf16 v[76:79], v[180:183], v[148:151], v[76:79]
    v_mfma_f32_16x16x32_bf16 v[68:71], v[180:183], v[144:147], v[68:71]
    s_nop 0
    s_waitcnt lgkmcnt(0)
    v_mfma_f32_16x16x32_bf16 v[48:51], v[152:155], v[88:91], v[48:51]
    ds_read_b64_tr_b16 v[168:169], v200 offset:20480
    ds_read_b64_tr_b16 v[170:171], v200 offset:22528
    v_mfma_f32_16x16x32_bf16 v[56:59], v[152:155], v[92:95], v[56:59]
    ds_read_b64_tr_b16 v[172:173], v201 offset:20480
    ds_read_b64_tr_b16 v[174:175], v201 offset:22528
    v_mfma_f32_16x16x32_bf16 v[60:63], v[156:159], v[92:95], v[60:63]
    ds_read_b64_tr_b16 v[176:177], v202 offset:20480
    ds_read_b64_tr_b16 v[178:179], v202 offset:22528
    v_mfma_f32_16x16x32_bf16 v[52:55], v[156:159], v[88:91], v[52:55]
    ds_read_b64_tr_b16 v[180:181], v203 offset:20480
    ds_read_b64_tr_b16 v[182:183], v203 offset:22528
    v_mfma_f32_16x16x32_bf16 v[64:67], v[160:163], v[88:91], v[64:67]
    v_mfma_f32_16x16x32_bf16 v[72:75], v[160:163], v[92:95], v[72:75]
    v_mfma_f32_16x16x32_bf16 v[76:79], v[164:167], v[92:95], v[76:79]
    v_mfma_f32_16x16x32_bf16 v[68:71], v[164:167], v[88:91], v[68:71]
    s_waitcnt vmcnt(4) lgkmcnt(0)
    s_barrier
    v_mfma_f32_16x16x32_bf16 v[48:51], v[168:171], v[96:99], v[48:51]
    ds_read_b64_tr_b16 v[152:153], v200 offset:49152
    ds_read_b64_tr_b16 v[154:155], v200 offset:51200
    v_mfma_f32_16x16x32_bf16 v[56:59], v[168:171], v[100:103], v[56:59]
    ds_read_b64_tr_b16 v[156:157], v201 offset:49152
    ds_read_b64_tr_b16 v[158:159], v201 offset:51200
    v_mfma_f32_16x16x32_bf16 v[60:63], v[172:175], v[100:103], v[60:63]
    ds_read_b64_tr_b16 v[160:161], v202 offset:49152
    ds_read_b64_tr_b16 v[162:163], v202 offset:51200
    v_mfma_f32_16x16x32_bf16 v[52:55], v[172:175], v[96:99], v[52:55]
    ds_read_b64_tr_b16 v[164:165], v203 offset:49152
    ds_read_b64_tr_b16 v[166:167], v203 offset:51200
    v_mfma_f32_16x16x32_bf16 v[64:67], v[176:179], v[96:99], v[64:67]
    v_mfma_f32_16x16x32_bf16 v[72:75], v[176:179], v[100:103], v[72:75]
    v_mfma_f32_16x16x32_bf16 v[76:79], v[180:183], v[100:103], v[76:79]
    v_mfma_f32_16x16x32_bf16 v[68:71], v[180:183], v[96:99], v[68:71]
    s_nop 0
    s_waitcnt lgkmcnt(0)
    v_mfma_f32_16x16x32_bf16 v[48:51], v[152:155], v[104:107], v[48:51]
    ds_read_b64_tr_b16 v[168:169], v200 offset:53248
    ds_read_b64_tr_b16 v[170:171], v200 offset:55296
    v_mfma_f32_16x16x32_bf16 v[56:59], v[152:155], v[108:111], v[56:59]
    ds_read_b64_tr_b16 v[172:173], v201 offset:53248
    ds_read_b64_tr_b16 v[174:175], v201 offset:55296
    v_mfma_f32_16x16x32_bf16 v[60:63], v[156:159], v[108:111], v[60:63]
    ds_read_b64_tr_b16 v[176:177], v202 offset:53248
    ds_read_b64_tr_b16 v[178:179], v202 offset:55296
    v_mfma_f32_16x16x32_bf16 v[52:55], v[156:159], v[104:107], v[52:55]
    ds_read_b64_tr_b16 v[180:181], v203 offset:53248
    ds_read_b64_tr_b16 v[182:183], v203 offset:55296
    v_mfma_f32_16x16x32_bf16 v[64:67], v[160:163], v[104:107], v[64:67]
    v_mfma_f32_16x16x32_bf16 v[72:75], v[160:163], v[108:111], v[72:75]
    v_mfma_f32_16x16x32_bf16 v[76:79], v[164:167], v[108:111], v[76:79]
    v_mfma_f32_16x16x32_bf16 v[68:71], v[164:167], v[104:107], v[68:71]
    s_nop 0
    s_waitcnt lgkmcnt(0)
    v_mfma_f32_16x16x32_bf16 v[48:51], v[168:171], v[112:115], v[48:51]
    ds_read_b64_tr_b16 v[152:153], v204 offset:32768
    ds_read_b64_tr_b16 v[154:155], v204 offset:34816
    v_mfma_f32_16x16x32_bf16 v[56:59], v[168:171], v[116:119], v[56:59]
    ds_read_b64_tr_b16 v[156:157], v205 offset:32768
    ds_read_b64_tr_b16 v[158:159], v205 offset:34816
    v_mfma_f32_16x16x32_bf16 v[60:63], v[172:175], v[116:119], v[60:63]
    ds_read_b64_tr_b16 v[160:161], v206 offset:32768
    ds_read_b64_tr_b16 v[162:163], v206 offset:34816
    v_mfma_f32_16x16x32_bf16 v[52:55], v[172:175], v[112:115], v[52:55]
    ds_read_b64_tr_b16 v[164:165], v207 offset:32768
    ds_read_b64_tr_b16 v[166:167], v207 offset:34816
    v_mfma_f32_16x16x32_bf16 v[64:67], v[176:179], v[112:115], v[64:67]
    v_mfma_f32_16x16x32_bf16 v[72:75], v[176:179], v[116:119], v[72:75]
    v_mfma_f32_16x16x32_bf16 v[76:79], v[180:183], v[116:119], v[76:79]
    v_mfma_f32_16x16x32_bf16 v[68:71], v[180:183], v[112:115], v[68:71]
    s_nop 0
    s_waitcnt lgkmcnt(0)
    v_mfma_f32_16x16x32_bf16 v[16:19], v[152:155], v[136:139], v[16:19]
    ds_read_b64_tr_b16 v[168:169], v204 offset:36864
    ds_read_b64_tr_b16 v[170:171], v204 offset:38912
    v_mfma_f32_16x16x32_bf16 v[24:27], v[152:155], v[140:143], v[24:27]
    ds_read_b64_tr_b16 v[172:173], v205 offset:36864
    ds_read_b64_tr_b16 v[174:175], v205 offset:38912
    v_mfma_f32_16x16x32_bf16 v[28:31], v[156:159], v[140:143], v[28:31]
    ds_read_b64_tr_b16 v[176:177], v206 offset:36864
    ds_read_b64_tr_b16 v[178:179], v206 offset:38912
    v_mfma_f32_16x16x32_bf16 v[20:23], v[156:159], v[136:139], v[20:23]
    ds_read_b64_tr_b16 v[180:181], v207 offset:36864
    ds_read_b64_tr_b16 v[182:183], v207 offset:38912
    v_mfma_f32_16x16x32_bf16 v[32:35], v[160:163], v[136:139], v[32:35]
    ds_write_b128 v11, v[64:67] offset:0
    v_mfma_f32_16x16x32_bf16 v[40:43], v[160:163], v[140:143], v[40:43]
    ds_write_b128 v11, v[68:71] offset:1024
    v_mfma_f32_16x16x32_bf16 v[44:47], v[164:167], v[140:143], v[44:47]
    ds_write_b128 v11, v[72:75] offset:2048
    v_mfma_f32_16x16x32_bf16 v[36:39], v[164:167], v[136:139], v[36:39]
    ds_write_b128 v11, v[76:79] offset:3072
    s_waitcnt vmcnt(0) lgkmcnt(0)
    s_barrier
    v_mfma_f32_16x16x32_bf16 v[16:19], v[168:171], v[144:147], v[16:19]
    ds_read_b128 v[64:67], v12 offset:0
    ds_read_b128 v[68:71], v12 offset:1024
    v_mfma_f32_16x16x32_bf16 v[24:27], v[168:171], v[148:151], v[24:27]
    ds_read_b128 v[72:75], v12 offset:2048
    ds_read_b128 v[76:79], v12 offset:3072
    v_mfma_f32_16x16x32_bf16 v[28:31], v[172:175], v[148:151], v[28:31]
    ds_read_b64_tr_b16 v[152:153], v200 offset:0
    ds_read_b64_tr_b16 v[154:155], v200 offset:2048
    v_mfma_f32_16x16x32_bf16 v[20:23], v[172:175], v[144:147], v[20:23]
    ds_read_b64_tr_b16 v[156:157], v201 offset:0
    ds_read_b64_tr_b16 v[158:159], v201 offset:2048
    v_mfma_f32_16x16x32_bf16 v[32:35], v[176:179], v[144:147], v[32:35]
    ds_read_b64_tr_b16 v[160:161], v202 offset:0
    ds_read_b64_tr_b16 v[162:163], v202 offset:2048
    v_mfma_f32_16x16x32_bf16 v[40:43], v[176:179], v[148:151], v[40:43]
    ds_read_b64_tr_b16 v[164:165], v203 offset:0
    ds_read_b64_tr_b16 v[166:167], v203 offset:2048
    v_mfma_f32_16x16x32_bf16 v[44:47], v[180:183], v[148:151], v[44:47]
    v_mfma_f32_16x16x32_bf16 v[36:39], v[180:183], v[144:147], v[36:39]
    s_nop 0
    s_waitcnt lgkmcnt(0)
    v_mfma_f32_16x16x32_bf16 v[16:19], v[152:155], v[88:91], v[16:19]
    ds_read_b64_tr_b16 v[168:169], v200 offset:4096
    ds_read_b64_tr_b16 v[170:171], v200 offset:6144
    v_add_f32 v48, v48, v64
    v_add_f32 v49, v49, v65
    v_add_f32 v50, v50, v66
    v_add_f32 v51, v51, v67
    v_mfma_f32_16x16x32_bf16 v[24:27], v[152:155], v[92:95], v[24:27]
    ds_read_b64_tr_b16 v[172:173], v201 offset:4096
    ds_read_b64_tr_b16 v[174:175], v201 offset:6144
    v_add_f32 v52, v52, v68
    v_add_f32 v53, v53, v69
    v_add_f32 v54, v54, v70
    v_add_f32 v55, v55, v71
    v_mfma_f32_16x16x32_bf16 v[28:31], v[156:159], v[92:95], v[28:31]
    ds_read_b64_tr_b16 v[176:177], v202 offset:4096
    ds_read_b64_tr_b16 v[178:179], v202 offset:6144
    v_mul_f32_e64 v48, s56, v48
    v_cmp_lt_f32 vcc, |v48|, v15
    v_cvt_pk_bf16_f32 v65, v50, v51
    s_nop 0
    v_cndmask_b32 v48, v48, v15, vcc
    v_mfma_f32_16x16x32_bf16 v[20:23], v[156:159], v[88:91], v[20:23]
    ds_read_b64_tr_b16 v[180:181], v203 offset:4096
    ds_read_b64_tr_b16 v[182:183], v203 offset:6144
    v_cvt_pk_bf16_f32 v66, v52, v53
    v_cvt_pk_bf16_f32 v67, v54, v55
    v_cvt_pk_bf16_f32 v64, v48, v49
    buffer_store_dwordx4 v[64:67], v6, s[52:55], s50 offen offset:0 sc1
    v_mfma_f32_16x16x32_bf16 v[32:35], v[160:163], v[88:91], v[32:35]
    v_add_f32 v56, v56, v72
    v_add_f32 v57, v57, v73
    v_add_f32 v58, v58, v74
    v_add_f32 v59, v59, v75
    v_mfma_f32_16x16x32_bf16 v[40:43], v[160:163], v[92:95], v[40:43]
    v_add_f32 v60, v60, v76
    v_add_f32 v61, v61, v77
    v_add_f32 v62, v62, v78
    v_add_f32 v63, v63, v79
    v_mfma_f32_16x16x32_bf16 v[44:47], v[164:167], v[92:95], v[44:47]
    v_mul_f32_e64 v56, s56, v56
    v_cmp_lt_f32 vcc, |v56|, v15
    v_cvt_pk_bf16_f32 v73, v58, v59
    s_nop 0
    v_cndmask_b32 v56, v56, v15, vcc
    v_mfma_f32_16x16x32_bf16 v[36:39], v[164:167], v[88:91], v[36:39]
    v_cvt_pk_bf16_f32 v74, v60, v61
    v_cvt_pk_bf16_f32 v75, v62, v63
    v_cvt_pk_bf16_f32 v72, v56, v57
    buffer_store_dwordx4 v[72:75], v6, s[52:55], s50 offen offset:1024 sc1
    s_nop 0
    s_waitcnt lgkmcnt(0)
    v_mfma_f32_16x16x32_bf16 v[16:19], v[168:171], v[96:99], v[16:19]
    ds_read_b64_tr_b16 v[152:153], v200 offset:32768
    ds_read_b64_tr_b16 v[154:155], v200 offset:34816
    v_mfma_f32_16x16x32_bf16 v[24:27], v[168:171], v[100:103], v[24:27]
    ds_read_b64_tr_b16 v[156:157], v201 offset:32768
    ds_read_b64_tr_b16 v[158:159], v201 offset:34816
    v_mfma_f32_16x16x32_bf16 v[28:31], v[172:175], v[100:103], v[28:31]
    ds_read_b64_tr_b16 v[160:161], v202 offset:32768
    ds_read_b64_tr_b16 v[162:163], v202 offset:34816
    v_mfma_f32_16x16x32_bf16 v[20:23], v[172:175], v[96:99], v[20:23]
    ds_read_b64_tr_b16 v[164:165], v203 offset:32768
    ds_read_b64_tr_b16 v[166:167], v203 offset:34816
    v_mfma_f32_16x16x32_bf16 v[32:35], v[176:179], v[96:99], v[32:35]
    ds_read_b64_tr_b16 v[136:137], v1 offset:0
    ds_read_b64_tr_b16 v[138:139], v1 offset:2048
    v_mfma_f32_16x16x32_bf16 v[40:43], v[176:179], v[100:103], v[40:43]
    ds_read_b64_tr_b16 v[140:141], v1 offset:4096
    ds_read_b64_tr_b16 v[142:143], v1 offset:6144
    v_mfma_f32_16x16x32_bf16 v[44:47], v[180:183], v[100:103], v[44:47]
    ds_read_b64_tr_b16 v[144:145], v10 offset:0
    ds_read_b64_tr_b16 v[146:147], v10 offset:2048
    v_mfma_f32_16x16x32_bf16 v[36:39], v[180:183], v[96:99], v[36:39]
    ds_read_b64_tr_b16 v[148:149], v10 offset:4096
    ds_read_b64_tr_b16 v[150:151], v10 offset:6144
    s_nop 0
    s_waitcnt lgkmcnt(0)
    v_mfma_f32_16x16x32_bf16 v[32:35], v[160:163], v[104:107], v[32:35]
    ds_read_b64_tr_b16 v[168:169], v200 offset:36864
    ds_read_b64_tr_b16 v[170:171], v200 offset:38912
    v_mfma_f32_16x16x32_bf16 v[40:43], v[160:163], v[108:111], v[40:43]
    ds_read_b64_tr_b16 v[172:173], v201 offset:36864
    ds_read_b64_tr_b16 v[174:175], v201 offset:38912
    v_mfma_f32_16x16x32_bf16 v[44:47], v[164:167], v[108:111], v[44:47]
    ds_read_b64_tr_b16 v[176:177], v202 offset:36864
    ds_read_b64_tr_b16 v[178:179], v202 offset:38912
    v_mfma_f32_16x16x32_bf16 v[36:39], v[164:167], v[104:107], v[36:39]
    ds_read_b64_tr_b16 v[180:181], v203 offset:36864
    ds_read_b64_tr_b16 v[182:183], v203 offset:38912
    v_mfma_f32_16x16x32_bf16 v[16:19], v[152:155], v[104:107], v[16:19]
    v_mfma_f32_16x16x32_bf16 v[24:27], v[152:155], v[108:111], v[24:27]
    v_mfma_f32_16x16x32_bf16 v[28:31], v[156:159], v[108:111], v[28:31]
    v_mfma_f32_16x16x32_bf16 v[20:23], v[156:159], v[104:107], v[20:23]
    s_nop 0
    s_waitcnt lgkmcnt(0)
    v_mfma_f32_16x16x32_bf16 v[32:35], v[176:179], v[112:115], v[32:35]
    v_mfma_f32_16x16x32_bf16 v[40:43], v[176:179], v[116:119], v[40:43]
    v_mfma_f32_16x16x32_bf16 v[44:47], v[180:183], v[116:119], v[44:47]
    v_mfma_f32_16x16x32_bf16 v[36:39], v[180:183], v[112:115], v[36:39]
    v_mfma_f32_16x16x32_bf16 v[16:19], v[168:171], v[112:115], v[16:19]
    s_nop 3
    s_nop 0
    ds_write_b128 v11, v[32:35] offset:32768
    v_mfma_f32_16x16x32_bf16 v[24:27], v[168:171], v[116:119], v[24:27]
    ds_write_b128 v11, v[40:43] offset:34816
    v_mfma_f32_16x16x32_bf16 v[28:31], v[172:175], v[116:119], v[28:31]
    ds_write_b128 v11, v[36:39] offset:33792
    v_mfma_f32_16x16x32_bf16 v[20:23], v[172:175], v[112:115], v[20:23]
    ds_write_b128 v11, v[44:47] offset:35840
    s_waitcnt lgkmcnt(0)
    s_barrier
    ds_read_b128 v[32:35], v12 offset:32768
    ds_read_b128 v[36:39], v12 offset:33792
    ds_read_b128 v[40:43], v12 offset:34816
    ds_read_b128 v[44:47], v12 offset:35840
    buffer_load_dwordx4 v[56:59], v6, s[52:55], s49 offen offset:0 sc1
    buffer_load_dwordx4 v[60:63], v6, s[52:55], s49 offen offset:1024 sc1
    v_mfma_f32_16x16x32_bf16 v[120:123], v[136:139], v[184:187], 0
    v_mfma_f32_16x16x32_bf16 v[124:127], v[144:147], v[184:187], 0
    v_mfma_f32_16x16x32_bf16 v[128:131], v[136:139], v[192:195], 0
    v_mfma_f32_16x16x32_bf16 v[132:135], v[144:147], v[192:195], 0
    v_mfma_f32_16x16x32_bf16 v[120:123], v[140:143], v[188:191], v[120:123]
    v_mfma_f32_16x16x32_bf16 v[124:127], v[148:151], v[188:191], v[124:127]
    v_mfma_f32_16x16x32_bf16 v[128:131], v[140:143], v[196:199], v[128:131]
    v_mfma_f32_16x16x32_bf16 v[132:135], v[148:151], v[196:199], v[132:135]
    s_mul_i32 s35, s3, 2560
    s_add_u32 s35, s35, 32768
    v_and_b32_e64 v13, 15, v0
    v_mul_u32_u24 v13, 80, v13
    v_lshrrev_b32_e64 v14, 4, v0
    v_lshl_add_u32 v13, v14, 3, v13
    v_add_u32 v13, s35, v13
    v_lshrrev_b32 v14, 2, v0
    v_mul_u32_u24 v14, 80, v14
    v_and_b32_e64 v3, 3, v0
    v_lshl_add_u32 v14, v3, 4, v14
    v_add_u32 v14, s35, v14
    s_waitcnt lgkmcnt(0)
    v_add_f32 v16, v16, v32
    v_add_f32 v17, v17, v33
    v_add_f32 v18, v18, v34
    v_add_f32 v19, v19, v35
    v_add_f32 v20, v20, v36
    v_add_f32 v21, v21, v37
    v_add_f32 v22, v22, v38
    v_add_f32 v23, v23, v39
    v_add_f32 v24, v24, v40
    v_add_f32 v25, v25, v41
    v_add_f32 v26, v26, v42
    v_add_f32 v27, v27, v43
    v_add_f32 v28, v28, v44
    v_add_f32 v29, v29, v45
    v_add_f32 v30, v30, v46
    v_add_f32 v31, v31, v47
    s_mov_b32 s51, 0x40000
k3_poll:
    s_waitcnt vmcnt(0)
    v_and_b32 v3, v56, v60
    v_and_b32 v3, s58, v3
    v_cmp_ne_u32_e64 vcc, s58, v3
    s_sub_u32 s51, s51, 1
    s_cbranch_scc1 k3_got
    s_cbranch_vccz k3_got
    buffer_load_dwordx4 v[56:59], v6, s[52:55], s49 offen offset:0 sc1
    buffer_load_dwordx4 v[60:63], v6, s[52:55], s49 offen offset:1024 sc1
    s_branch k3_poll
k3_got:
    v_lshlrev_b32 v64, 16, v56
    v_and_b32 v65, 0xffff0000, v56
    v_lshlrev_b32_e64 v66, 16, v57
    v_and_b32 v67, 0xffff0000, v57
    v_lshlrev_b32_e64 v68, 16, v58
    v_and_b32 v69, 0xffff0000, v58
    v_lshlrev_b32_e64 v70, 16, v59
    v_and_b32 v71, 0xffff0000, v59
    v_lshlrev_b32_e64 v72, 16, v60
    v_and_b32 v73, 0xffff0000, v60
    v_lshlrev_b32_e64 v74, 16, v61
    v_and_b32 v75, 0xffff0000, v61
    v_lshlrev_b32_e64 v76, 16, v62
    v_and_b32 v77, 0xffff0000, v62
    v_lshlrev_b32_e64 v78, 16, v63
    v_and_b32 v79, 0xffff0000, v63
    v_mul_f32 v64, 0x0f800000, v64
    v_mul_f32 v72, 0x0f800000, v72
    v_add_f32 v16, v16, v64
    v_add_f32 v17, v17, v65
    v_add_f32 v18, v18, v66
    v_add_f32 v19, v19, v67
    v_add_f32 v20, v20, v68
    v_add_f32 v21, v21, v69
    v_add_f32 v22, v22, v70
    v_add_f32 v23, v23, v71
    v_mul_f32 v32, 0xbfb8aa3b, v16
    v_mul_f32 v33, 0xbfb8aa3b, v17
    v_mul_f32 v34, 0xbfb8aa3b, v18
    v_mul_f32 v35, 0xbfb8aa3b, v19
    v_mul_f32 v36, 0xbfb8aa3b, v20
    v_mul_f32 v37, 0xbfb8aa3b, v21
    v_mul_f32 v38, 0xbfb8aa3b, v22
    v_mul_f32 v39, 0xbfb8aa3b, v23
    v_exp_f32 v32, v32
    v_exp_f32 v33, v33
    v_exp_f32 v34, v34
    v_exp_f32 v35, v35
    v_exp_f32 v36, v36
    v_exp_f32 v37, v37
    v_exp_f32 v38, v38
    v_exp_f32 v39, v39
    v_add_f32 v32, 1.0, v32
    v_add_f32 v33, 1.0, v33
    v_add_f32 v34, 1.0, v34
    v_add_f32 v35, 1.0, v35
    v_add_f32 v36, 1.0, v36
    v_add_f32 v37, 1.0, v37
    v_add_f32 v38, 1.0, v38
    v_add_f32 v39, 1.0, v39
    v_rcp_f32 v32, v32
    v_rcp_f32 v33, v33
    v_rcp_f32 v34, v34
    v_rcp_f32 v35, v35
    v_rcp_f32 v36, v36
    v_rcp_f32 v37, v37
    v_rcp_f32 v38, v38
    v_rcp_f32 v39, v39
    v_mul_f32 v16, v16, v120
    v_mul_f32 v17, v17, v121
    v_mul_f32 v18, v18, v122
    v_mul_f32 v19, v19, v123
    v_mul_f32 v20, v20, v124
    v_mul_f32 v21, v21, v125
    v_mul_f32 v22, v22, v126
    v_mul_f32 v23, v23, v127
    v_mul_f32 v16, v16, v32
    v_mul_f32 v17, v17, v33
    v_mul_f32 v18, v18, v34
    v_mul_f32 v19, v19, v35
    v_mul_f32 v20, v20, v36
    v_mul_f32 v21, v21, v37
    v_mul_f32 v22, v22, v38
    v_mul_f32 v23, v23, v39
    v_cvt_pk_bf16_f32 v48, v16, v17
    v_cvt_pk_bf16_f32 v49, v18, v19
    v_cvt_pk_bf16_f32 v50, v20, v21
    v_cvt_pk_bf16_f32 v51, v22, v23
    ds_write_b64 v13, v[48:49] offset:0
    ds_write_b64 v13, v[50:51] offset:32
    ds_read_b128 v[88:91], v14 offset:0
    v_add_f32 v24, v24, v72
    v_add_f32 v25, v25, v73
    v_add_f32 v26, v26, v74
    v_add_f32 v27, v27, v75
    v_add_f32 v28, v28, v76
    v_add_f32 v29, v29, v77
    v_add_f32 v30, v30, v78
    v_add_f32 v31, v31, v79
    v_mul_f32 v40, 0xbfb8aa3b, v24
    v_mul_f32 v41, 0xbfb8aa3b, v25
    v_mul_f32 v42, 0xbfb8aa3b, v26
    v_mul_f32 v43, 0xbfb8aa3b, v27
    v_mul_f32 v44, 0xbfb8aa3b, v28
    v_mul_f32 v45, 0xbfb8aa3b, v29
    v_mul_f32 v46, 0xbfb8aa3b, v30
    v_mul_f32 v47, 0xbfb8aa3b, v31
    v_exp_f32 v40, v40
    v_exp_f32 v41, v41
    v_exp_f32 v42, v42
    v_exp_f32 v43, v43
    v_exp_f32 v44, v44
    v_exp_f32 v45, v45
    v_exp_f32 v46, v46
    v_exp_f32 v47, v47
    v_add_f32 v40, 1.0, v40
    v_add_f32 v41, 1.0, v41
    v_add_f32 v42, 1.0, v42
    v_add_f32 v43, 1.0, v43
    v_add_f32 v44, 1.0, v44
    v_add_f32 v45, 1.0, v45
    v_add_f32 v46, 1.0, v46
    v_add_f32 v47, 1.0, v47
    v_rcp_f32 v40, v40
    v_rcp_f32 v41, v41
    v_rcp_f32 v42, v42
    v_rcp_f32 v43, v43
    v_rcp_f32 v44, v44
    v_rcp_f32 v45, v45
    v_rcp_f32 v46, v46
    v_rcp_f32 v47, v47
    v_mul_f32 v24, v24, v128
    v_mul_f32 v25, v25, v129
    v_mul_f32 v26, v26, v130
    v_mul_f32 v27, v27, v131
    v_mul_f32 v28, v28, v132
    v_mul_f32 v29, v29, v133
    v_mul_f32 v30, v30, v134
    v_mul_f32 v31, v31, v135
    v_mul_f32 v24, v24, v40
    v_mul_f32 v25, v25, v41
    v_mul_f32 v26, v26, v42
    v_mul_f32 v27, v27, v43
    v_mul_f32 v28, v28, v44
    v_mul_f32 v29, v29, v45
    v_mul_f32 v30, v30, v46
    v_mul_f32 v31, v31, v47
    v_cvt_pk_bf16_f32 v52, v24, v25
    v_cvt_pk_bf16_f32 v53, v26, v27
    v_cvt_pk_bf16_f32 v54, v28, v29
    v_cvt_pk_bf16_f32 v55, v30, v31
    ds_write_b64 v13, v[52:53] offset:1280
    ds_write_b64 v13, v[54:55] offset:1312
    ds_read_b128 v[92:95], v14 offset:1280
    s_waitcnt lgkmcnt(3)
    v_lshlrev_b32 v16, 16, v80
    v_and_b32 v17, 0xffff0000, v80
    v_lshlrev_b32_e64 v18, 16, v88
    v_and_b32 v19, 0xffff0000, v88
    v_add_f32 v16, v16, v18
    v_add_f32 v17, v17, v19
    v_cvt_pk_bf16_f32 v80, v16, v17
    v_lshlrev_b32_e64 v16, 16, v81
    v_and_b32 v17, 0xffff0000, v81
    v_lshlrev_b32_e64 v18, 16, v89
    v_and_b32 v19, 0xffff0000, v89
    v_add_f32 v16, v16, v18
    v_add_f32 v17, v17, v19
    v_cvt_pk_bf16_f32 v81, v16, v17
    v_lshlrev_b32_e64 v16, 16, v82
    v_and_b32 v17, 0xffff0000, v82
    v_lshlrev_b32_e64 v18, 16, v90
    v_and_b32 v19, 0xffff0000, v90
    v_add_f32 v16, v16, v18
    v_add_f32 v17, v17, v19
    v_cvt_pk_bf16_f32 v82, v16, v17
    v_lshlrev_b32_e64 v16, 16, v83
    v_and_b32 v17, 0xffff0000, v83
    v_lshlrev_b32_e64 v18, 16, v91
    v_and_b32 v19, 0xffff0000, v91
    v_add_f32 v16, v16, v18
    v_add_f32 v17, v17, v19
    v_cvt_pk_bf16_f32 v83, v16, v17
    buffer_store_dwordx4 v[80:83], v7, s[24:27], 0 offen
    s_waitcnt lgkmcnt(0)
    v_lshlrev_b32 v16, 16, v84
    v_and_b32 v17, 0xffff0000, v84
    v_lshlrev_b32_e64 v18, 16, v92
    v_and_b32 v19, 0xffff0000, v92
    v_add_f32 v16, v16, v18
    v_add_f32 v17, v17, v19
    v_cvt_pk_bf16_f32 v84, v16, v17
    v_lshlrev_b32_e64 v16, 16, v85
    v_and_b32 v17, 0xffff0000, v85
    v_lshlrev_b32_e64 v18, 16, v93
    v_and_b32 v19, 0xffff0000, v93
    v_add_f32 v16, v16, v18
    v_add_f32 v17, v17, v19
    v_cvt_pk_bf16_f32 v85, v16, v17
    v_lshlrev_b32_e64 v16, 16, v86
    v_and_b32 v17, 0xffff0000, v86
    v_lshlrev_b32_e64 v18, 16, v94
    v_and_b32 v19, 0xffff0000, v94
    v_add_f32 v16, v16, v18
    v_add_f32 v17, v17, v19
    v_cvt_pk_bf16_f32 v86, v16, v17
    v_lshlrev_b32_e64 v16, 16, v87
    v_and_b32 v17, 0xffff0000, v87
    v_lshlrev_b32_e64 v18, 16, v95
    v_and_b32 v19, 0xffff0000, v95
    v_add_f32 v16, v16, v18
    v_add_f32 v17, v17, v19
    v_cvt_pk_bf16_f32 v87, v16, v17
    buffer_store_dwordx4 v[84:87], v7, s[24:27], s46 offen
k3_end:
    s_endpgm
.section .rodata,"a"
.p2align 6
.amdhsa_kernel k1_kernel
  .amdhsa_next_free_vgpr 256
  .amdhsa_next_free_sgpr 96
  .amdhsa_accum_offset 256
  .amdhsa_group_segment_fixed_size 0
  .amdhsa_kernarg_size 80
  .amdhsa_user_sgpr_count 2
  .amdhsa_user_sgpr_kernarg_segment_ptr 1
  .amdhsa_system_sgpr_workgroup_id_x 1
.end_amdhsa_kernel
```
